```python
import torch

def _softmax(x, axis=-1):
    return torch.softmax(x, dim=axis)
def _gelu(x):
    return torch.nn.functional.gelu(x, approximate="tanh")
def _silu(x):
    return torch.nn.functional.silu(x)
def _sigmoid(x):
    return torch.sigmoid(x)
def _layernorm(x, axis=-1, eps=1e-5):
    m = x.mean(dim=axis, keepdim=True)
    v = x.var(dim=axis, keepdim=True, unbiased=False)
    return (x - m) / torch.sqrt(v + eps)
def _scatter_add(tgt, idx, src, axis=0):
    return tgt.clone().index_add_(axis, idx, src)
def _segment_sum(src, seg, n):
    out = torch.zeros((n,) + src.shape[1:], dtype=src.dtype)
    return out.index_add_(0, seg, src)
def _pad(x, pw):
    flat = tuple(v for pair in reversed(pw) for v in pair)
    return torch.nn.functional.pad(x, flat)

kernel_name = 'parallel_sum__grouped_kv_mqa__swiglu_ffn__prompt'

def setup_inputs():

    _w = (lambda a: (lambda t: t.to(torch.bfloat16) if t.is_floating_point() else t)(torch.as_tensor(a)))
    def _A_setup():
        B, S, D, H = 1, 2048, 1024, 32
        Dh = D // H
        return {
            "x": _w((lambda *s: torch.randn(*s, dtype=torch.bfloat16) * 0.05)(B, S, D)),
            "wq": _w((lambda *s: torch.randn(*s, dtype=torch.bfloat16) * 0.1)(D, H * Dh)),
            "wk": _w((lambda *s: torch.randn(*s, dtype=torch.bfloat16) * 0.1)(D, Dh)),
            "wv": _w((lambda *s: torch.randn(*s, dtype=torch.bfloat16) * 0.05)(D, Dh)),
            "wo": _w((lambda *s: torch.randn(*s, dtype=torch.bfloat16) * 0.05)(H * Dh, D)),
        }
    _A_in = _A_setup()

    def _B_setup():
        B, S, D, F = 1, 2048, 1024, 3584
        return {
            "x": _w((lambda *s: torch.randn(*s, dtype=torch.bfloat16) * 0.05)(B, S, D)),
            "w_gate": _w((lambda *s: torch.randn(*s, dtype=torch.bfloat16) * 0.05)(D, F)),
            "w_up": _w((lambda *s: torch.randn(*s, dtype=torch.bfloat16) * 0.05)(D, F)),
            "w_down": _w((lambda *s: torch.randn(*s, dtype=torch.bfloat16) * 0.05)(F, D)),
        }
    _B_in = _B_setup()

    return {
        "A_x": _A_in["x"],
        "A_wq": _A_in["wq"],
        "A_wk": _A_in["wk"],
        "A_wv": _A_in["wv"],
        "A_wo": _A_in["wo"],
        "B_x": _B_in["x"],
        "B_w_gate": _B_in["w_gate"],
        "B_w_up": _B_in["w_up"],
        "B_w_down": _B_in["w_down"],
    }

def reference(A_x, A_wq, A_wk, A_wv, A_wo, B_x, B_w_gate, B_w_up, B_w_down):
    def _A_ref(x, wq, wk, wv, wo):
        B, S, D = x.shape
        H = 32
        Dh = D // H
        q = (lambda x, *d: x.permute(*d))((x @ wq).reshape(B, S, H, Dh), 0, 2, 1, 3)
        k = x @ wk
        v = x @ wv
        scores = torch.einsum("bhqd,bkd->bhqk", q, k) * (Dh ** -0.5)
        p = _softmax(scores, axis=-1)
        o = torch.einsum("bhqk,bkd->bhqd", p, v)
        return (lambda x, *d: x.permute(*d))(o, 0, 2, 1, 3).reshape(B, S, H * Dh) @ wo

    def _B_ref(x, w_gate, w_up, w_down):
        g = _silu(x @ w_gate)
        u = x @ w_up
        return (g * u) @ w_down

    x = A_x
    xn = _layernorm(x, axis=-1)
    return x + _A_ref(xn, A_wq, A_wk, A_wv, A_wo) + _B_ref(xn, B_w_gate, B_w_up, B_w_down)
```

```asm
; @launch kernel=proj_kernel grid=(256,1,1) block=(256,1,1) lds=163840
; @launch kernel=attn_out_kernel grid=(512,1,1) block=(256,1,1) lds=81920
.amdgcn_target "amdgcn-amd-amdhsa--gfx950"
.text
.globl proj_kernel
.p2align 8
.type proj_kernel,@function
proj_kernel:
    s_cmp_ge_u32 s2, 256
    s_cbranch_scc1 proj_kernel_done
    s_nop 0
    s_load_dwordx8 s[4:11], s[0:1], 0
    s_load_dwordx4 s[12:15], s[0:1], 48
    s_load_dwordx4 s[16:19], s[0:1], 80
    s_and_b32 s67, s2, 7
    s_lshr_b32 s68, s2, 3
    s_and_b32 s69, s67, 1
    s_lshl_b32 s69, s69, 2
    s_lshr_b32 s67, s67, 1
    s_sub_u32 s70, s68, 4
    s_mul_i32 s71, s70, 37
    s_lshr_b32 s71, s71, 8
    s_mul_i32 s72, s71, 7
    s_sub_u32 s70, s70, s72
    s_mul_i32 s72, s67, 7
    s_add_u32 s70, s70, s72
    s_add_u32 s67, s67, 28
    s_cmp_lt_u32 s68, 4
    s_cselect_b32 s21, s67, s70
    s_cselect_b32 s71, s68, s71
    s_add_u32 s20, s69, s71
    v_lshrrev_b32 v1, 6, v0
    v_and_b32 v0, 63, v0
    v_readfirstlane_b32 s22, v1
    s_mov_b32 s65, 0x3f803f80
    s_and_b32 s24, s22, 1
    s_lshr_b32 s23, s22, 1
    s_cmp_ge_u32 s21, 28
    s_cbranch_scc1 proj_kernel_qkv
proj_kernel_ffn:
    s_getpc_b64 s[74:75]
proj_kernel_ffn_pfpc:
    s_add_u32 s74, s74, proj_kernel_ffn_pfstart-proj_kernel_ffn_pfpc
    s_addc_u32 s75, s75, 0
    v_lshlrev_b32_e64 v19, 7, v0
    v_min_u32 v20, proj_kernel_ffn_pfend-proj_kernel_ffn_pfstart-4, v19
    global_load_dword v68, v20, s[74:75]
    v_add_u32 v19, 8192, v19
    v_min_u32 v20, proj_kernel_ffn_pfend-proj_kernel_ffn_pfstart-4, v19
    global_load_dword v68, v20, s[74:75]
    v_add_u32 v19, 8192, v19
    v_min_u32 v20, proj_kernel_ffn_pfend-proj_kernel_ffn_pfstart-4, v19
    global_load_dword v68, v20, s[74:75]
proj_kernel_ffn_pfstart:
    s_waitcnt lgkmcnt(0)
    s_mov_b32 s28, s4
    s_mov_b32 s29, s5
    s_mov_b32 s30, 4194304
    s_mov_b32 s31, 0x20000
    s_lshl_b32 s68, s20, 8
    s_lshl_b32 s69, s21, 3
    s_add_u32 s68, s68, s69
    s_lshl_b32 s69, s22, 1
    s_add_u32 s68, s68, s69
    s_lshl_b32 s69, s68, 11
    v_lshlrev_b32 v18, 4, v0
    buffer_load_dwordx4 v[24:27], v18, s[28:31], s69 offen offset:0
    buffer_load_dwordx4 v[28:31], v18, s[28:31], s69 offen offset:1024
    buffer_load_dwordx4 v[32:35], v18, s[28:31], s69 offen offset:2048
    buffer_load_dwordx4 v[36:39], v18, s[28:31], s69 offen offset:3072
    s_lshl_b32 s66, s68, 3
    s_mov_b32 s32, s12
    s_mov_b32 s33, s13
    s_mov_b32 s34, 7340032
    s_mov_b32 s35, 0x20000
    s_mov_b32 s36, s14
    s_mov_b32 s37, s15
    s_mov_b32 s38, 7340032
    s_mov_b32 s39, 0x20000
    s_mov_b32 s25, 0
    s_lshl_b32 s67, s21, 8
    s_add_u32 s48, s18, 29626368
    s_addc_u32 s49, s19, 0
    s_mov_b32 s50, 20480
    s_mov_b32 s51, 0x20000
    s_or_b32 s68, s2, s22
    s_cmp_eq_u32 s68, 0
    s_cbranch_scc0 proj_kernel_ffn_nozero
    v_lshrrev_b32 v21, 2, v0
    v_lshlrev_b32 v21, 8, v21
    v_and_b32 v20, 3, v0
    v_lshl_add_u32 v21, v20, 4, v21
    v_mov_b32 v56, 0
    v_mov_b32 v57, 0
    v_mov_b32 v58, 0
    v_mov_b32 v59, 0
    s_mov_b32 s68, 16384
    buffer_store_dwordx4 v[56:59], v21, s[48:51], s68 offen
proj_kernel_ffn_nozero:
    s_mov_b32 s52, 229376
    v_lshrrev_b32 v19, 4, v0
    v_and_b32 v20, 15, v0
    s_and_b32 s70, s22, 1
    s_lshl_b32 s70, s70, 2
    v_or_b32 v21, s70, v19
    v_lshrrev_b32 v22, 1, v20
    v_xor_b32 v22, v22, v21
    v_lshlrev_b32 v22, 5, v22
    v_and_b32_e64 v21, 1, v20
    v_lshl_add_u32 v22, v21, 4, v22
    s_lshl_b32 s69, s22, 3
    v_add_u32 v21, s69, v19
    v_mul_u32_u24 v21, 7168, v21
    v_add3_u32 v1, v21, v22, s67
    v_add_u32 v2, 27648, v1
    v_lshrrev_b32 v19, 3, v0
    v_and_b32 v20, 7, v0
    s_lshl_b32 s68, s20, 8
    s_lshl_b32 s69, s25, 5
    s_lshl_b32 s70, s22, 5
    s_add_u32 s70, s70, 0
    v_add_u32_e64 v21, s70, v19
    v_bfe_u32 v22, v21, 1, 3
    v_xor_b32 v22, v22, v20
    v_xor_b32 v21, s69, v21
    v_add_u32 v21, s68, v21
    v_lshlrev_b32 v21, 11, v21
    v_lshl_add_u32 v21, v22, 4, v21
    v_mov_b32 v3, v21
    s_lshl_b32 s70, s22, 5
    s_add_u32 s70, s70, 8
    v_add_u32 v21, s70, v19
    v_bfe_u32 v22, v21, 1, 3
    v_xor_b32 v22, v22, v20
    v_xor_b32 v21, s69, v21
    v_add_u32 v21, s68, v21
    v_lshlrev_b32 v21, 11, v21
    v_lshl_add_u32 v21, v22, 4, v21
    v_subrev_u32 v4, 1024, v21
    s_lshl_b32 s70, s22, 5
    s_add_u32 s70, s70, 16
    v_add_u32_e64 v21, s70, v19
    v_bfe_u32 v22, v21, 1, 3
    v_xor_b32 v22, v22, v20
    v_xor_b32 v21, s69, v21
    v_add_u32 v21, s68, v21
    v_lshlrev_b32 v21, 11, v21
    v_lshl_add_u32 v21, v22, 4, v21
    v_subrev_u32 v5, 2048, v21
    s_lshl_b32 s70, s22, 5
    s_add_u32 s70, s70, 24
    v_add_u32_e64 v21, s70, v19
    v_bfe_u32 v22, v21, 1, 3
    v_xor_b32 v22, v22, v20
    v_xor_b32 v21, s69, v21
    v_add_u32 v21, s68, v21
    v_lshlrev_b32 v21, 11, v21
    v_lshl_add_u32 v21, v22, 4, v21
    v_subrev_u32 v6, 3072, v21
    s_lshl_b32 s59, s22, 11
    s_lshl_b32 s60, s22, 12
    s_add_u32 s60, s60, 65536
    s_mov_b32 s58, 0
    s_mov_b32 s54, 0
    s_add_u32 s72, s58, s60
    s_mov_b32 m0, s72
    s_nop 0
    s_nop 0
    buffer_load_dwordx4 v3, s[28:31], s54 offen offset:0 lds
    buffer_load_dwordx4 v4, s[28:31], s54 offen offset:1024 lds
    buffer_load_dwordx4 v5, s[28:31], s54 offen offset:2048 lds
    buffer_load_dwordx4 v6, s[28:31], s54 offen offset:3072 lds
    s_mov_b32 s56, 0
    s_mov_b32 s53, 0
    s_add_u32 m0, s56, s59
    s_nop 0
    buffer_load_dwordx4 v1, s[32:35], s53 offen offset:0 lds
    buffer_load_dwordx4 v2, s[32:35], s53 offen offset:1024 lds
    s_add_u32 m0, m0, 8192
    s_nop 0
    buffer_load_dwordx4 v1, s[36:39], s53 offen offset:0 lds
    buffer_load_dwordx4 v2, s[36:39], s53 offen offset:1024 lds
    s_mov_b32 s58, 0
    s_mov_b32 s54, 262144
    s_add_u32 s72, s58, s60
    s_add_u32 m0, s72, 16384
    s_nop 0
    buffer_load_dwordx4 v3, s[28:31], s54 offen offset:0 lds
    buffer_load_dwordx4 v4, s[28:31], s54 offen offset:1024 lds
    buffer_load_dwordx4 v5, s[28:31], s54 offen offset:2048 lds
    buffer_load_dwordx4 v6, s[28:31], s54 offen offset:3072 lds
    s_mov_b32 s56, 16384
    s_mov_b32 s53, 229376
    s_add_u32 m0, s56, s59
    s_nop 0
    buffer_load_dwordx4 v1, s[32:35], s53 offen offset:0 lds
    buffer_load_dwordx4 v2, s[32:35], s53 offen offset:1024 lds
    s_add_u32 m0, m0, 8192
    s_nop 0
    s_nop 0
    buffer_load_dwordx4 v1, s[36:39], s53 offen offset:0 lds
    buffer_load_dwordx4 v2, s[36:39], s53 offen offset:1024 lds
    s_mov_b32 s58, 32768
    s_mov_b32 s54, 128
    s_add_u32 s72, s58, s60
    s_mov_b32 m0, s72
    s_nop 0
    s_nop 0
    buffer_load_dwordx4 v3, s[28:31], s54 offen offset:0 lds
    buffer_load_dwordx4 v4, s[28:31], s54 offen offset:1024 lds
    buffer_load_dwordx4 v5, s[28:31], s54 offen offset:2048 lds
    buffer_load_dwordx4 v6, s[28:31], s54 offen offset:3072 lds
    s_mov_b32 s58, 32768
    s_mov_b32 s54, 262272
    s_add_u32 s72, s58, s60
    s_add_u32 m0, s72, 16384
    s_nop 0
    buffer_load_dwordx4 v3, s[28:31], s54 offen offset:0 lds
    buffer_load_dwordx4 v4, s[28:31], s54 offen offset:1024 lds
    buffer_load_dwordx4 v5, s[28:31], s54 offen offset:2048 lds
    buffer_load_dwordx4 v6, s[28:31], s54 offen offset:3072 lds
    s_mov_b32 s56, 32768
    s_mov_b32 s53, 458752
    s_add_u32 m0, s56, s59
    s_nop 0
    buffer_load_dwordx4 v1, s[32:35], s53 offen offset:0 lds
    buffer_load_dwordx4 v2, s[32:35], s53 offen offset:1024 lds
    s_add_u32 m0, m0, 8192
    s_nop 0
    buffer_load_dwordx4 v1, s[36:39], s53 offen offset:0 lds
    buffer_load_dwordx4 v2, s[36:39], s53 offen offset:1024 lds
    v_and_b32 v19, 15, v0
    s_lshl_b32 s71, s20, 8
    s_lshl_b32 s72, s23, 7
    s_add_u32 s71, s71, s72
    v_add_u32 v19, s71, v19
    v_lshlrev_b32 v66, 3, v19
    v_lshrrev_b32 v19, 4, v0
    v_bfe_u32 v20, v0, 2, 2
    v_and_b32_e64 v21, 1, v19
    v_lshl_or_b32 v22, v21, 2, v20
    v_lshl_add_u32 v19, v19, 3, v20
    v_and_b32 v20, 3, v0
    v_lshlrev_b32 v19, 8, v19
    v_lshl_add_u32 v19, v20, 3, v19
    s_lshl_b32 s68, s24, 2
    s_add_u32 s69, s68, 0
    v_xor_b32_e64 v21, s69, v22
    v_lshl_add_u32 v7, v21, 5, v19
    s_add_u32 s69, s68, 1
    v_xor_b32 v21, s69, v22
    v_lshl_add_u32 v8, v21, 5, v19
    s_add_u32 s69, s68, 2
    v_xor_b32 v21, s69, v22
    v_lshl_add_u32 v9, v21, 5, v19
    s_add_u32 s69, s68, 3
    v_xor_b32 v21, s69, v22
    v_lshl_add_u32 v10, v21, 5, v19
    v_and_b32 v19, 15, v0
    v_lshrrev_b32 v20, 4, v0
    v_lshrrev_b32 v21, 1, v19
    v_xor_b32_e64 v21, v21, v20
    s_lshl_b32 s68, s23, 14
    s_add_u32 s68, s68, 65536
    v_lshlrev_b32 v19, 7, v19
    v_add_u32 v19, s68, v19
    v_lshl_add_u32 v15, v21, 4, v19
    v_xor_b32_e64 v21, 4, v21
    v_lshl_add_u32 v16, v21, 4, v19
    v_mov_b32_e64 v19, s65
    v_accvgpr_write_b32 a112, v19
    v_accvgpr_write_b32 a113, v19
    v_accvgpr_write_b32 a114, v19
    v_accvgpr_write_b32 a115, v19
    s_waitcnt vmcnt(28)
    s_nop 0
    s_mov_b32 s68, 0xffff0000
    s_mov_b32 s69, 0x3a800000
    s_mov_b32 s70, 0x3727c5ac
    v_lshlrev_b32 v76, 16, v24
    v_lshlrev_b32 v92, 16, v32
    v_and_b32 v77, s68, v24
    v_and_b32 v93, s68, v32
    v_lshlrev_b32 v78, 16, v25
    v_lshlrev_b32 v94, 16, v33
    v_and_b32 v79, s68, v25
    v_and_b32 v95, s68, v33
    v_lshlrev_b32 v80, 16, v26
    v_lshlrev_b32 v96, 16, v34
    v_and_b32 v81, s68, v26
    v_and_b32 v97, s68, v34
    v_lshlrev_b32 v82, 16, v27
    v_lshlrev_b32 v98, 16, v35
    v_and_b32 v83, s68, v27
    v_and_b32 v99, s68, v35
    v_lshlrev_b32 v84, 16, v28
    v_lshlrev_b32 v100, 16, v36
    v_and_b32 v85, s68, v28
    v_and_b32 v101, s68, v36
    v_lshlrev_b32 v86, 16, v29
    v_lshlrev_b32 v102, 16, v37
    v_and_b32 v87, s68, v29
    v_and_b32 v103, s68, v37
    v_lshlrev_b32 v88, 16, v30
    v_lshlrev_b32 v104, 16, v38
    v_and_b32 v89, s68, v30
    v_and_b32 v105, s68, v38
    v_lshlrev_b32 v90, 16, v31
    v_lshlrev_b32 v106, 16, v39
    v_and_b32 v91, s68, v31
    v_and_b32 v107, s68, v39
    v_pk_add_f32 v[60:61], v[76:77], v[78:79] op_sel:[0,0] op_sel_hi:[1,1]
    v_pk_add_f32 v[62:63], v[92:93], v[94:95] op_sel:[0,0] op_sel_hi:[1,1]
    v_pk_add_f32 v[60:61], v[60:61], v[80:81] op_sel:[0,0] op_sel_hi:[1,1]
    v_pk_add_f32 v[62:63], v[62:63], v[96:97] op_sel:[0,0] op_sel_hi:[1,1]
    v_pk_add_f32 v[60:61], v[60:61], v[82:83] op_sel:[0,0] op_sel_hi:[1,1]
    v_pk_add_f32 v[62:63], v[62:63], v[98:99] op_sel:[0,0] op_sel_hi:[1,1]
    v_pk_add_f32 v[60:61], v[60:61], v[84:85] op_sel:[0,0] op_sel_hi:[1,1]
    v_pk_add_f32 v[62:63], v[62:63], v[100:101] op_sel:[0,0] op_sel_hi:[1,1]
    v_pk_add_f32 v[60:61], v[60:61], v[86:87] op_sel:[0,0] op_sel_hi:[1,1]
    v_pk_add_f32 v[62:63], v[62:63], v[102:103] op_sel:[0,0] op_sel_hi:[1,1]
    v_pk_add_f32 v[60:61], v[60:61], v[88:89] op_sel:[0,0] op_sel_hi:[1,1]
    v_pk_add_f32 v[62:63], v[62:63], v[104:105] op_sel:[0,0] op_sel_hi:[1,1]
    v_pk_add_f32 v[60:61], v[60:61], v[90:91] op_sel:[0,0] op_sel_hi:[1,1]
    v_pk_add_f32 v[62:63], v[62:63], v[106:107] op_sel:[0,0] op_sel_hi:[1,1]
    v_add_f32 v60, v60, v61
    v_add_f32 v62, v62, v63
    s_nop 0
    s_nop 0
    v_add_f32_dpp v60, v60, v60 quad_perm:[1,0,3,2] row_mask:0xf bank_mask:0xf
    v_add_f32_dpp v62, v62, v62 quad_perm:[1,0,3,2] row_mask:0xf bank_mask:0xf
    s_nop 0
    v_add_f32_dpp v60, v60, v60 quad_perm:[2,3,0,1] row_mask:0xf bank_mask:0xf
    v_add_f32_dpp v62, v62, v62 quad_perm:[2,3,0,1] row_mask:0xf bank_mask:0xf
    s_nop 0
    v_add_f32_dpp v60, v60, v60 row_half_mirror row_mask:0xf bank_mask:0xf
    v_add_f32_dpp v62, v62, v62 row_half_mirror row_mask:0xf bank_mask:0xf
    s_nop 0
    v_add_f32_dpp v60, v60, v60 row_mirror row_mask:0xf bank_mask:0xf
    v_add_f32_dpp v62, v62, v62 row_mirror row_mask:0xf bank_mask:0xf
    v_mov_b32 v64, v60
    v_mov_b32 v65, v62
    s_nop 0
    v_permlane16_swap_b32 v60, v64
    v_permlane16_swap_b32 v62, v65
    s_nop 0
    v_add_f32 v60, v60, v64
    v_add_f32 v62, v62, v65
    v_mov_b32 v64, v60
    v_mov_b32 v65, v62
    s_nop 0
    v_permlane32_swap_b32 v60, v64
    v_permlane32_swap_b32 v62, v65
    s_nop 0
    v_add_f32 v60, v60, v64
    v_add_f32 v62, v62, v65
    v_mul_f32 v56, s69, v60
    v_mul_f32 v58, s69, v62
    v_sub_f32 v56, 0, v56
    v_sub_f32_e64 v58, 0, v58
    v_pk_add_f32 v[76:77], v[76:77], v[56:57] op_sel:[0,0] op_sel_hi:[1,0]
    v_pk_add_f32 v[92:93], v[92:93], v[58:59] op_sel:[0,0] op_sel_hi:[1,0]
    v_pk_add_f32 v[78:79], v[78:79], v[56:57] op_sel:[0,0] op_sel_hi:[1,0]
    v_pk_add_f32 v[94:95], v[94:95], v[58:59] op_sel:[0,0] op_sel_hi:[1,0]
    v_pk_add_f32 v[80:81], v[80:81], v[56:57] op_sel:[0,0] op_sel_hi:[1,0]
    v_pk_add_f32 v[96:97], v[96:97], v[58:59] op_sel:[0,0] op_sel_hi:[1,0]
    v_pk_add_f32 v[82:83], v[82:83], v[56:57] op_sel:[0,0] op_sel_hi:[1,0]
    v_pk_add_f32 v[98:99], v[98:99], v[58:59] op_sel:[0,0] op_sel_hi:[1,0]
    v_pk_add_f32 v[84:85], v[84:85], v[56:57] op_sel:[0,0] op_sel_hi:[1,0]
    v_pk_add_f32 v[100:101], v[100:101], v[58:59] op_sel:[0,0] op_sel_hi:[1,0]
    v_pk_add_f32 v[86:87], v[86:87], v[56:57] op_sel:[0,0] op_sel_hi:[1,0]
    v_pk_add_f32 v[102:103], v[102:103], v[58:59] op_sel:[0,0] op_sel_hi:[1,0]
    v_pk_add_f32 v[88:89], v[88:89], v[56:57] op_sel:[0,0] op_sel_hi:[1,0]
    v_pk_add_f32 v[104:105], v[104:105], v[58:59] op_sel:[0,0] op_sel_hi:[1,0]
    v_pk_add_f32 v[90:91], v[90:91], v[56:57] op_sel:[0,0] op_sel_hi:[1,0]
    v_pk_add_f32 v[106:107], v[106:107], v[58:59] op_sel:[0,0] op_sel_hi:[1,0]
    v_pk_mul_f32 v[60:61], v[76:77], v[76:77] op_sel:[0,0] op_sel_hi:[1,1]
    v_pk_mul_f32 v[62:63], v[92:93], v[92:93] op_sel:[0,0] op_sel_hi:[1,1]
    v_pk_fma_f32 v[60:61], v[78:79], v[78:79], v[60:61] op_sel:[0,0,0] op_sel_hi:[1,1,1]
    v_pk_fma_f32 v[62:63], v[94:95], v[94:95], v[62:63] op_sel:[0,0,0] op_sel_hi:[1,1,1]
    v_pk_fma_f32 v[60:61], v[80:81], v[80:81], v[60:61] op_sel:[0,0,0] op_sel_hi:[1,1,1]
    v_pk_fma_f32 v[62:63], v[96:97], v[96:97], v[62:63] op_sel:[0,0,0] op_sel_hi:[1,1,1]
    v_pk_fma_f32 v[60:61], v[82:83], v[82:83], v[60:61] op_sel:[0,0,0] op_sel_hi:[1,1,1]
    v_pk_fma_f32 v[62:63], v[98:99], v[98:99], v[62:63] op_sel:[0,0,0] op_sel_hi:[1,1,1]
    v_pk_fma_f32 v[60:61], v[84:85], v[84:85], v[60:61] op_sel:[0,0,0] op_sel_hi:[1,1,1]
    v_pk_fma_f32 v[62:63], v[100:101], v[100:101], v[62:63] op_sel:[0,0,0] op_sel_hi:[1,1,1]
    v_pk_fma_f32 v[60:61], v[86:87], v[86:87], v[60:61] op_sel:[0,0,0] op_sel_hi:[1,1,1]
    v_pk_fma_f32 v[62:63], v[102:103], v[102:103], v[62:63] op_sel:[0,0,0] op_sel_hi:[1,1,1]
    v_pk_fma_f32 v[60:61], v[88:89], v[88:89], v[60:61] op_sel:[0,0,0] op_sel_hi:[1,1,1]
    v_pk_fma_f32 v[62:63], v[104:105], v[104:105], v[62:63] op_sel:[0,0,0] op_sel_hi:[1,1,1]
    v_pk_fma_f32 v[60:61], v[90:91], v[90:91], v[60:61] op_sel:[0,0,0] op_sel_hi:[1,1,1]
    v_pk_fma_f32 v[62:63], v[106:107], v[106:107], v[62:63] op_sel:[0,0,0] op_sel_hi:[1,1,1]
    v_add_f32 v60, v60, v61
    v_add_f32 v62, v62, v63
    s_nop 0
    s_nop 0
    v_add_f32_dpp v60, v60, v60 quad_perm:[1,0,3,2] row_mask:0xf bank_mask:0xf
    v_add_f32_dpp v62, v62, v62 quad_perm:[1,0,3,2] row_mask:0xf bank_mask:0xf
    s_nop 0
    v_add_f32_dpp v60, v60, v60 quad_perm:[2,3,0,1] row_mask:0xf bank_mask:0xf
    v_add_f32_dpp v62, v62, v62 quad_perm:[2,3,0,1] row_mask:0xf bank_mask:0xf
    s_nop 0
    v_add_f32_dpp v60, v60, v60 row_half_mirror row_mask:0xf bank_mask:0xf
    v_add_f32_dpp v62, v62, v62 row_half_mirror row_mask:0xf bank_mask:0xf
    s_nop 0
    v_add_f32_dpp v60, v60, v60 row_mirror row_mask:0xf bank_mask:0xf
    v_add_f32_dpp v62, v62, v62 row_mirror row_mask:0xf bank_mask:0xf
    v_mov_b32 v64, v60
    v_mov_b32 v65, v62
    s_nop 0
    v_permlane16_swap_b32 v60, v64
    v_permlane16_swap_b32 v62, v65
    s_nop 0
    v_add_f32 v60, v60, v64
    v_add_f32 v62, v62, v65
    v_mov_b32 v64, v60
    v_mov_b32 v65, v62
    s_nop 0
    v_permlane32_swap_b32 v60, v64
    v_permlane32_swap_b32 v62, v65
    s_nop 0
    v_add_f32 v60, v60, v64
    v_add_f32 v62, v62, v65
    v_mov_b32 v57, s70
    v_mov_b32 v59, s70
    v_fmac_f32 v57, s69, v60
    v_fmac_f32 v59, s69, v62
    v_mov_b32 v19, s66
    v_cmp_eq_u32 vcc, 0, v0
    s_and_saveexec_b64 s[4:5], vcc
    buffer_store_dwordx4 v[56:59], v19, s[48:51], 0 offen sc0 sc1
    s_mov_b64 exec, s[4:5]
    s_waitcnt vmcnt(17)
    s_barrier
    s_nop 0
    ds_read_b128 a[32:35], v15 offset:0
    ds_read_b64_tr_b16 v[24:25], v7 offset:0
    ds_read_b64_tr_b16 v[26:27], v7 offset:1024
    ds_read_b64_tr_b16 v[40:41], v7 offset:8192
    ds_read_b64_tr_b16 v[42:43], v7 offset:9216
    ds_read_b64_tr_b16 v[28:29], v8 offset:0
    ds_read_b64_tr_b16 v[30:31], v8 offset:1024
    ds_read_b64_tr_b16 v[44:45], v8 offset:8192
    ds_read_b64_tr_b16 v[46:47], v8 offset:9216
    ds_read_b64_tr_b16 v[32:33], v9 offset:0
    ds_read_b64_tr_b16 v[34:35], v9 offset:1024
    ds_read_b64_tr_b16 v[48:49], v9 offset:8192
    ds_read_b64_tr_b16 v[50:51], v9 offset:9216
    ds_read_b64_tr_b16 v[36:37], v10 offset:0
    ds_read_b64_tr_b16 v[38:39], v10 offset:1024
    ds_read_b64_tr_b16 v[52:53], v10 offset:8192
    ds_read_b64_tr_b16 v[54:55], v10 offset:9216
    ds_read_b128 a[36:39], v15 offset:2048
    ds_read_b128 a[40:43], v15 offset:4096
    ds_read_b128 a[44:47], v15 offset:6144
    ds_read_b128 a[48:51], v15 offset:8192
    ds_read_b128 a[52:55], v15 offset:10240
    ds_read_b128 a[56:59], v15 offset:12288
    ds_read_b128 a[60:63], v15 offset:14336
    s_waitcnt vmcnt(13) lgkmcnt(0)
    s_barrier
    s_mov_b32 s55, 16384
    s_mov_b32 s56, 0
    s_mov_b32 s53, 917504
    s_mov_b32 s57, 0
    s_mov_b32 s58, 65536
    s_mov_b32 s54, 262400
    s_mov_b32 s61, 16
    s_cmp_eq_u32 s22, 0
    s_cselect_b32 s62, 32780, 12
    v_add_u32 v11, s55, v7
    v_add_u32 v12, s55, v8
    v_add_u32 v13, s55, v9
    v_add_u32 v14, s55, v10
    v_add_u32 v17, s57, v16
    s_cmp_eq_u32 s23, 0
    s_cbranch_scc0 proj_kernel_ffn_first1
proj_kernel_ffn_first0:
    v_mfma_f32_16x16x32_bf16 v[68:71], v[24:27], a[32:35], 0
    ds_read_b128 a[64:67], v17 offset:0
    s_mov_b32 s56, 49152
    v_mfma_f32_16x16x32_bf16 v[72:75], v[28:31], a[32:35], 0
    s_mov_b32 s53, 688128
    v_mfma_f32_16x16x32_bf16 v[76:79], v[32:35], a[32:35], 0
    ds_read_b64_tr_b16 a[0:1], v11 offset:0
    s_add_u32 m0, s56, s59
    v_mfma_f32_16x16x32_bf16 v[80:83], v[36:39], a[32:35], 0
    s_nop 0
    v_mfma_f32_16x16x32_bf16 v[84:87], v[40:43], a[32:35], 0
    ds_read_b64_tr_b16 a[2:3], v11 offset:1024
    v_mfma_f32_16x16x32_bf16 v[88:91], v[44:47], a[32:35], 0
    buffer_load_dwordx4 v1, s[32:35], s53 offen offset:0 lds
    v_mfma_f32_16x16x32_bf16 v[92:95], v[48:51], a[32:35], 0
    buffer_load_dwordx4 v2, s[32:35], s53 offen offset:1024 lds
    v_mfma_f32_16x16x32_bf16 v[96:99], v[52:55], a[32:35], 0
    ds_read_b64_tr_b16 a[16:17], v11 offset:8192
    s_add_u32 m0, m0, 8192
    v_mfma_f32_16x16x32_bf16 v[100:103], v[24:27], a[36:39], 0
    s_nop 0
    v_mfma_f32_16x16x32_bf16 v[104:107], v[28:31], a[36:39], 0
    ds_read_b64_tr_b16 a[18:19], v11 offset:9216
    v_mfma_f32_16x16x32_bf16 v[108:111], v[32:35], a[36:39], 0
    buffer_load_dwordx4 v1, s[36:39], s53 offen offset:0 lds
    v_mfma_f32_16x16x32_bf16 v[112:115], v[36:39], a[36:39], 0
    ds_read_b64_tr_b16 a[4:5], v12 offset:0
    buffer_load_dwordx4 v2, s[36:39], s53 offen offset:1024 lds
    v_mfma_f32_16x16x32_bf16 v[116:119], v[40:43], a[36:39], 0
    s_mov_b32 s56, 0
    v_mfma_f32_16x16x32_bf16 v[120:123], v[44:47], a[36:39], 0
    v_mfma_f32_16x16x32_bf16 v[124:127], v[48:51], a[36:39], 0
    ds_read_b64_tr_b16 a[6:7], v12 offset:1024
    s_mov_b32 s53, 917504
    v_mfma_f32_16x16x32_bf16 v[128:131], v[52:55], a[36:39], 0
    s_mov_b32 s58, 65536
    v_mfma_f32_16x16x32_bf16 v[132:135], v[24:27], a[40:43], 0
    ds_read_b64_tr_b16 a[20:21], v12 offset:8192
    s_mov_b32 s54, 256
    v_mfma_f32_16x16x32_bf16 v[136:139], v[28:31], a[40:43], 0
    s_add_u32 s72, s58, s60
    v_mfma_f32_16x16x32_bf16 v[140:143], v[32:35], a[40:43], 0
    v_mfma_f32_16x16x32_bf16 v[144:147], v[36:39], a[40:43], 0
    ds_read_b64_tr_b16 a[22:23], v12 offset:9216
    s_mov_b32 m0, s72
    v_mfma_f32_16x16x32_bf16 v[148:151], v[40:43], a[40:43], 0
    s_nop 0
    v_mfma_f32_16x16x32_bf16 v[152:155], v[44:47], a[40:43], 0
    ds_read_b64_tr_b16 a[8:9], v13 offset:0
    buffer_load_dwordx4 v3, s[28:31], s54 offen offset:0 lds
    v_mfma_f32_16x16x32_bf16 v[156:159], v[48:51], a[40:43], 0
    v_mfma_f32_16x16x32_bf16 v[160:163], v[52:55], a[40:43], 0
    ds_read_b64_tr_b16 a[10:11], v13 offset:1024
    buffer_load_dwordx4 v4, s[28:31], s54 offen offset:1024 lds
    v_mfma_f32_16x16x32_bf16 a[116:119], v[24:27], a[112:115], 0
    buffer_load_dwordx4 v5, s[28:31], s54 offen offset:2048 lds
    v_mfma_f32_16x16x32_bf16 v[164:167], v[24:27], a[44:47], 0
    buffer_load_dwordx4 v6, s[28:31], s54 offen offset:3072 lds
    v_mfma_f32_16x16x32_bf16 v[168:171], v[28:31], a[44:47], 0
    ds_read_b64_tr_b16 a[24:25], v13 offset:8192
    s_mov_b32 s54, 262400
    v_mfma_f32_16x16x32_bf16 v[172:175], v[32:35], a[44:47], 0
    v_mfma_f32_16x16x32_bf16 v[176:179], v[36:39], a[44:47], 0
    ds_read_b64_tr_b16 a[26:27], v13 offset:9216
    s_add_u32 m0, s56, s59
    v_mfma_f32_16x16x32_bf16 v[180:183], v[40:43], a[44:47], 0
    s_nop 0
    v_mfma_f32_16x16x32_bf16 v[184:187], v[44:47], a[44:47], 0
    ds_read_b64_tr_b16 a[12:13], v14 offset:0
    buffer_load_dwordx4 v1, s[32:35], s53 offen offset:0 lds
    v_mfma_f32_16x16x32_bf16 v[188:191], v[48:51], a[44:47], 0
    v_mfma_f32_16x16x32_bf16 v[192:195], v[52:55], a[44:47], 0
    buffer_load_dwordx4 v2, s[32:35], s53 offen offset:1024 lds
    v_mfma_f32_16x16x32_bf16 a[120:123], v[28:31], a[112:115], 0
    ds_read_b64_tr_b16 a[14:15], v14 offset:1024
    s_add_u32 m0, m0, 8192
    v_mfma_f32_16x16x32_bf16 v[196:199], v[24:27], a[48:51], 0
    s_nop 0
    v_mfma_f32_16x16x32_bf16 v[200:203], v[28:31], a[48:51], 0
    ds_read_b64_tr_b16 a[28:29], v14 offset:8192
    buffer_load_dwordx4 v1, s[36:39], s53 offen offset:0 lds
    v_mfma_f32_16x16x32_bf16 v[204:207], v[32:35], a[48:51], 0
    v_mfma_f32_16x16x32_bf16 v[208:211], v[36:39], a[48:51], 0
    buffer_load_dwordx4 v2, s[36:39], s53 offen offset:1024 lds
    v_mfma_f32_16x16x32_bf16 v[212:215], v[40:43], a[48:51], 0
    ds_read_b64_tr_b16 a[30:31], v14 offset:9216
    s_add_u32 s53, s53, s52
    v_mfma_f32_16x16x32_bf16 v[216:219], v[44:47], a[48:51], 0
    s_mov_b32 s56, s55
    v_mfma_f32_16x16x32_bf16 v[220:223], v[48:51], a[48:51], 0
    ds_read_b128 a[68:71], v17 offset:2048
    s_add_u32 s55, s55, 16384
    v_mfma_f32_16x16x32_bf16 v[224:227], v[52:55], a[48:51], 0
    v_mfma_f32_16x16x32_bf16 a[124:127], v[32:35], a[112:115], 0
    ds_read_b128 a[72:75], v17 offset:4096
    s_cmp_eq_u32 s55, 65536
    v_mfma_f32_16x16x32_bf16 v[228:231], v[24:27], a[52:55], 0
    s_cselect_b32 s55, 0, s55
    v_mfma_f32_16x16x32_bf16 v[232:235], v[28:31], a[52:55], 0
    s_add_u32 s72, s58, s60
    v_mfma_f32_16x16x32_bf16 v[236:239], v[32:35], a[52:55], 0
    ds_read_b128 a[76:79], v17 offset:6144
    v_mfma_f32_16x16x32_bf16 v[240:243], v[36:39], a[52:55], 0
    s_add_u32 m0, s72, 16384
    v_mfma_f32_16x16x32_bf16 v[244:247], v[40:43], a[52:55], 0
    ds_read_b128 a[80:83], v17 offset:8192
    s_nop 0
    v_mfma_f32_16x16x32_bf16 v[248:251], v[44:47], a[52:55], 0
    buffer_load_dwordx4 v3, s[28:31], s54 offen offset:0 lds
    v_mfma_f32_16x16x32_bf16 a[132:135], v[48:51], a[52:55], 0
    ds_read_b128 a[84:87], v17 offset:10240
    buffer_load_dwordx4 v4, s[28:31], s54 offen offset:1024 lds
    v_mfma_f32_16x16x32_bf16 a[136:139], v[52:55], a[52:55], 0
    v_mfma_f32_16x16x32_bf16 a[128:131], v[36:39], a[112:115], 0
    buffer_load_dwordx4 v5, s[28:31], s54 offen offset:2048 lds
    v_mfma_f32_16x16x32_bf16 a[140:143], v[24:27], a[56:59], 0
    ds_read_b128 a[88:91], v17 offset:12288
    buffer_load_dwordx4 v6, s[28:31], s54 offen offset:3072 lds
    v_mfma_f32_16x16x32_bf16 a[144:147], v[28:31], a[56:59], 0
    s_add_u32 s54, s54, -262016
    v_mfma_f32_16x16x32_bf16 a[148:151], v[32:35], a[56:59], 0
    ds_read_b128 a[92:95], v17 offset:14336
    v_mfma_f32_16x16x32_bf16 a[152:155], v[36:39], a[56:59], 0
    s_mov_b32 s58, s57
    v_mfma_f32_16x16x32_bf16 a[156:159], v[40:43], a[56:59], 0
    s_and_b32 s71, s54, 0x3ffff
    v_mfma_f32_16x16x32_bf16 a[160:163], v[44:47], a[56:59], 0
    s_cmp_ge_u32 s71, 2048
    v_mfma_f32_16x16x32_bf16 a[164:167], v[48:51], a[56:59], 0
    s_cselect_b32 s54, 0x40000000, s54
    v_mfma_f32_16x16x32_bf16 a[168:171], v[52:55], a[56:59], 0
    v_mfma_f32_16x16x32_bf16 a[172:175], v[24:27], a[60:63], 0
    s_add_u32 s57, s57, 32768
    v_mfma_f32_16x16x32_bf16 a[176:179], v[28:31], a[60:63], 0
    s_cmp_eq_u32 s57, 98304
    v_mfma_f32_16x16x32_bf16 a[180:183], v[32:35], a[60:63], 0
    s_cselect_b32 s57, 0, s57
    v_add_u32 v11, s55, v7
    v_mfma_f32_16x16x32_bf16 a[184:187], v[36:39], a[60:63], 0
    v_add_u32_e64 v12, s55, v8
    v_mfma_f32_16x16x32_bf16 a[188:191], v[40:43], a[60:63], 0
    v_add_u32_e64 v13, s55, v9
    v_mfma_f32_16x16x32_bf16 a[192:195], v[44:47], a[60:63], 0
    v_add_u32_e64 v14, s55, v10
    v_mfma_f32_16x16x32_bf16 a[196:199], v[48:51], a[60:63], 0
    v_add_u32_e64 v17, s57, v15
    v_mfma_f32_16x16x32_bf16 a[200:203], v[52:55], a[60:63], 0
    s_waitcnt vmcnt(17) lgkmcnt(0)
    s_barrier
    s_branch proj_kernel_ffn_mid0
proj_kernel_ffn_loop0:
    s_bitcmp1_b32 s62, s61
    s_cbranch_scc1 proj_kernel_ffn_event
proj_kernel_ffn_resume0:
    v_mfma_f32_16x16x32_bf16 v[68:71], v[24:27], a[32:35], v[68:71]
    ds_read_b128 a[64:67], v17 offset:0
    s_add_u32 m0, s56, s59
    v_mfma_f32_16x16x32_bf16 v[72:75], v[28:31], a[32:35], v[72:75]
    v_mfma_f32_16x16x32_bf16 v[76:79], v[32:35], a[32:35], v[76:79]
    ds_read_b64_tr_b16 a[0:1], v11 offset:0
    s_nop 0
    v_mfma_f32_16x16x32_bf16 v[80:83], v[36:39], a[32:35], v[80:83]
    v_mfma_f32_16x16x32_bf16 v[84:87], v[40:43], a[32:35], v[84:87]
    ds_read_b64_tr_b16 a[2:3], v11 offset:1024
    buffer_load_dwordx4 v1, s[32:35], s53 offen offset:0 lds
    v_mfma_f32_16x16x32_bf16 v[88:91], v[44:47], a[32:35], v[88:91]
    v_mfma_f32_16x16x32_bf16 v[92:95], v[48:51], a[32:35], v[92:95]
    buffer_load_dwordx4 v2, s[32:35], s53 offen offset:1024 lds
    v_mfma_f32_16x16x32_bf16 v[96:99], v[52:55], a[32:35], v[96:99]
    ds_read_b64_tr_b16 a[16:17], v11 offset:8192
    v_mfma_f32_16x16x32_bf16 v[100:103], v[24:27], a[36:39], v[100:103]
    v_mfma_f32_16x16x32_bf16 v[104:107], v[28:31], a[36:39], v[104:107]
    ds_read_b64_tr_b16 a[18:19], v11 offset:9216
    s_add_u32 m0, m0, 8192
    v_mfma_f32_16x16x32_bf16 v[108:111], v[32:35], a[36:39], v[108:111]
    v_mfma_f32_16x16x32_bf16 v[112:115], v[36:39], a[36:39], v[112:115]
    ds_read_b64_tr_b16 a[4:5], v12 offset:0
    s_nop 0
    v_mfma_f32_16x16x32_bf16 v[116:119], v[40:43], a[36:39], v[116:119]
    v_mfma_f32_16x16x32_bf16 v[120:123], v[44:47], a[36:39], v[120:123]
    buffer_load_dwordx4 v1, s[36:39], s53 offen offset:0 lds
    v_mfma_f32_16x16x32_bf16 v[124:127], v[48:51], a[36:39], v[124:127]
    ds_read_b64_tr_b16 a[6:7], v12 offset:1024
    v_mfma_f32_16x16x32_bf16 v[128:131], v[52:55], a[36:39], v[128:131]
    v_mfma_f32_16x16x32_bf16 v[132:135], v[24:27], a[40:43], v[132:135]
    ds_read_b64_tr_b16 a[20:21], v12 offset:8192
    buffer_load_dwordx4 v2, s[36:39], s53 offen offset:1024 lds
    v_mfma_f32_16x16x32_bf16 v[136:139], v[28:31], a[40:43], v[136:139]
    v_mfma_f32_16x16x32_bf16 v[140:143], v[32:35], a[40:43], v[140:143]
    s_add_u32 s53, s53, s52
    v_mfma_f32_16x16x32_bf16 v[144:147], v[36:39], a[40:43], v[144:147]
    ds_read_b64_tr_b16 a[22:23], v12 offset:9216
    v_mfma_f32_16x16x32_bf16 v[148:151], v[40:43], a[40:43], v[148:151]
    s_mov_b32 s56, s55
    v_mfma_f32_16x16x32_bf16 v[152:155], v[44:47], a[40:43], v[152:155]
    ds_read_b64_tr_b16 a[8:9], v13 offset:0
    v_mfma_f32_16x16x32_bf16 v[156:159], v[48:51], a[40:43], v[156:159]
    s_add_u32 s55, s55, 16384
    v_mfma_f32_16x16x32_bf16 v[160:163], v[52:55], a[40:43], v[160:163]
    ds_read_b64_tr_b16 a[10:11], v13 offset:1024
    v_mfma_f32_16x16x32_bf16 a[116:119], v[24:27], a[112:115], a[116:119]
    v_mfma_f32_16x16x32_bf16 v[164:167], v[24:27], a[44:47], v[164:167]
    s_cmp_eq_u32 s55, 65536
    v_mfma_f32_16x16x32_bf16 v[168:171], v[28:31], a[44:47], v[168:171]
    ds_read_b64_tr_b16 a[24:25], v13 offset:8192
    v_mfma_f32_16x16x32_bf16 v[172:175], v[32:35], a[44:47], v[172:175]
    s_cselect_b32 s55, 0, s55
    v_mfma_f32_16x16x32_bf16 v[176:179], v[36:39], a[44:47], v[176:179]
    ds_read_b64_tr_b16 a[26:27], v13 offset:9216
    v_mfma_f32_16x16x32_bf16 v[180:183], v[40:43], a[44:47], v[180:183]
    s_add_u32 s72, s58, s60
    v_mfma_f32_16x16x32_bf16 v[184:187], v[44:47], a[44:47], v[184:187]
    ds_read_b64_tr_b16 a[12:13], v14 offset:0
    v_mfma_f32_16x16x32_bf16 v[188:191], v[48:51], a[44:47], v[188:191]
    v_mfma_f32_16x16x32_bf16 v[192:195], v[52:55], a[44:47], v[192:195]
    s_add_u32 m0, s72, 16384
    v_mfma_f32_16x16x32_bf16 a[120:123], v[28:31], a[112:115], a[120:123]
    ds_read_b64_tr_b16 a[14:15], v14 offset:1024
    v_mfma_f32_16x16x32_bf16 v[196:199], v[24:27], a[48:51], v[196:199]
    s_nop 0
    v_mfma_f32_16x16x32_bf16 v[200:203], v[28:31], a[48:51], v[200:203]
    ds_read_b64_tr_b16 a[28:29], v14 offset:8192
    v_mfma_f32_16x16x32_bf16 v[204:207], v[32:35], a[48:51], v[204:207]
    buffer_load_dwordx4 v3, s[28:31], s54 offen offset:0 lds
    v_mfma_f32_16x16x32_bf16 v[208:211], v[36:39], a[48:51], v[208:211]
    v_mfma_f32_16x16x32_bf16 v[212:215], v[40:43], a[48:51], v[212:215]
    ds_read_b64_tr_b16 a[30:31], v14 offset:9216
    buffer_load_dwordx4 v4, s[28:31], s54 offen offset:1024 lds
    v_mfma_f32_16x16x32_bf16 v[216:219], v[44:47], a[48:51], v[216:219]
    v_mfma_f32_16x16x32_bf16 v[220:223], v[48:51], a[48:51], v[220:223]
    ds_read_b128 a[68:71], v17 offset:2048
    v_mfma_f32_16x16x32_bf16 v[224:227], v[52:55], a[48:51], v[224:227]
    buffer_load_dwordx4 v5, s[28:31], s54 offen offset:2048 lds
    v_mfma_f32_16x16x32_bf16 a[124:127], v[32:35], a[112:115], a[124:127]
    ds_read_b128 a[72:75], v17 offset:4096
    v_mfma_f32_16x16x32_bf16 v[228:231], v[24:27], a[52:55], v[228:231]
    buffer_load_dwordx4 v6, s[28:31], s54 offen offset:3072 lds
    v_mfma_f32_16x16x32_bf16 v[232:235], v[28:31], a[52:55], v[232:235]
    v_mfma_f32_16x16x32_bf16 v[236:239], v[32:35], a[52:55], v[236:239]
    ds_read_b128 a[76:79], v17 offset:6144
    s_add_u32 s54, s54, -262016
    v_mfma_f32_16x16x32_bf16 v[240:243], v[36:39], a[52:55], v[240:243]
    v_mfma_f32_16x16x32_bf16 v[244:247], v[40:43], a[52:55], v[244:247]
    ds_read_b128 a[80:83], v17 offset:8192
    v_mfma_f32_16x16x32_bf16 v[248:251], v[44:47], a[52:55], v[248:251]
    s_mov_b32 s58, s57
    v_mfma_f32_16x16x32_bf16 a[132:135], v[48:51], a[52:55], a[132:135]
    ds_read_b128 a[84:87], v17 offset:10240
    v_mfma_f32_16x16x32_bf16 a[136:139], v[52:55], a[52:55], a[136:139]
    s_and_b32 s71, s54, 0x3ffff
    v_mfma_f32_16x16x32_bf16 a[128:131], v[36:39], a[112:115], a[128:131]
    v_mfma_f32_16x16x32_bf16 a[140:143], v[24:27], a[56:59], a[140:143]
    ds_read_b128 a[88:91], v17 offset:12288
    s_cmp_ge_u32 s71, 2048
    v_mfma_f32_16x16x32_bf16 a[144:147], v[28:31], a[56:59], a[144:147]
    v_mfma_f32_16x16x32_bf16 a[148:151], v[32:35], a[56:59], a[148:151]
    ds_read_b128 a[92:95], v17 offset:14336
    s_cselect_b32 s54, 0x40000000, s54
    v_mfma_f32_16x16x32_bf16 a[152:155], v[36:39], a[56:59], a[152:155]
    v_mfma_f32_16x16x32_bf16 a[156:159], v[40:43], a[56:59], a[156:159]
    v_mfma_f32_16x16x32_bf16 a[160:163], v[44:47], a[56:59], a[160:163]
    s_add_u32 s57, s57, 32768
    v_mfma_f32_16x16x32_bf16 a[164:167], v[48:51], a[56:59], a[164:167]
    v_mfma_f32_16x16x32_bf16 a[168:171], v[52:55], a[56:59], a[168:171]
    s_cmp_eq_u32 s57, 98304
    v_mfma_f32_16x16x32_bf16 a[172:175], v[24:27], a[60:63], a[172:175]
    v_mfma_f32_16x16x32_bf16 a[176:179], v[28:31], a[60:63], a[176:179]
    s_cselect_b32 s57, 0, s57
    v_add_u32_e64 v11, s55, v7
    v_mfma_f32_16x16x32_bf16 a[180:183], v[32:35], a[60:63], a[180:183]
    v_add_u32_e64 v12, s55, v8
    v_mfma_f32_16x16x32_bf16 a[184:187], v[36:39], a[60:63], a[184:187]
    v_add_u32_e64 v13, s55, v9
    v_mfma_f32_16x16x32_bf16 a[188:191], v[40:43], a[60:63], a[188:191]
    v_add_u32_e64 v14, s55, v10
    v_mfma_f32_16x16x32_bf16 a[192:195], v[44:47], a[60:63], a[192:195]
    v_add_u32_e64 v17, s57, v15
    v_mfma_f32_16x16x32_bf16 a[196:199], v[48:51], a[60:63], a[196:199]
    v_mfma_f32_16x16x32_bf16 a[200:203], v[52:55], a[60:63], a[200:203]
    s_waitcnt vmcnt(16) lgkmcnt(0)
    s_barrier
proj_kernel_ffn_mid0:
    v_mfma_f32_16x16x32_bf16 v[68:71], a[0:3], a[64:67], v[68:71]
    ds_read_b128 a[32:35], v17 offset:0
    s_add_u32 m0, s56, s59
    v_mfma_f32_16x16x32_bf16 v[72:75], a[4:7], a[64:67], v[72:75]
    v_mfma_f32_16x16x32_bf16 v[76:79], a[8:11], a[64:67], v[76:79]
    ds_read_b64_tr_b16 v[24:25], v11 offset:0
    v_mfma_f32_16x16x32_bf16 v[80:83], a[12:15], a[64:67], v[80:83]
    s_nop 0
    v_mfma_f32_16x16x32_bf16 v[84:87], a[16:19], a[64:67], v[84:87]
    ds_read_b64_tr_b16 v[26:27], v11 offset:1024
    v_mfma_f32_16x16x32_bf16 v[88:91], a[20:23], a[64:67], v[88:91]
    v_mfma_f32_16x16x32_bf16 v[92:95], a[24:27], a[64:67], v[92:95]
    buffer_load_dwordx4 v1, s[32:35], s53 offen offset:0 lds
    v_mfma_f32_16x16x32_bf16 v[96:99], a[28:31], a[64:67], v[96:99]
    ds_read_b64_tr_b16 v[40:41], v11 offset:8192
    v_mfma_f32_16x16x32_bf16 v[100:103], a[0:3], a[68:71], v[100:103]
    v_mfma_f32_16x16x32_bf16 v[104:107], a[4:7], a[68:71], v[104:107]
    ds_read_b64_tr_b16 v[42:43], v11 offset:9216
    buffer_load_dwordx4 v2, s[32:35], s53 offen offset:1024 lds
    v_mfma_f32_16x16x32_bf16 v[108:111], a[8:11], a[68:71], v[108:111]
    v_mfma_f32_16x16x32_bf16 v[112:115], a[12:15], a[68:71], v[112:115]
    ds_read_b64_tr_b16 v[28:29], v12 offset:0
    v_mfma_f32_16x16x32_bf16 v[116:119], a[16:19], a[68:71], v[116:119]
    s_add_u32 m0, m0, 8192
    v_mfma_f32_16x16x32_bf16 v[120:123], a[20:23], a[68:71], v[120:123]
    v_mfma_f32_16x16x32_bf16 v[124:127], a[24:27], a[68:71], v[124:127]
    ds_read_b64_tr_b16 v[30:31], v12 offset:1024
    v_mfma_f32_16x16x32_bf16 v[128:131], a[28:31], a[68:71], v[128:131]
    s_nop 0
    v_mfma_f32_16x16x32_bf16 v[132:135], a[0:3], a[72:75], v[132:135]
    ds_read_b64_tr_b16 v[44:45], v12 offset:8192
    v_mfma_f32_16x16x32_bf16 v[136:139], a[4:7], a[72:75], v[136:139]
    v_mfma_f32_16x16x32_bf16 v[140:143], a[8:11], a[72:75], v[140:143]
    buffer_load_dwordx4 v1, s[36:39], s53 offen offset:0 lds
    v_mfma_f32_16x16x32_bf16 v[144:147], a[12:15], a[72:75], v[144:147]
    ds_read_b64_tr_b16 v[46:47], v12 offset:9216
    v_mfma_f32_16x16x32_bf16 v[148:151], a[16:19], a[72:75], v[148:151]
    v_mfma_f32_16x16x32_bf16 v[152:155], a[20:23], a[72:75], v[152:155]
    ds_read_b64_tr_b16 v[32:33], v13 offset:0
    buffer_load_dwordx4 v2, s[36:39], s53 offen offset:1024 lds
    v_mfma_f32_16x16x32_bf16 v[156:159], a[24:27], a[72:75], v[156:159]
    v_mfma_f32_16x16x32_bf16 v[160:163], a[28:31], a[72:75], v[160:163]
    ds_read_b64_tr_b16 v[34:35], v13 offset:1024
    v_mfma_f32_16x16x32_bf16 a[116:119], a[0:3], a[112:115], a[116:119]
    s_add_u32 s53, s53, s52
    v_mfma_f32_16x16x32_bf16 v[164:167], a[0:3], a[76:79], v[164:167]
    v_mfma_f32_16x16x32_bf16 v[168:171], a[4:7], a[76:79], v[168:171]
    ds_read_b64_tr_b16 v[48:49], v13 offset:8192
    v_mfma_f32_16x16x32_bf16 v[172:175], a[8:11], a[76:79], v[172:175]
    s_mov_b32 s56, s55
    v_mfma_f32_16x16x32_bf16 v[176:179], a[12:15], a[76:79], v[176:179]
    ds_read_b64_tr_b16 v[50:51], v13 offset:9216
    v_mfma_f32_16x16x32_bf16 v[180:183], a[16:19], a[76:79], v[180:183]
    v_mfma_f32_16x16x32_bf16 v[184:187], a[20:23], a[76:79], v[184:187]
    ds_read_b64_tr_b16 v[36:37], v14 offset:0
    s_add_u32 s55, s55, 16384
    v_mfma_f32_16x16x32_bf16 v[188:191], a[24:27], a[76:79], v[188:191]
    v_mfma_f32_16x16x32_bf16 v[192:195], a[28:31], a[76:79], v[192:195]
    v_mfma_f32_16x16x32_bf16 a[120:123], a[4:7], a[112:115], a[120:123]
    ds_read_b64_tr_b16 v[38:39], v14 offset:1024
    s_cmp_eq_u32 s55, 65536
    v_mfma_f32_16x16x32_bf16 v[196:199], a[0:3], a[80:83], v[196:199]
    v_mfma_f32_16x16x32_bf16 v[200:203], a[4:7], a[80:83], v[200:203]
    ds_read_b64_tr_b16 v[52:53], v14 offset:8192
    v_mfma_f32_16x16x32_bf16 v[204:207], a[8:11], a[80:83], v[204:207]
    s_cselect_b32 s55, 0, s55
    v_mfma_f32_16x16x32_bf16 v[208:211], a[12:15], a[80:83], v[208:211]
    v_mfma_f32_16x16x32_bf16 v[212:215], a[16:19], a[80:83], v[212:215]
    ds_read_b64_tr_b16 v[54:55], v14 offset:9216
    v_mfma_f32_16x16x32_bf16 v[216:219], a[20:23], a[80:83], v[216:219]
    s_add_u32 s72, s58, s60
    v_mfma_f32_16x16x32_bf16 v[220:223], a[24:27], a[80:83], v[220:223]
    ds_read_b128 a[36:39], v17 offset:2048
    v_mfma_f32_16x16x32_bf16 v[224:227], a[28:31], a[80:83], v[224:227]
    v_mfma_f32_16x16x32_bf16 a[124:127], a[8:11], a[112:115], a[124:127]
    ds_read_b128 a[40:43], v17 offset:4096
    s_mov_b32 m0, s72
    v_mfma_f32_16x16x32_bf16 v[228:231], a[0:3], a[84:87], v[228:231]
    v_mfma_f32_16x16x32_bf16 v[232:235], a[4:7], a[84:87], v[232:235]
    v_mfma_f32_16x16x32_bf16 v[236:239], a[8:11], a[84:87], v[236:239]
    ds_read_b128 a[44:47], v17 offset:6144
    s_nop 0
    v_mfma_f32_16x16x32_bf16 v[240:243], a[12:15], a[84:87], v[240:243]
    v_mfma_f32_16x16x32_bf16 v[244:247], a[16:19], a[84:87], v[244:247]
    ds_read_b128 a[48:51], v17 offset:8192
    v_mfma_f32_16x16x32_bf16 v[248:251], a[20:23], a[84:87], v[248:251]
    buffer_load_dwordx4 v3, s[28:31], s54 offen offset:0 lds
    v_mfma_f32_16x16x32_bf16 a[132:135], a[24:27], a[84:87], a[132:135]
    ds_read_b128 a[52:55], v17 offset:10240
    v_mfma_f32_16x16x32_bf16 a[136:139], a[28:31], a[84:87], a[136:139]
    v_mfma_f32_16x16x32_bf16 a[128:131], a[12:15], a[112:115], a[128:131]
    buffer_load_dwordx4 v4, s[28:31], s54 offen offset:1024 lds
    v_mfma_f32_16x16x32_bf16 a[140:143], a[0:3], a[88:91], a[140:143]
    ds_read_b128 a[56:59], v17 offset:12288
    v_mfma_f32_16x16x32_bf16 a[144:147], a[4:7], a[88:91], a[144:147]
    v_mfma_f32_16x16x32_bf16 a[148:151], a[8:11], a[88:91], a[148:151]
    ds_read_b128 a[60:63], v17 offset:14336
    buffer_load_dwordx4 v5, s[28:31], s54 offen offset:2048 lds
    v_mfma_f32_16x16x32_bf16 a[152:155], a[12:15], a[88:91], a[152:155]
    v_mfma_f32_16x16x32_bf16 a[156:159], a[16:19], a[88:91], a[156:159]
    v_mfma_f32_16x16x32_bf16 a[160:163], a[20:23], a[88:91], a[160:163]
    buffer_load_dwordx4 v6, s[28:31], s54 offen offset:3072 lds
    v_mfma_f32_16x16x32_bf16 a[164:167], a[24:27], a[88:91], a[164:167]
    v_mfma_f32_16x16x32_bf16 a[168:171], a[28:31], a[88:91], a[168:171]
    v_mfma_f32_16x16x32_bf16 a[172:175], a[0:3], a[92:95], a[172:175]
    s_add_u32 s54, s54, 262144
    v_add_u32 v11, s55, v7
    v_mfma_f32_16x16x32_bf16 a[176:179], a[4:7], a[92:95], a[176:179]
    v_add_u32_e64 v12, s55, v8
    v_mfma_f32_16x16x32_bf16 a[180:183], a[8:11], a[92:95], a[180:183]
    v_add_u32_e64 v13, s55, v9
    v_mfma_f32_16x16x32_bf16 a[184:187], a[12:15], a[92:95], a[184:187]
    v_add_u32_e64 v14, s55, v10
    v_mfma_f32_16x16x32_bf16 a[188:191], a[16:19], a[92:95], a[188:191]
    v_add_u32_e64 v17, s57, v16
    v_mfma_f32_16x16x32_bf16 a[192:195], a[20:23], a[92:95], a[192:195]
    v_mfma_f32_16x16x32_bf16 a[196:199], a[24:27], a[92:95], a[196:199]
    v_mfma_f32_16x16x32_bf16 a[200:203], a[28:31], a[92:95], a[200:203]
    s_waitcnt vmcnt(16) lgkmcnt(0)
    s_barrier
proj_kernel_ffn_iend0:
    s_sub_u32 s61, s61, 1
    s_cmp_lg_u32 s61, 0
    s_cbranch_scc1 proj_kernel_ffn_loop0
    s_branch proj_kernel_ffn_epi
proj_kernel_ffn_first1:
    v_mfma_f32_16x16x32_bf16 v[68:71], v[24:27], a[32:35], 0
    ds_read_b128 a[64:67], v17 offset:0
    s_mov_b32 s56, 49152
    v_mfma_f32_16x16x32_bf16 v[72:75], v[28:31], a[32:35], 0
    s_mov_b32 s53, 688128
    v_mfma_f32_16x16x32_bf16 v[76:79], v[32:35], a[32:35], 0
    ds_read_b64_tr_b16 a[0:1], v11 offset:0
    s_add_u32 m0, s56, s59
    v_mfma_f32_16x16x32_bf16 v[80:83], v[36:39], a[32:35], 0
    s_nop 0
    v_mfma_f32_16x16x32_bf16 v[84:87], v[40:43], a[32:35], 0
    ds_read_b64_tr_b16 a[2:3], v11 offset:1024
    v_mfma_f32_16x16x32_bf16 v[88:91], v[44:47], a[32:35], 0
    buffer_load_dwordx4 v1, s[32:35], s53 offen offset:0 lds
    v_mfma_f32_16x16x32_bf16 v[92:95], v[48:51], a[32:35], 0
    buffer_load_dwordx4 v2, s[32:35], s53 offen offset:1024 lds
    v_mfma_f32_16x16x32_bf16 v[96:99], v[52:55], a[32:35], 0
    ds_read_b64_tr_b16 a[16:17], v11 offset:8192
    s_add_u32 m0, m0, 8192
    v_mfma_f32_16x16x32_bf16 v[100:103], v[24:27], a[36:39], 0
    s_nop 0
    v_mfma_f32_16x16x32_bf16 v[104:107], v[28:31], a[36:39], 0
    ds_read_b64_tr_b16 a[18:19], v11 offset:9216
    v_mfma_f32_16x16x32_bf16 v[108:111], v[32:35], a[36:39], 0
    buffer_load_dwordx4 v1, s[36:39], s53 offen offset:0 lds
    v_mfma_f32_16x16x32_bf16 v[112:115], v[36:39], a[36:39], 0
    ds_read_b64_tr_b16 a[4:5], v12 offset:0
    buffer_load_dwordx4 v2, s[36:39], s53 offen offset:1024 lds
    v_mfma_f32_16x16x32_bf16 v[116:119], v[40:43], a[36:39], 0
    s_mov_b32 s56, 0
    v_mfma_f32_16x16x32_bf16 v[120:123], v[44:47], a[36:39], 0
    v_mfma_f32_16x16x32_bf16 v[124:127], v[48:51], a[36:39], 0
    ds_read_b64_tr_b16 a[6:7], v12 offset:1024
    s_mov_b32 s53, 917504
    v_mfma_f32_16x16x32_bf16 v[128:131], v[52:55], a[36:39], 0
    s_mov_b32 s58, 65536
    v_mfma_f32_16x16x32_bf16 v[132:135], v[24:27], a[40:43], 0
    ds_read_b64_tr_b16 a[20:21], v12 offset:8192
    s_mov_b32 s54, 256
    v_mfma_f32_16x16x32_bf16 v[136:139], v[28:31], a[40:43], 0
    s_add_u32 s72, s58, s60
    v_mfma_f32_16x16x32_bf16 v[140:143], v[32:35], a[40:43], 0
    v_mfma_f32_16x16x32_bf16 v[144:147], v[36:39], a[40:43], 0
    ds_read_b64_tr_b16 a[22:23], v12 offset:9216
    s_mov_b32 m0, s72
    v_mfma_f32_16x16x32_bf16 v[148:151], v[40:43], a[40:43], 0
    s_nop 0
    v_mfma_f32_16x16x32_bf16 v[152:155], v[44:47], a[40:43], 0
    ds_read_b64_tr_b16 a[8:9], v13 offset:0
    buffer_load_dwordx4 v3, s[28:31], s54 offen offset:0 lds
    v_mfma_f32_16x16x32_bf16 v[156:159], v[48:51], a[40:43], 0
    v_mfma_f32_16x16x32_bf16 v[160:163], v[52:55], a[40:43], 0
    ds_read_b64_tr_b16 a[10:11], v13 offset:1024
    buffer_load_dwordx4 v4, s[28:31], s54 offen offset:1024 lds
    v_mfma_f32_16x16x32_bf16 a[116:119], v[40:43], a[112:115], 0
    buffer_load_dwordx4 v5, s[28:31], s54 offen offset:2048 lds
    v_mfma_f32_16x16x32_bf16 v[164:167], v[24:27], a[44:47], 0
    buffer_load_dwordx4 v6, s[28:31], s54 offen offset:3072 lds
    v_mfma_f32_16x16x32_bf16 v[168:171], v[28:31], a[44:47], 0
    ds_read_b64_tr_b16 a[24:25], v13 offset:8192
    s_mov_b32 s54, 262400
    v_mfma_f32_16x16x32_bf16 v[172:175], v[32:35], a[44:47], 0
    v_mfma_f32_16x16x32_bf16 v[176:179], v[36:39], a[44:47], 0
    ds_read_b64_tr_b16 a[26:27], v13 offset:9216
    s_add_u32 m0, s56, s59
    v_mfma_f32_16x16x32_bf16 v[180:183], v[40:43], a[44:47], 0
    s_nop 0
    v_mfma_f32_16x16x32_bf16 v[184:187], v[44:47], a[44:47], 0
    ds_read_b64_tr_b16 a[12:13], v14 offset:0
    buffer_load_dwordx4 v1, s[32:35], s53 offen offset:0 lds
    v_mfma_f32_16x16x32_bf16 v[188:191], v[48:51], a[44:47], 0
    v_mfma_f32_16x16x32_bf16 v[192:195], v[52:55], a[44:47], 0
    buffer_load_dwordx4 v2, s[32:35], s53 offen offset:1024 lds
    v_mfma_f32_16x16x32_bf16 a[120:123], v[44:47], a[112:115], 0
    ds_read_b64_tr_b16 a[14:15], v14 offset:1024
    s_add_u32 m0, m0, 8192
    v_mfma_f32_16x16x32_bf16 v[196:199], v[24:27], a[48:51], 0
    s_nop 0
    v_mfma_f32_16x16x32_bf16 v[200:203], v[28:31], a[48:51], 0
    ds_read_b64_tr_b16 a[28:29], v14 offset:8192
    buffer_load_dwordx4 v1, s[36:39], s53 offen offset:0 lds
    v_mfma_f32_16x16x32_bf16 v[204:207], v[32:35], a[48:51], 0
    v_mfma_f32_16x16x32_bf16 v[208:211], v[36:39], a[48:51], 0
    buffer_load_dwordx4 v2, s[36:39], s53 offen offset:1024 lds
    v_mfma_f32_16x16x32_bf16 v[212:215], v[40:43], a[48:51], 0
    ds_read_b64_tr_b16 a[30:31], v14 offset:9216
    s_add_u32 s53, s53, s52
    v_mfma_f32_16x16x32_bf16 v[216:219], v[44:47], a[48:51], 0
    s_mov_b32 s56, s55
    v_mfma_f32_16x16x32_bf16 v[220:223], v[48:51], a[48:51], 0
    ds_read_b128 a[68:71], v17 offset:2048
    s_add_u32 s55, s55, 16384
    v_mfma_f32_16x16x32_bf16 v[224:227], v[52:55], a[48:51], 0
    v_mfma_f32_16x16x32_bf16 a[124:127], v[48:51], a[112:115], 0
    ds_read_b128 a[72:75], v17 offset:4096
    s_cmp_eq_u32 s55, 65536
    v_mfma_f32_16x16x32_bf16 v[228:231], v[24:27], a[52:55], 0
    s_cselect_b32 s55, 0, s55
    v_mfma_f32_16x16x32_bf16 v[232:235], v[28:31], a[52:55], 0
    s_add_u32 s72, s58, s60
    v_mfma_f32_16x16x32_bf16 v[236:239], v[32:35], a[52:55], 0
    ds_read_b128 a[76:79], v17 offset:6144
    v_mfma_f32_16x16x32_bf16 v[240:243], v[36:39], a[52:55], 0
    s_add_u32 m0, s72, 16384
    v_mfma_f32_16x16x32_bf16 v[244:247], v[40:43], a[52:55], 0
    ds_read_b128 a[80:83], v17 offset:8192
    s_nop 0
    v_mfma_f32_16x16x32_bf16 v[248:251], v[44:47], a[52:55], 0
    buffer_load_dwordx4 v3, s[28:31], s54 offen offset:0 lds
    v_mfma_f32_16x16x32_bf16 a[132:135], v[48:51], a[52:55], 0
    ds_read_b128 a[84:87], v17 offset:10240
    buffer_load_dwordx4 v4, s[28:31], s54 offen offset:1024 lds
    v_mfma_f32_16x16x32_bf16 a[136:139], v[52:55], a[52:55], 0
    v_mfma_f32_16x16x32_bf16 a[128:131], v[52:55], a[112:115], 0
    buffer_load_dwordx4 v5, s[28:31], s54 offen offset:2048 lds
    v_mfma_f32_16x16x32_bf16 a[140:143], v[24:27], a[56:59], 0
    ds_read_b128 a[88:91], v17 offset:12288
    buffer_load_dwordx4 v6, s[28:31], s54 offen offset:3072 lds
    v_mfma_f32_16x16x32_bf16 a[144:147], v[28:31], a[56:59], 0
    s_add_u32 s54, s54, -262016
    v_mfma_f32_16x16x32_bf16 a[148:151], v[32:35], a[56:59], 0
    ds_read_b128 a[92:95], v17 offset:14336
    v_mfma_f32_16x16x32_bf16 a[152:155], v[36:39], a[56:59], 0
    s_mov_b32 s58, s57
    v_mfma_f32_16x16x32_bf16 a[156:159], v[40:43], a[56:59], 0
    s_and_b32 s71, s54, 0x3ffff
    v_mfma_f32_16x16x32_bf16 a[160:163], v[44:47], a[56:59], 0
    s_cmp_ge_u32 s71, 2048
    v_mfma_f32_16x16x32_bf16 a[164:167], v[48:51], a[56:59], 0
    s_cselect_b32 s54, 0x40000000, s54
    v_mfma_f32_16x16x32_bf16 a[168:171], v[52:55], a[56:59], 0
    v_mfma_f32_16x16x32_bf16 a[172:175], v[24:27], a[60:63], 0
    s_add_u32 s57, s57, 32768
    v_mfma_f32_16x16x32_bf16 a[176:179], v[28:31], a[60:63], 0
    s_cmp_eq_u32 s57, 98304
    v_mfma_f32_16x16x32_bf16 a[180:183], v[32:35], a[60:63], 0
    s_cselect_b32 s57, 0, s57
    v_add_u32_e64 v11, s55, v7
    v_mfma_f32_16x16x32_bf16 a[184:187], v[36:39], a[60:63], 0
    v_add_u32_e64 v12, s55, v8
    v_mfma_f32_16x16x32_bf16 a[188:191], v[40:43], a[60:63], 0
    v_add_u32_e64 v13, s55, v9
    v_mfma_f32_16x16x32_bf16 a[192:195], v[44:47], a[60:63], 0
    v_add_u32_e64 v14, s55, v10
    v_mfma_f32_16x16x32_bf16 a[196:199], v[48:51], a[60:63], 0
    v_add_u32_e64 v17, s57, v15
    v_mfma_f32_16x16x32_bf16 a[200:203], v[52:55], a[60:63], 0
    s_waitcnt vmcnt(17) lgkmcnt(0)
    s_barrier
    s_branch proj_kernel_ffn_mid1
proj_kernel_ffn_loop1:
    s_bitcmp1_b32 s62, s61
    s_cbranch_scc1 proj_kernel_ffn_event
proj_kernel_ffn_resume1:
    v_mfma_f32_16x16x32_bf16 v[68:71], v[24:27], a[32:35], v[68:71]
    ds_read_b128 a[64:67], v17 offset:0
    s_add_u32 m0, s56, s59
    v_mfma_f32_16x16x32_bf16 v[72:75], v[28:31], a[32:35], v[72:75]
    v_mfma_f32_16x16x32_bf16 v[76:79], v[32:35], a[32:35], v[76:79]
    ds_read_b64_tr_b16 a[0:1], v11 offset:0
    s_nop 0
    v_mfma_f32_16x16x32_bf16 v[80:83], v[36:39], a[32:35], v[80:83]
    v_mfma_f32_16x16x32_bf16 v[84:87], v[40:43], a[32:35], v[84:87]
    ds_read_b64_tr_b16 a[2:3], v11 offset:1024
    buffer_load_dwordx4 v1, s[32:35], s53 offen offset:0 lds
    v_mfma_f32_16x16x32_bf16 v[88:91], v[44:47], a[32:35], v[88:91]
    v_mfma_f32_16x16x32_bf16 v[92:95], v[48:51], a[32:35], v[92:95]
    buffer_load_dwordx4 v2, s[32:35], s53 offen offset:1024 lds
    v_mfma_f32_16x16x32_bf16 v[96:99], v[52:55], a[32:35], v[96:99]
    ds_read_b64_tr_b16 a[16:17], v11 offset:8192
    v_mfma_f32_16x16x32_bf16 v[100:103], v[24:27], a[36:39], v[100:103]
    v_mfma_f32_16x16x32_bf16 v[104:107], v[28:31], a[36:39], v[104:107]
    ds_read_b64_tr_b16 a[18:19], v11 offset:9216
    s_add_u32 m0, m0, 8192
    v_mfma_f32_16x16x32_bf16 v[108:111], v[32:35], a[36:39], v[108:111]
    v_mfma_f32_16x16x32_bf16 v[112:115], v[36:39], a[36:39], v[112:115]
    ds_read_b64_tr_b16 a[4:5], v12 offset:0
    s_nop 0
    v_mfma_f32_16x16x32_bf16 v[116:119], v[40:43], a[36:39], v[116:119]
    v_mfma_f32_16x16x32_bf16 v[120:123], v[44:47], a[36:39], v[120:123]
    buffer_load_dwordx4 v1, s[36:39], s53 offen offset:0 lds
    v_mfma_f32_16x16x32_bf16 v[124:127], v[48:51], a[36:39], v[124:127]
    ds_read_b64_tr_b16 a[6:7], v12 offset:1024
    v_mfma_f32_16x16x32_bf16 v[128:131], v[52:55], a[36:39], v[128:131]
    v_mfma_f32_16x16x32_bf16 v[132:135], v[24:27], a[40:43], v[132:135]
    ds_read_b64_tr_b16 a[20:21], v12 offset:8192
    buffer_load_dwordx4 v2, s[36:39], s53 offen offset:1024 lds
    v_mfma_f32_16x16x32_bf16 v[136:139], v[28:31], a[40:43], v[136:139]
    v_mfma_f32_16x16x32_bf16 v[140:143], v[32:35], a[40:43], v[140:143]
    s_add_u32 s53, s53, s52
    v_mfma_f32_16x16x32_bf16 v[144:147], v[36:39], a[40:43], v[144:147]
    ds_read_b64_tr_b16 a[22:23], v12 offset:9216
    v_mfma_f32_16x16x32_bf16 v[148:151], v[40:43], a[40:43], v[148:151]
    s_mov_b32 s56, s55
    v_mfma_f32_16x16x32_bf16 v[152:155], v[44:47], a[40:43], v[152:155]
    ds_read_b64_tr_b16 a[8:9], v13 offset:0
    v_mfma_f32_16x16x32_bf16 v[156:159], v[48:51], a[40:43], v[156:159]
    s_add_u32 s55, s55, 16384
    v_mfma_f32_16x16x32_bf16 v[160:163], v[52:55], a[40:43], v[160:163]
    ds_read_b64_tr_b16 a[10:11], v13 offset:1024
    v_mfma_f32_16x16x32_bf16 a[116:119], v[40:43], a[112:115], a[116:119]
    v_mfma_f32_16x16x32_bf16 v[164:167], v[24:27], a[44:47], v[164:167]
    s_cmp_eq_u32 s55, 65536
    v_mfma_f32_16x16x32_bf16 v[168:171], v[28:31], a[44:47], v[168:171]
    ds_read_b64_tr_b16 a[24:25], v13 offset:8192
    v_mfma_f32_16x16x32_bf16 v[172:175], v[32:35], a[44:47], v[172:175]
    s_cselect_b32 s55, 0, s55
    v_mfma_f32_16x16x32_bf16 v[176:179], v[36:39], a[44:47], v[176:179]
    ds_read_b64_tr_b16 a[26:27], v13 offset:9216
    v_mfma_f32_16x16x32_bf16 v[180:183], v[40:43], a[44:47], v[180:183]
    s_add_u32 s72, s58, s60
    v_mfma_f32_16x16x32_bf16 v[184:187], v[44:47], a[44:47], v[184:187]
    ds_read_b64_tr_b16 a[12:13], v14 offset:0
    v_mfma_f32_16x16x32_bf16 v[188:191], v[48:51], a[44:47], v[188:191]
    v_mfma_f32_16x16x32_bf16 v[192:195], v[52:55], a[44:47], v[192:195]
    s_add_u32 m0, s72, 16384
    v_mfma_f32_16x16x32_bf16 a[120:123], v[44:47], a[112:115], a[120:123]
    ds_read_b64_tr_b16 a[14:15], v14 offset:1024
    v_mfma_f32_16x16x32_bf16 v[196:199], v[24:27], a[48:51], v[196:199]
    s_nop 0
    v_mfma_f32_16x16x32_bf16 v[200:203], v[28:31], a[48:51], v[200:203]
    ds_read_b64_tr_b16 a[28:29], v14 offset:8192
    v_mfma_f32_16x16x32_bf16 v[204:207], v[32:35], a[48:51], v[204:207]
    buffer_load_dwordx4 v3, s[28:31], s54 offen offset:0 lds
    v_mfma_f32_16x16x32_bf16 v[208:211], v[36:39], a[48:51], v[208:211]
    v_mfma_f32_16x16x32_bf16 v[212:215], v[40:43], a[48:51], v[212:215]
    ds_read_b64_tr_b16 a[30:31], v14 offset:9216
    buffer_load_dwordx4 v4, s[28:31], s54 offen offset:1024 lds
    v_mfma_f32_16x16x32_bf16 v[216:219], v[44:47], a[48:51], v[216:219]
    v_mfma_f32_16x16x32_bf16 v[220:223], v[48:51], a[48:51], v[220:223]
    ds_read_b128 a[68:71], v17 offset:2048
    v_mfma_f32_16x16x32_bf16 v[224:227], v[52:55], a[48:51], v[224:227]
    buffer_load_dwordx4 v5, s[28:31], s54 offen offset:2048 lds
    v_mfma_f32_16x16x32_bf16 a[124:127], v[48:51], a[112:115], a[124:127]
    ds_read_b128 a[72:75], v17 offset:4096
    v_mfma_f32_16x16x32_bf16 v[228:231], v[24:27], a[52:55], v[228:231]
    buffer_load_dwordx4 v6, s[28:31], s54 offen offset:3072 lds
    v_mfma_f32_16x16x32_bf16 v[232:235], v[28:31], a[52:55], v[232:235]
    v_mfma_f32_16x16x32_bf16 v[236:239], v[32:35], a[52:55], v[236:239]
    ds_read_b128 a[76:79], v17 offset:6144
    s_add_u32 s54, s54, -262016
    v_mfma_f32_16x16x32_bf16 v[240:243], v[36:39], a[52:55], v[240:243]
    v_mfma_f32_16x16x32_bf16 v[244:247], v[40:43], a[52:55], v[244:247]
    ds_read_b128 a[80:83], v17 offset:8192
    v_mfma_f32_16x16x32_bf16 v[248:251], v[44:47], a[52:55], v[248:251]
    s_mov_b32 s58, s57
    v_mfma_f32_16x16x32_bf16 a[132:135], v[48:51], a[52:55], a[132:135]
    ds_read_b128 a[84:87], v17 offset:10240
    v_mfma_f32_16x16x32_bf16 a[136:139], v[52:55], a[52:55], a[136:139]
    s_and_b32 s71, s54, 0x3ffff
    v_mfma_f32_16x16x32_bf16 a[128:131], v[52:55], a[112:115], a[128:131]
    v_mfma_f32_16x16x32_bf16 a[140:143], v[24:27], a[56:59], a[140:143]
    ds_read_b128 a[88:91], v17 offset:12288
    s_cmp_ge_u32 s71, 2048
    v_mfma_f32_16x16x32_bf16 a[144:147], v[28:31], a[56:59], a[144:147]
    v_mfma_f32_16x16x32_bf16 a[148:151], v[32:35], a[56:59], a[148:151]
    ds_read_b128 a[92:95], v17 offset:14336
    s_cselect_b32 s54, 0x40000000, s54
    v_mfma_f32_16x16x32_bf16 a[152:155], v[36:39], a[56:59], a[152:155]
    v_mfma_f32_16x16x32_bf16 a[156:159], v[40:43], a[56:59], a[156:159]
    v_mfma_f32_16x16x32_bf16 a[160:163], v[44:47], a[56:59], a[160:163]
    s_add_u32 s57, s57, 32768
    v_mfma_f32_16x16x32_bf16 a[164:167], v[48:51], a[56:59], a[164:167]
    v_mfma_f32_16x16x32_bf16 a[168:171], v[52:55], a[56:59], a[168:171]
    s_cmp_eq_u32 s57, 98304
    v_mfma_f32_16x16x32_bf16 a[172:175], v[24:27], a[60:63], a[172:175]
    v_mfma_f32_16x16x32_bf16 a[176:179], v[28:31], a[60:63], a[176:179]
    s_cselect_b32 s57, 0, s57
    v_add_u32_e64 v11, s55, v7
    v_mfma_f32_16x16x32_bf16 a[180:183], v[32:35], a[60:63], a[180:183]
    v_add_u32_e64 v12, s55, v8
    v_mfma_f32_16x16x32_bf16 a[184:187], v[36:39], a[60:63], a[184:187]
    v_add_u32_e64 v13, s55, v9
    v_mfma_f32_16x16x32_bf16 a[188:191], v[40:43], a[60:63], a[188:191]
    v_add_u32_e64 v14, s55, v10
    v_mfma_f32_16x16x32_bf16 a[192:195], v[44:47], a[60:63], a[192:195]
    v_add_u32_e64 v17, s57, v15
    v_mfma_f32_16x16x32_bf16 a[196:199], v[48:51], a[60:63], a[196:199]
    v_mfma_f32_16x16x32_bf16 a[200:203], v[52:55], a[60:63], a[200:203]
    s_waitcnt vmcnt(16) lgkmcnt(0)
    s_barrier
proj_kernel_ffn_mid1:
    v_mfma_f32_16x16x32_bf16 v[68:71], a[0:3], a[64:67], v[68:71]
    ds_read_b128 a[32:35], v17 offset:0
    s_add_u32 m0, s56, s59
    v_mfma_f32_16x16x32_bf16 v[72:75], a[4:7], a[64:67], v[72:75]
    v_mfma_f32_16x16x32_bf16 v[76:79], a[8:11], a[64:67], v[76:79]
    ds_read_b64_tr_b16 v[24:25], v11 offset:0
    v_mfma_f32_16x16x32_bf16 v[80:83], a[12:15], a[64:67], v[80:83]
    s_nop 0
    v_mfma_f32_16x16x32_bf16 v[84:87], a[16:19], a[64:67], v[84:87]
    ds_read_b64_tr_b16 v[26:27], v11 offset:1024
    v_mfma_f32_16x16x32_bf16 v[88:91], a[20:23], a[64:67], v[88:91]
    v_mfma_f32_16x16x32_bf16 v[92:95], a[24:27], a[64:67], v[92:95]
    buffer_load_dwordx4 v1, s[32:35], s53 offen offset:0 lds
    v_mfma_f32_16x16x32_bf16 v[96:99], a[28:31], a[64:67], v[96:99]
    ds_read_b64_tr_b16 v[40:41], v11 offset:8192
    v_mfma_f32_16x16x32_bf16 v[100:103], a[0:3], a[68:71], v[100:103]
    v_mfma_f32_16x16x32_bf16 v[104:107], a[4:7], a[68:71], v[104:107]
    ds_read_b64_tr_b16 v[42:43], v11 offset:9216
    buffer_load_dwordx4 v2, s[32:35], s53 offen offset:1024 lds
    v_mfma_f32_16x16x32_bf16 v[108:111], a[8:11], a[68:71], v[108:111]
    v_mfma_f32_16x16x32_bf16 v[112:115], a[12:15], a[68:71], v[112:115]
    ds_read_b64_tr_b16 v[28:29], v12 offset:0
    v_mfma_f32_16x16x32_bf16 v[116:119], a[16:19], a[68:71], v[116:119]
    s_add_u32 m0, m0, 8192
    v_mfma_f32_16x16x32_bf16 v[120:123], a[20:23], a[68:71], v[120:123]
    v_mfma_f32_16x16x32_bf16 v[124:127], a[24:27], a[68:71], v[124:127]
    ds_read_b64_tr_b16 v[30:31], v12 offset:1024
    v_mfma_f32_16x16x32_bf16 v[128:131], a[28:31], a[68:71], v[128:131]
    s_nop 0
    v_mfma_f32_16x16x32_bf16 v[132:135], a[0:3], a[72:75], v[132:135]
    ds_read_b64_tr_b16 v[44:45], v12 offset:8192
    v_mfma_f32_16x16x32_bf16 v[136:139], a[4:7], a[72:75], v[136:139]
    v_mfma_f32_16x16x32_bf16 v[140:143], a[8:11], a[72:75], v[140:143]
    buffer_load_dwordx4 v1, s[36:39], s53 offen offset:0 lds
    v_mfma_f32_16x16x32_bf16 v[144:147], a[12:15], a[72:75], v[144:147]
    ds_read_b64_tr_b16 v[46:47], v12 offset:9216
    v_mfma_f32_16x16x32_bf16 v[148:151], a[16:19], a[72:75], v[148:151]
    v_mfma_f32_16x16x32_bf16 v[152:155], a[20:23], a[72:75], v[152:155]
    ds_read_b64_tr_b16 v[32:33], v13 offset:0
    buffer_load_dwordx4 v2, s[36:39], s53 offen offset:1024 lds
    v_mfma_f32_16x16x32_bf16 v[156:159], a[24:27], a[72:75], v[156:159]
    v_mfma_f32_16x16x32_bf16 v[160:163], a[28:31], a[72:75], v[160:163]
    ds_read_b64_tr_b16 v[34:35], v13 offset:1024
    v_mfma_f32_16x16x32_bf16 a[116:119], a[16:19], a[112:115], a[116:119]
    s_add_u32 s53, s53, s52
    v_mfma_f32_16x16x32_bf16 v[164:167], a[0:3], a[76:79], v[164:167]
    v_mfma_f32_16x16x32_bf16 v[168:171], a[4:7], a[76:79], v[168:171]
    ds_read_b64_tr_b16 v[48:49], v13 offset:8192
    v_mfma_f32_16x16x32_bf16 v[172:175], a[8:11], a[76:79], v[172:175]
    s_mov_b32 s56, s55
    v_mfma_f32_16x16x32_bf16 v[176:179], a[12:15], a[76:79], v[176:179]
    ds_read_b64_tr_b16 v[50:51], v13 offset:9216
    v_mfma_f32_16x16x32_bf16 v[180:183], a[16:19], a[76:79], v[180:183]
    v_mfma_f32_16x16x32_bf16 v[184:187], a[20:23], a[76:79], v[184:187]
    ds_read_b64_tr_b16 v[36:37], v14 offset:0
    s_add_u32 s55, s55, 16384
    v_mfma_f32_16x16x32_bf16 v[188:191], a[24:27], a[76:79], v[188:191]
    v_mfma_f32_16x16x32_bf16 v[192:195], a[28:31], a[76:79], v[192:195]
    v_mfma_f32_16x16x32_bf16 a[120:123], a[20:23], a[112:115], a[120:123]
    ds_read_b64_tr_b16 v[38:39], v14 offset:1024
    s_cmp_eq_u32 s55, 65536
    v_mfma_f32_16x16x32_bf16 v[196:199], a[0:3], a[80:83], v[196:199]
    v_mfma_f32_16x16x32_bf16 v[200:203], a[4:7], a[80:83], v[200:203]
    ds_read_b64_tr_b16 v[52:53], v14 offset:8192
    v_mfma_f32_16x16x32_bf16 v[204:207], a[8:11], a[80:83], v[204:207]
    s_cselect_b32 s55, 0, s55
    v_mfma_f32_16x16x32_bf16 v[208:211], a[12:15], a[80:83], v[208:211]
    v_mfma_f32_16x16x32_bf16 v[212:215], a[16:19], a[80:83], v[212:215]
    ds_read_b64_tr_b16 v[54:55], v14 offset:9216
    v_mfma_f32_16x16x32_bf16 v[216:219], a[20:23], a[80:83], v[216:219]
    s_add_u32 s72, s58, s60
    v_mfma_f32_16x16x32_bf16 v[220:223], a[24:27], a[80:83], v[220:223]
    ds_read_b128 a[36:39], v17 offset:2048
    v_mfma_f32_16x16x32_bf16 v[224:227], a[28:31], a[80:83], v[224:227]
    v_mfma_f32_16x16x32_bf16 a[124:127], a[24:27], a[112:115], a[124:127]
    ds_read_b128 a[40:43], v17 offset:4096
    s_mov_b32 m0, s72
    v_mfma_f32_16x16x32_bf16 v[228:231], a[0:3], a[84:87], v[228:231]
    v_mfma_f32_16x16x32_bf16 v[232:235], a[4:7], a[84:87], v[232:235]
    v_mfma_f32_16x16x32_bf16 v[236:239], a[8:11], a[84:87], v[236:239]
    ds_read_b128 a[44:47], v17 offset:6144
    s_nop 0
    v_mfma_f32_16x16x32_bf16 v[240:243], a[12:15], a[84:87], v[240:243]
    v_mfma_f32_16x16x32_bf16 v[244:247], a[16:19], a[84:87], v[244:247]
    ds_read_b128 a[48:51], v17 offset:8192
    v_mfma_f32_16x16x32_bf16 v[248:251], a[20:23], a[84:87], v[248:251]
    buffer_load_dwordx4 v3, s[28:31], s54 offen offset:0 lds
    v_mfma_f32_16x16x32_bf16 a[132:135], a[24:27], a[84:87], a[132:135]
    ds_read_b128 a[52:55], v17 offset:10240
    v_mfma_f32_16x16x32_bf16 a[136:139], a[28:31], a[84:87], a[136:139]
    v_mfma_f32_16x16x32_bf16 a[128:131], a[28:31], a[112:115], a[128:131]
    buffer_load_dwordx4 v4, s[28:31], s54 offen offset:1024 lds
    v_mfma_f32_16x16x32_bf16 a[140:143], a[0:3], a[88:91], a[140:143]
    ds_read_b128 a[56:59], v17 offset:12288
    v_mfma_f32_16x16x32_bf16 a[144:147], a[4:7], a[88:91], a[144:147]
    v_mfma_f32_16x16x32_bf16 a[148:151], a[8:11], a[88:91], a[148:151]
    ds_read_b128 a[60:63], v17 offset:14336
    buffer_load_dwordx4 v5, s[28:31], s54 offen offset:2048 lds
    v_mfma_f32_16x16x32_bf16 a[152:155], a[12:15], a[88:91], a[152:155]
    v_mfma_f32_16x16x32_bf16 a[156:159], a[16:19], a[88:91], a[156:159]
    v_mfma_f32_16x16x32_bf16 a[160:163], a[20:23], a[88:91], a[160:163]
    buffer_load_dwordx4 v6, s[28:31], s54 offen offset:3072 lds
    v_mfma_f32_16x16x32_bf16 a[164:167], a[24:27], a[88:91], a[164:167]
    v_mfma_f32_16x16x32_bf16 a[168:171], a[28:31], a[88:91], a[168:171]
    v_mfma_f32_16x16x32_bf16 a[172:175], a[0:3], a[92:95], a[172:175]
    s_add_u32 s54, s54, 262144
    v_add_u32 v11, s55, v7
    v_mfma_f32_16x16x32_bf16 a[176:179], a[4:7], a[92:95], a[176:179]
    v_add_u32_e64 v12, s55, v8
    v_mfma_f32_16x16x32_bf16 a[180:183], a[8:11], a[92:95], a[180:183]
    v_add_u32_e64 v13, s55, v9
    v_mfma_f32_16x16x32_bf16 a[184:187], a[12:15], a[92:95], a[184:187]
    v_add_u32_e64 v14, s55, v10
    v_mfma_f32_16x16x32_bf16 a[188:191], a[16:19], a[92:95], a[188:191]
    v_add_u32_e64 v17, s57, v16
    v_mfma_f32_16x16x32_bf16 a[192:195], a[20:23], a[92:95], a[192:195]
    v_mfma_f32_16x16x32_bf16 a[196:199], a[24:27], a[92:95], a[196:199]
    v_mfma_f32_16x16x32_bf16 a[200:203], a[28:31], a[92:95], a[200:203]
    s_waitcnt vmcnt(16) lgkmcnt(0)
    s_barrier
proj_kernel_ffn_iend1:
    s_sub_u32 s61, s61, 1
    s_cmp_lg_u32 s61, 0
    s_cbranch_scc1 proj_kernel_ffn_loop1
    s_branch proj_kernel_ffn_epi
proj_kernel_ffn_resume:
    s_cmp_eq_u32 s23, 0
    s_cbranch_scc1 proj_kernel_ffn_resume0
    s_branch proj_kernel_ffn_resume1
proj_kernel_ffn_event:
    s_cmp_eq_u32 s61, 15
    s_cbranch_scc0 proj_kernel_ffn_ev2
    s_lshl_b32 s71, s20, 5
    s_add_u32 s71, s71, s21
    v_mov_b32 v19, s71
    v_mov_b32_e64 v20, 1
    v_cmp_eq_u32 vcc, 0, v0
    s_and_saveexec_b64 s[4:5], vcc
    global_store_byte v19, v20, s[16:17] sc1
    s_mov_b64 exec, s[4:5]
    s_branch proj_kernel_ffn_resume
proj_kernel_ffn_ev2:
    v_and_b32 v19, 7, v0
    v_lshlrev_b32 v19, 2, v19
    s_lshl_b32 s71, s20, 5
    v_add_u32 v19, s71, v19
    s_cmp_eq_u32 s61, 3
    s_cbranch_scc0 proj_kernel_ffn_ev3
    global_load_dword v18, v19, s[16:17] offset:0 sc1
    s_getpc_b64 s[74:75]
proj_kernel_ffn_e_pfpc:
    s_add_u32 s74, s74, proj_kernel_ffn_epi-proj_kernel_ffn_e_pfpc
    s_addc_u32 s75, s75, 0
    v_lshlrev_b32_e64 v19, 7, v0
    v_min_u32 v20, proj_kernel_ffn_pfend-proj_kernel_ffn_epi-4, v19
    global_load_dword v64, v20, s[74:75]
    s_branch proj_kernel_ffn_resume
proj_kernel_ffn_ev3:
    s_mov_b32 s72, 0x40000
proj_kernel_ffn_ev3chk:
    v_cmp_eq_u32 vcc, 0x01010101, v18
    s_nop 3
    s_cmp_eq_u64 vcc, exec
    s_cbranch_scc1 proj_kernel_ffn_ev3ok
    s_sub_u32 s72, s72, 1
    s_cbranch_scc1 proj_kernel_ffn_ev3ok
    s_sleep 2
    global_load_dword v18, v19, s[16:17] offset:0 sc1
    s_waitcnt vmcnt(0)
    s_branch proj_kernel_ffn_ev3chk
proj_kernel_ffn_ev3ok:
    s_nop 0
    buffer_load_dwordx2 a[96:97], v66, s[48:51], 0 offen offset:0 sc0 sc1
    buffer_load_dwordx2 a[98:99], v66, s[48:51], 0 offen offset:128 sc0 sc1
    buffer_load_dwordx2 a[100:101], v66, s[48:51], 0 offen offset:256 sc0 sc1
    buffer_load_dwordx2 a[102:103], v66, s[48:51], 0 offen offset:384 sc0 sc1
    buffer_load_dwordx2 a[104:105], v66, s[48:51], 0 offen offset:512 sc0 sc1
    buffer_load_dwordx2 a[106:107], v66, s[48:51], 0 offen offset:640 sc0 sc1
    buffer_load_dwordx2 a[108:109], v66, s[48:51], 0 offen offset:768 sc0 sc1
    buffer_load_dwordx2 a[110:111], v66, s[48:51], 0 offen offset:896 sc0 sc1
    s_branch proj_kernel_ffn_resume
proj_kernel_ffn_epi:
    s_waitcnt vmcnt(0)
    s_barrier
    v_lshrrev_b32 v20, 4, v0
    v_lshlrev_b32 v20, 4, v20
    s_lshl_b32 s68, s24, 10
    v_add_u32 v20, s68, v20
    s_lshl_b32 s68, s23, 8
    v_add_u32_e64 v19, s68, v20
    ds_write_b128 v19, a[116:119] offset:0
    ds_write_b128 v19, a[120:123] offset:64
    ds_write_b128 v19, a[124:127] offset:128
    ds_write_b128 v19, a[128:131] offset:192
    s_waitcnt lgkmcnt(0)
    s_barrier
    ds_read_b128 v[24:27], v20 offset:0
    ds_read_b128 v[28:31], v20 offset:64
    ds_read_b128 v[32:35], v20 offset:128
    ds_read_b128 v[36:39], v20 offset:192
    ds_read_b128 v[40:43], v20 offset:256
    ds_read_b128 v[44:47], v20 offset:320
    ds_read_b128 v[48:51], v20 offset:384
    ds_read_b128 v[52:55], v20 offset:448
    s_mov_b32 s69, 0xbfb8aa3b
    s_waitcnt lgkmcnt(0)
    v_lshlrev_b32 v19, 4, v0
    v_accvgpr_read_b32 v56, a96
    v_accvgpr_read_b32 v57, a97
    v_rsq_f32 v59, v57
    s_nop 0
    v_mul_f32_e64 v58, s69, v59
    s_add_u32 s40, s18, 4194304
    s_addc_u32 s41, s19, 0
    s_mov_b32 s42, 18874368
    s_mov_b32 s43, 0x20000
    s_lshl_b32 s67, s20, 4
    s_lshl_b32 s68, s23, 3
    s_add_u32 s67, s67, s68
    s_mul_i32 s67, s67, 144
    s_lshl_b32 s68, s21, 2
    s_add_u32 s67, s67, s68
    s_lshl_b32 s68, s24, 1
    s_add_u32 s67, s67, s68
    s_lshl_b32 s67, s67, 10
    s_nop 0
    v_pk_fma_f32 v[68:69], v[24:25], v[56:57], v[68:69] op_sel:[0,0,0] op_sel_hi:[1,0,1]
    v_pk_fma_f32 v[72:73], v[28:29], v[56:57], v[72:73] op_sel:[0,0,0] op_sel_hi:[1,0,1]
    v_pk_fma_f32 v[70:71], v[26:27], v[56:57], v[70:71] op_sel:[0,0,0] op_sel_hi:[1,0,1]
    v_pk_fma_f32 v[74:75], v[30:31], v[56:57], v[74:75] op_sel:[0,0,0] op_sel_hi:[1,0,1]
    v_pk_fma_f32 v[84:85], v[40:41], v[56:57], v[84:85] op_sel:[0,0,0] op_sel_hi:[1,0,1]
    v_pk_fma_f32 v[88:89], v[44:45], v[56:57], v[88:89] op_sel:[0,0,0] op_sel_hi:[1,0,1]
    v_pk_fma_f32 v[86:87], v[42:43], v[56:57], v[86:87] op_sel:[0,0,0] op_sel_hi:[1,0,1]
    v_pk_fma_f32 v[90:91], v[46:47], v[56:57], v[90:91] op_sel:[0,0,0] op_sel_hi:[1,0,1]
    v_pk_mul_f32 v[10:11], v[68:69], v[58:59] op_sel:[0,0] op_sel_hi:[1,0]
    v_pk_mul_f32 v[14:15], v[72:73], v[58:59] op_sel:[0,0] op_sel_hi:[1,0]
    v_pk_mul_f32 v[12:13], v[70:71], v[58:59] op_sel:[0,0] op_sel_hi:[1,0]
    v_pk_mul_f32 v[16:17], v[74:75], v[58:59] op_sel:[0,0] op_sel_hi:[1,0]
    v_exp_f32 v10, v10
    v_exp_f32 v14, v14
    v_exp_f32 v11, v11
    v_exp_f32 v15, v15
    v_exp_f32 v12, v12
    v_exp_f32 v16, v16
    v_exp_f32 v13, v13
    v_exp_f32 v17, v17
    v_pk_mul_f32 v[84:85], v[68:69], v[84:85] op_sel:[0,0] op_sel_hi:[1,1]
    v_pk_mul_f32 v[88:89], v[72:73], v[88:89] op_sel:[0,0] op_sel_hi:[1,1]
    v_pk_mul_f32 v[86:87], v[70:71], v[86:87] op_sel:[0,0] op_sel_hi:[1,1]
    v_pk_mul_f32 v[90:91], v[74:75], v[90:91] op_sel:[0,0] op_sel_hi:[1,1]
    v_pk_fma_f32 v[10:11], v[10:11], v[56:57], v[56:57] op_sel:[0,1,1] op_sel_hi:[1,1,1]
    v_pk_fma_f32 v[14:15], v[14:15], v[56:57], v[56:57] op_sel:[0,1,1] op_sel_hi:[1,1,1]
    v_pk_fma_f32 v[12:13], v[12:13], v[56:57], v[56:57] op_sel:[0,1,1] op_sel_hi:[1,1,1]
    v_pk_fma_f32 v[16:17], v[16:17], v[56:57], v[56:57] op_sel:[0,1,1] op_sel_hi:[1,1,1]
    v_rcp_f32 v10, v10
    v_rcp_f32 v14, v14
    v_rcp_f32 v11, v11
    v_rcp_f32 v15, v15
    v_rcp_f32 v12, v12
    v_rcp_f32 v16, v16
    v_rcp_f32 v13, v13
    v_rcp_f32 v17, v17
    v_pk_mul_f32 v[84:85], v[84:85], v[10:11] op_sel:[0,0] op_sel_hi:[1,1]
    v_pk_mul_f32 v[88:89], v[88:89], v[14:15] op_sel:[0,0] op_sel_hi:[1,1]
    v_pk_mul_f32 v[86:87], v[86:87], v[12:13] op_sel:[0,0] op_sel_hi:[1,1]
    v_pk_mul_f32 v[90:91], v[90:91], v[16:17] op_sel:[0,0] op_sel_hi:[1,1]
    v_cvt_pk_bf16_f32 v2, v84, v85
    v_cvt_pk_bf16_f32 v4, v88, v89
    v_cvt_pk_bf16_f32 v3, v86, v87
    v_cvt_pk_bf16_f32 v5, v90, v91
    s_add_u32 s70, s67, 0
    s_nop 0
    buffer_store_dwordx4 v[2:5], v19, s[40:43], s70 offen sc1
    v_pk_fma_f32 v[76:77], v[32:33], v[56:57], v[76:77] op_sel:[0,0,0] op_sel_hi:[1,0,1]
    v_pk_fma_f32 v[80:81], v[36:37], v[56:57], v[80:81] op_sel:[0,0,0] op_sel_hi:[1,0,1]
    v_accvgpr_read_b32 v60, a98
    v_pk_fma_f32 v[78:79], v[34:35], v[56:57], v[78:79] op_sel:[0,0,0] op_sel_hi:[1,0,1]
    v_pk_fma_f32 v[82:83], v[38:39], v[56:57], v[82:83] op_sel:[0,0,0] op_sel_hi:[1,0,1]
    v_accvgpr_read_b32 v61, a99
    v_pk_fma_f32 v[92:93], v[48:49], v[56:57], v[92:93] op_sel:[0,0,0] op_sel_hi:[1,0,1]
    v_pk_fma_f32 v[96:97], v[52:53], v[56:57], v[96:97] op_sel:[0,0,0] op_sel_hi:[1,0,1]
    v_rsq_f32_e64 v63, v61
    v_pk_fma_f32 v[94:95], v[50:51], v[56:57], v[94:95] op_sel:[0,0,0] op_sel_hi:[1,0,1]
    v_pk_fma_f32 v[98:99], v[54:55], v[56:57], v[98:99] op_sel:[0,0,0] op_sel_hi:[1,0,1]
    s_nop 0
    v_pk_mul_f32 v[10:11], v[76:77], v[58:59] op_sel:[0,0] op_sel_hi:[1,0]
    v_pk_mul_f32 v[14:15], v[80:81], v[58:59] op_sel:[0,0] op_sel_hi:[1,0]
    v_mul_f32 v62, s69, v63
    v_pk_mul_f32 v[12:13], v[78:79], v[58:59] op_sel:[0,0] op_sel_hi:[1,0]
    v_pk_mul_f32 v[16:17], v[82:83], v[58:59] op_sel:[0,0] op_sel_hi:[1,0]
    v_exp_f32 v10, v10
    v_exp_f32 v14, v14
    v_exp_f32 v11, v11
    v_exp_f32 v15, v15
    v_exp_f32 v12, v12
    v_exp_f32 v16, v16
    v_exp_f32 v13, v13
    v_exp_f32 v17, v17
    v_pk_mul_f32 v[92:93], v[76:77], v[92:93] op_sel:[0,0] op_sel_hi:[1,1]
    v_pk_mul_f32 v[96:97], v[80:81], v[96:97] op_sel:[0,0] op_sel_hi:[1,1]
    v_pk_mul_f32 v[94:95], v[78:79], v[94:95] op_sel:[0,0] op_sel_hi:[1,1]
    v_pk_mul_f32 v[98:99], v[82:83], v[98:99] op_sel:[0,0] op_sel_hi:[1,1]
    v_pk_fma_f32 v[10:11], v[10:11], v[56:57], v[56:57] op_sel:[0,1,1] op_sel_hi:[1,1,1]
    v_pk_fma_f32 v[14:15], v[14:15], v[56:57], v[56:57] op_sel:[0,1,1] op_sel_hi:[1,1,1]
    v_pk_fma_f32 v[12:13], v[12:13], v[56:57], v[56:57] op_sel:[0,1,1] op_sel_hi:[1,1,1]
    v_pk_fma_f32 v[16:17], v[16:17], v[56:57], v[56:57] op_sel:[0,1,1] op_sel_hi:[1,1,1]
    v_rcp_f32 v10, v10
    v_rcp_f32 v14, v14
    v_rcp_f32 v11, v11
    v_rcp_f32 v15, v15
    v_rcp_f32 v12, v12
    v_rcp_f32 v16, v16
    v_rcp_f32 v13, v13
    v_rcp_f32 v17, v17
    v_pk_mul_f32 v[92:93], v[92:93], v[10:11] op_sel:[0,0] op_sel_hi:[1,1]
    v_pk_mul_f32 v[96:97], v[96:97], v[14:15] op_sel:[0,0] op_sel_hi:[1,1]
    v_pk_mul_f32 v[94:95], v[94:95], v[12:13] op_sel:[0,0] op_sel_hi:[1,1]
    v_pk_mul_f32 v[98:99], v[98:99], v[16:17] op_sel:[0,0] op_sel_hi:[1,1]
    v_cvt_pk_bf16_f32 v6, v92, v93
    v_cvt_pk_bf16_f32 v8, v96, v97
    v_cvt_pk_bf16_f32 v7, v94, v95
    v_cvt_pk_bf16_f32 v9, v98, v99
    s_add_u32 s70, s67, 1024
    buffer_store_dwordx4 v[6:9], v19, s[40:43], s70 offen sc1
    v_pk_fma_f32 v[100:101], v[24:25], v[60:61], v[100:101] op_sel:[0,0,0] op_sel_hi:[1,0,1]
    v_pk_fma_f32 v[104:105], v[28:29], v[60:61], v[104:105] op_sel:[0,0,0] op_sel_hi:[1,0,1]
    v_pk_fma_f32 v[102:103], v[26:27], v[60:61], v[102:103] op_sel:[0,0,0] op_sel_hi:[1,0,1]
    v_pk_fma_f32 v[106:107], v[30:31], v[60:61], v[106:107] op_sel:[0,0,0] op_sel_hi:[1,0,1]
    v_pk_fma_f32 v[116:117], v[40:41], v[60:61], v[116:117] op_sel:[0,0,0] op_sel_hi:[1,0,1]
    v_pk_fma_f32 v[120:121], v[44:45], v[60:61], v[120:121] op_sel:[0,0,0] op_sel_hi:[1,0,1]
    v_pk_fma_f32 v[118:119], v[42:43], v[60:61], v[118:119] op_sel:[0,0,0] op_sel_hi:[1,0,1]
    v_pk_fma_f32 v[122:123], v[46:47], v[60:61], v[122:123] op_sel:[0,0,0] op_sel_hi:[1,0,1]
    v_pk_mul_f32 v[10:11], v[100:101], v[62:63] op_sel:[0,0] op_sel_hi:[1,0]
    v_pk_mul_f32 v[14:15], v[104:105], v[62:63] op_sel:[0,0] op_sel_hi:[1,0]
    v_pk_mul_f32 v[12:13], v[102:103], v[62:63] op_sel:[0,0] op_sel_hi:[1,0]
    v_pk_mul_f32 v[16:17], v[106:107], v[62:63] op_sel:[0,0] op_sel_hi:[1,0]
    v_exp_f32 v10, v10
    v_exp_f32 v14, v14
    v_exp_f32 v11, v11
    v_exp_f32 v15, v15
    v_exp_f32 v12, v12
    v_exp_f32 v16, v16
    v_exp_f32 v13, v13
    v_exp_f32 v17, v17
    v_pk_mul_f32 v[116:117], v[100:101], v[116:117] op_sel:[0,0] op_sel_hi:[1,1]
    v_pk_mul_f32 v[120:121], v[104:105], v[120:121] op_sel:[0,0] op_sel_hi:[1,1]
    v_pk_mul_f32 v[118:119], v[102:103], v[118:119] op_sel:[0,0] op_sel_hi:[1,1]
    v_pk_mul_f32 v[122:123], v[106:107], v[122:123] op_sel:[0,0] op_sel_hi:[1,1]
    v_pk_fma_f32 v[10:11], v[10:11], v[60:61], v[60:61] op_sel:[0,1,1] op_sel_hi:[1,1,1]
    v_pk_fma_f32 v[14:15], v[14:15], v[60:61], v[60:61] op_sel:[0,1,1] op_sel_hi:[1,1,1]
    v_pk_fma_f32 v[12:13], v[12:13], v[60:61], v[60:61] op_sel:[0,1,1] op_sel_hi:[1,1,1]
    v_pk_fma_f32 v[16:17], v[16:17], v[60:61], v[60:61] op_sel:[0,1,1] op_sel_hi:[1,1,1]
    v_rcp_f32 v10, v10
    v_rcp_f32 v14, v14
    v_rcp_f32 v11, v11
    v_rcp_f32 v15, v15
    v_rcp_f32 v12, v12
    v_rcp_f32 v16, v16
    v_rcp_f32 v13, v13
    v_rcp_f32 v17, v17
    v_pk_mul_f32 v[116:117], v[116:117], v[10:11] op_sel:[0,0] op_sel_hi:[1,1]
    v_pk_mul_f32 v[120:121], v[120:121], v[14:15] op_sel:[0,0] op_sel_hi:[1,1]
    v_pk_mul_f32 v[118:119], v[118:119], v[12:13] op_sel:[0,0] op_sel_hi:[1,1]
    v_pk_mul_f32 v[122:123], v[122:123], v[16:17] op_sel:[0,0] op_sel_hi:[1,1]
    v_cvt_pk_bf16_f32 v2, v116, v117
    v_cvt_pk_bf16_f32 v4, v120, v121
    v_cvt_pk_bf16_f32 v3, v118, v119
    v_cvt_pk_bf16_f32 v5, v122, v123
    s_add_u32 s70, s67, 147456
    buffer_store_dwordx4 v[2:5], v19, s[40:43], s70 offen sc1
    v_pk_fma_f32 v[108:109], v[32:33], v[60:61], v[108:109] op_sel:[0,0,0] op_sel_hi:[1,0,1]
    v_pk_fma_f32 v[112:113], v[36:37], v[60:61], v[112:113] op_sel:[0,0,0] op_sel_hi:[1,0,1]
    v_accvgpr_read_b32 v56, a100
    v_pk_fma_f32 v[110:111], v[34:35], v[60:61], v[110:111] op_sel:[0,0,0] op_sel_hi:[1,0,1]
    v_pk_fma_f32 v[114:115], v[38:39], v[60:61], v[114:115] op_sel:[0,0,0] op_sel_hi:[1,0,1]
    v_accvgpr_read_b32 v57, a101
    v_pk_fma_f32 v[124:125], v[48:49], v[60:61], v[124:125] op_sel:[0,0,0] op_sel_hi:[1,0,1]
    v_pk_fma_f32 v[128:129], v[52:53], v[60:61], v[128:129] op_sel:[0,0,0] op_sel_hi:[1,0,1]
    v_rsq_f32_e64 v59, v57
    v_pk_fma_f32 v[126:127], v[50:51], v[60:61], v[126:127] op_sel:[0,0,0] op_sel_hi:[1,0,1]
    v_pk_fma_f32 v[130:131], v[54:55], v[60:61], v[130:131] op_sel:[0,0,0] op_sel_hi:[1,0,1]
    s_nop 0
    v_pk_mul_f32 v[10:11], v[108:109], v[62:63] op_sel:[0,0] op_sel_hi:[1,0]
    v_pk_mul_f32 v[14:15], v[112:113], v[62:63] op_sel:[0,0] op_sel_hi:[1,0]
    v_mul_f32 v58, s69, v59
    v_pk_mul_f32 v[12:13], v[110:111], v[62:63] op_sel:[0,0] op_sel_hi:[1,0]
    v_pk_mul_f32 v[16:17], v[114:115], v[62:63] op_sel:[0,0] op_sel_hi:[1,0]
    v_exp_f32 v10, v10
    v_exp_f32 v14, v14
    v_exp_f32 v11, v11
    v_exp_f32 v15, v15
    v_exp_f32 v12, v12
    v_exp_f32 v16, v16
    v_exp_f32 v13, v13
    v_exp_f32 v17, v17
    v_pk_mul_f32 v[124:125], v[108:109], v[124:125] op_sel:[0,0] op_sel_hi:[1,1]
    v_pk_mul_f32 v[128:129], v[112:113], v[128:129] op_sel:[0,0] op_sel_hi:[1,1]
    v_pk_mul_f32 v[126:127], v[110:111], v[126:127] op_sel:[0,0] op_sel_hi:[1,1]
    v_pk_mul_f32 v[130:131], v[114:115], v[130:131] op_sel:[0,0] op_sel_hi:[1,1]
    v_pk_fma_f32 v[10:11], v[10:11], v[60:61], v[60:61] op_sel:[0,1,1] op_sel_hi:[1,1,1]
    v_pk_fma_f32 v[14:15], v[14:15], v[60:61], v[60:61] op_sel:[0,1,1] op_sel_hi:[1,1,1]
    v_pk_fma_f32 v[12:13], v[12:13], v[60:61], v[60:61] op_sel:[0,1,1] op_sel_hi:[1,1,1]
    v_pk_fma_f32 v[16:17], v[16:17], v[60:61], v[60:61] op_sel:[0,1,1] op_sel_hi:[1,1,1]
    v_rcp_f32 v10, v10
    v_rcp_f32 v14, v14
    v_rcp_f32 v11, v11
    v_rcp_f32 v15, v15
    v_rcp_f32 v12, v12
    v_rcp_f32 v16, v16
    v_rcp_f32 v13, v13
    v_rcp_f32 v17, v17
    v_pk_mul_f32 v[124:125], v[124:125], v[10:11] op_sel:[0,0] op_sel_hi:[1,1]
    v_pk_mul_f32 v[128:129], v[128:129], v[14:15] op_sel:[0,0] op_sel_hi:[1,1]
    v_pk_mul_f32 v[126:127], v[126:127], v[12:13] op_sel:[0,0] op_sel_hi:[1,1]
    v_pk_mul_f32 v[130:131], v[130:131], v[16:17] op_sel:[0,0] op_sel_hi:[1,1]
    v_cvt_pk_bf16_f32 v6, v124, v125
    v_cvt_pk_bf16_f32 v8, v128, v129
    v_cvt_pk_bf16_f32 v7, v126, v127
    v_cvt_pk_bf16_f32 v9, v130, v131
    s_add_u32 s70, s67, 148480
    buffer_store_dwordx4 v[6:9], v19, s[40:43], s70 offen sc1
    v_pk_fma_f32 v[132:133], v[24:25], v[56:57], v[132:133] op_sel:[0,0,0] op_sel_hi:[1,0,1]
    v_pk_fma_f32 v[136:137], v[28:29], v[56:57], v[136:137] op_sel:[0,0,0] op_sel_hi:[1,0,1]
    v_pk_fma_f32 v[134:135], v[26:27], v[56:57], v[134:135] op_sel:[0,0,0] op_sel_hi:[1,0,1]
    v_pk_fma_f32 v[138:139], v[30:31], v[56:57], v[138:139] op_sel:[0,0,0] op_sel_hi:[1,0,1]
    v_pk_fma_f32 v[148:149], v[40:41], v[56:57], v[148:149] op_sel:[0,0,0] op_sel_hi:[1,0,1]
    v_pk_fma_f32 v[152:153], v[44:45], v[56:57], v[152:153] op_sel:[0,0,0] op_sel_hi:[1,0,1]
    v_pk_fma_f32 v[150:151], v[42:43], v[56:57], v[150:151] op_sel:[0,0,0] op_sel_hi:[1,0,1]
    v_pk_fma_f32 v[154:155], v[46:47], v[56:57], v[154:155] op_sel:[0,0,0] op_sel_hi:[1,0,1]
    v_pk_mul_f32 v[10:11], v[132:133], v[58:59] op_sel:[0,0] op_sel_hi:[1,0]
    v_pk_mul_f32 v[14:15], v[136:137], v[58:59] op_sel:[0,0] op_sel_hi:[1,0]
    v_pk_mul_f32 v[12:13], v[134:135], v[58:59] op_sel:[0,0] op_sel_hi:[1,0]
    v_pk_mul_f32 v[16:17], v[138:139], v[58:59] op_sel:[0,0] op_sel_hi:[1,0]
    v_exp_f32 v10, v10
    v_exp_f32 v14, v14
    v_exp_f32 v11, v11
    v_exp_f32 v15, v15
    v_exp_f32 v12, v12
    v_exp_f32 v16, v16
    v_exp_f32 v13, v13
    v_exp_f32 v17, v17
    v_pk_mul_f32 v[148:149], v[132:133], v[148:149] op_sel:[0,0] op_sel_hi:[1,1]
    v_pk_mul_f32 v[152:153], v[136:137], v[152:153] op_sel:[0,0] op_sel_hi:[1,1]
    v_pk_mul_f32 v[150:151], v[134:135], v[150:151] op_sel:[0,0] op_sel_hi:[1,1]
    v_pk_mul_f32 v[154:155], v[138:139], v[154:155] op_sel:[0,0] op_sel_hi:[1,1]
    v_pk_fma_f32 v[10:11], v[10:11], v[56:57], v[56:57] op_sel:[0,1,1] op_sel_hi:[1,1,1]
    v_pk_fma_f32 v[14:15], v[14:15], v[56:57], v[56:57] op_sel:[0,1,1] op_sel_hi:[1,1,1]
    v_pk_fma_f32 v[12:13], v[12:13], v[56:57], v[56:57] op_sel:[0,1,1] op_sel_hi:[1,1,1]
    v_pk_fma_f32 v[16:17], v[16:17], v[56:57], v[56:57] op_sel:[0,1,1] op_sel_hi:[1,1,1]
    v_rcp_f32 v10, v10
    v_rcp_f32 v14, v14
    v_rcp_f32 v11, v11
    v_rcp_f32 v15, v15
    v_rcp_f32 v12, v12
    v_rcp_f32 v16, v16
    v_rcp_f32 v13, v13
    v_rcp_f32 v17, v17
    v_pk_mul_f32 v[148:149], v[148:149], v[10:11] op_sel:[0,0] op_sel_hi:[1,1]
    v_pk_mul_f32 v[152:153], v[152:153], v[14:15] op_sel:[0,0] op_sel_hi:[1,1]
    v_pk_mul_f32 v[150:151], v[150:151], v[12:13] op_sel:[0,0] op_sel_hi:[1,1]
    v_pk_mul_f32 v[154:155], v[154:155], v[16:17] op_sel:[0,0] op_sel_hi:[1,1]
    v_cvt_pk_bf16_f32 v2, v148, v149
    v_cvt_pk_bf16_f32 v4, v152, v153
    v_cvt_pk_bf16_f32 v3, v150, v151
    v_cvt_pk_bf16_f32 v5, v154, v155
    s_add_u32 s70, s67, 294912
    buffer_store_dwordx4 v[2:5], v19, s[40:43], s70 offen sc1
    v_pk_fma_f32 v[140:141], v[32:33], v[56:57], v[140:141] op_sel:[0,0,0] op_sel_hi:[1,0,1]
    v_pk_fma_f32 v[144:145], v[36:37], v[56:57], v[144:145] op_sel:[0,0,0] op_sel_hi:[1,0,1]
    v_accvgpr_read_b32 v60, a102
    v_pk_fma_f32 v[142:143], v[34:35], v[56:57], v[142:143] op_sel:[0,0,0] op_sel_hi:[1,0,1]
    v_pk_fma_f32 v[146:147], v[38:39], v[56:57], v[146:147] op_sel:[0,0,0] op_sel_hi:[1,0,1]
    v_accvgpr_read_b32 v61, a103
    v_pk_fma_f32 v[156:157], v[48:49], v[56:57], v[156:157] op_sel:[0,0,0] op_sel_hi:[1,0,1]
    v_pk_fma_f32 v[160:161], v[52:53], v[56:57], v[160:161] op_sel:[0,0,0] op_sel_hi:[1,0,1]
    v_rsq_f32_e64 v63, v61
    v_pk_fma_f32 v[158:159], v[50:51], v[56:57], v[158:159] op_sel:[0,0,0] op_sel_hi:[1,0,1]
    v_pk_fma_f32 v[162:163], v[54:55], v[56:57], v[162:163] op_sel:[0,0,0] op_sel_hi:[1,0,1]
    s_nop 0
    v_pk_mul_f32 v[10:11], v[140:141], v[58:59] op_sel:[0,0] op_sel_hi:[1,0]
    v_pk_mul_f32 v[14:15], v[144:145], v[58:59] op_sel:[0,0] op_sel_hi:[1,0]
    v_mul_f32 v62, s69, v63
    v_pk_mul_f32 v[12:13], v[142:143], v[58:59] op_sel:[0,0] op_sel_hi:[1,0]
    v_pk_mul_f32 v[16:17], v[146:147], v[58:59] op_sel:[0,0] op_sel_hi:[1,0]
    v_exp_f32 v10, v10
    v_exp_f32 v14, v14
    v_exp_f32 v11, v11
    v_exp_f32 v15, v15
    v_exp_f32 v12, v12
    v_exp_f32 v16, v16
    v_exp_f32 v13, v13
    v_exp_f32 v17, v17
    v_pk_mul_f32 v[156:157], v[140:141], v[156:157] op_sel:[0,0] op_sel_hi:[1,1]
    v_pk_mul_f32 v[160:161], v[144:145], v[160:161] op_sel:[0,0] op_sel_hi:[1,1]
    v_pk_mul_f32 v[158:159], v[142:143], v[158:159] op_sel:[0,0] op_sel_hi:[1,1]
    v_pk_mul_f32 v[162:163], v[146:147], v[162:163] op_sel:[0,0] op_sel_hi:[1,1]
    v_pk_fma_f32 v[10:11], v[10:11], v[56:57], v[56:57] op_sel:[0,1,1] op_sel_hi:[1,1,1]
    v_pk_fma_f32 v[14:15], v[14:15], v[56:57], v[56:57] op_sel:[0,1,1] op_sel_hi:[1,1,1]
    v_pk_fma_f32 v[12:13], v[12:13], v[56:57], v[56:57] op_sel:[0,1,1] op_sel_hi:[1,1,1]
    v_pk_fma_f32 v[16:17], v[16:17], v[56:57], v[56:57] op_sel:[0,1,1] op_sel_hi:[1,1,1]
    v_rcp_f32 v10, v10
    v_rcp_f32 v14, v14
    v_rcp_f32 v11, v11
    v_rcp_f32 v15, v15
    v_rcp_f32 v12, v12
    v_rcp_f32 v16, v16
    v_rcp_f32 v13, v13
    v_rcp_f32 v17, v17
    v_pk_mul_f32 v[156:157], v[156:157], v[10:11] op_sel:[0,0] op_sel_hi:[1,1]
    v_pk_mul_f32 v[160:161], v[160:161], v[14:15] op_sel:[0,0] op_sel_hi:[1,1]
    v_pk_mul_f32 v[158:159], v[158:159], v[12:13] op_sel:[0,0] op_sel_hi:[1,1]
    v_pk_mul_f32 v[162:163], v[162:163], v[16:17] op_sel:[0,0] op_sel_hi:[1,1]
    v_cvt_pk_bf16_f32 v6, v156, v157
    v_cvt_pk_bf16_f32 v8, v160, v161
    v_cvt_pk_bf16_f32 v7, v158, v159
    v_cvt_pk_bf16_f32 v9, v162, v163
    s_add_u32 s70, s67, 295936
    buffer_store_dwordx4 v[6:9], v19, s[40:43], s70 offen sc1
    v_pk_fma_f32 v[164:165], v[24:25], v[60:61], v[164:165] op_sel:[0,0,0] op_sel_hi:[1,0,1]
    v_pk_fma_f32 v[168:169], v[28:29], v[60:61], v[168:169] op_sel:[0,0,0] op_sel_hi:[1,0,1]
    v_pk_fma_f32 v[166:167], v[26:27], v[60:61], v[166:167] op_sel:[0,0,0] op_sel_hi:[1,0,1]
    v_pk_fma_f32 v[170:171], v[30:31], v[60:61], v[170:171] op_sel:[0,0,0] op_sel_hi:[1,0,1]
    v_pk_fma_f32 v[180:181], v[40:41], v[60:61], v[180:181] op_sel:[0,0,0] op_sel_hi:[1,0,1]
    v_pk_fma_f32 v[184:185], v[44:45], v[60:61], v[184:185] op_sel:[0,0,0] op_sel_hi:[1,0,1]
    v_pk_fma_f32 v[182:183], v[42:43], v[60:61], v[182:183] op_sel:[0,0,0] op_sel_hi:[1,0,1]
    v_pk_fma_f32 v[186:187], v[46:47], v[60:61], v[186:187] op_sel:[0,0,0] op_sel_hi:[1,0,1]
    v_pk_mul_f32 v[10:11], v[164:165], v[62:63] op_sel:[0,0] op_sel_hi:[1,0]
    v_pk_mul_f32 v[14:15], v[168:169], v[62:63] op_sel:[0,0] op_sel_hi:[1,0]
    v_pk_mul_f32 v[12:13], v[166:167], v[62:63] op_sel:[0,0] op_sel_hi:[1,0]
    v_pk_mul_f32 v[16:17], v[170:171], v[62:63] op_sel:[0,0] op_sel_hi:[1,0]
    v_exp_f32 v10, v10
    v_exp_f32 v14, v14
    v_exp_f32 v11, v11
    v_exp_f32 v15, v15
    v_exp_f32 v12, v12
    v_exp_f32 v16, v16
    v_exp_f32 v13, v13
    v_exp_f32 v17, v17
    v_pk_mul_f32 v[180:181], v[164:165], v[180:181] op_sel:[0,0] op_sel_hi:[1,1]
    v_pk_mul_f32 v[184:185], v[168:169], v[184:185] op_sel:[0,0] op_sel_hi:[1,1]
    v_pk_mul_f32 v[182:183], v[166:167], v[182:183] op_sel:[0,0] op_sel_hi:[1,1]
    v_pk_mul_f32 v[186:187], v[170:171], v[186:187] op_sel:[0,0] op_sel_hi:[1,1]
    v_pk_fma_f32 v[10:11], v[10:11], v[60:61], v[60:61] op_sel:[0,1,1] op_sel_hi:[1,1,1]
    v_pk_fma_f32 v[14:15], v[14:15], v[60:61], v[60:61] op_sel:[0,1,1] op_sel_hi:[1,1,1]
    v_pk_fma_f32 v[12:13], v[12:13], v[60:61], v[60:61] op_sel:[0,1,1] op_sel_hi:[1,1,1]
    v_pk_fma_f32 v[16:17], v[16:17], v[60:61], v[60:61] op_sel:[0,1,1] op_sel_hi:[1,1,1]
    v_rcp_f32 v10, v10
    v_rcp_f32 v14, v14
    v_rcp_f32 v11, v11
    v_rcp_f32 v15, v15
    v_rcp_f32 v12, v12
    v_rcp_f32 v16, v16
    v_rcp_f32 v13, v13
    v_rcp_f32 v17, v17
    v_pk_mul_f32 v[180:181], v[180:181], v[10:11] op_sel:[0,0] op_sel_hi:[1,1]
    v_pk_mul_f32 v[184:185], v[184:185], v[14:15] op_sel:[0,0] op_sel_hi:[1,1]
    v_pk_mul_f32 v[182:183], v[182:183], v[12:13] op_sel:[0,0] op_sel_hi:[1,1]
    v_pk_mul_f32 v[186:187], v[186:187], v[16:17] op_sel:[0,0] op_sel_hi:[1,1]
    v_cvt_pk_bf16_f32 v2, v180, v181
    v_cvt_pk_bf16_f32 v4, v184, v185
    v_cvt_pk_bf16_f32 v3, v182, v183
    v_cvt_pk_bf16_f32 v5, v186, v187
    s_add_u32 s70, s67, 442368
    buffer_store_dwordx4 v[2:5], v19, s[40:43], s70 offen sc1
    v_pk_fma_f32 v[172:173], v[32:33], v[60:61], v[172:173] op_sel:[0,0,0] op_sel_hi:[1,0,1]
    v_pk_fma_f32 v[176:177], v[36:37], v[60:61], v[176:177] op_sel:[0,0,0] op_sel_hi:[1,0,1]
    v_accvgpr_read_b32 v56, a104
    v_pk_fma_f32 v[174:175], v[34:35], v[60:61], v[174:175] op_sel:[0,0,0] op_sel_hi:[1,0,1]
    v_pk_fma_f32 v[178:179], v[38:39], v[60:61], v[178:179] op_sel:[0,0,0] op_sel_hi:[1,0,1]
    v_accvgpr_read_b32 v57, a105
    v_pk_fma_f32 v[188:189], v[48:49], v[60:61], v[188:189] op_sel:[0,0,0] op_sel_hi:[1,0,1]
    v_pk_fma_f32 v[192:193], v[52:53], v[60:61], v[192:193] op_sel:[0,0,0] op_sel_hi:[1,0,1]
    v_rsq_f32_e64 v59, v57
    v_pk_fma_f32 v[190:191], v[50:51], v[60:61], v[190:191] op_sel:[0,0,0] op_sel_hi:[1,0,1]
    v_pk_fma_f32 v[194:195], v[54:55], v[60:61], v[194:195] op_sel:[0,0,0] op_sel_hi:[1,0,1]
    s_nop 0
    v_pk_mul_f32 v[10:11], v[172:173], v[62:63] op_sel:[0,0] op_sel_hi:[1,0]
    v_pk_mul_f32 v[14:15], v[176:177], v[62:63] op_sel:[0,0] op_sel_hi:[1,0]
    v_mul_f32 v58, s69, v59
    v_pk_mul_f32 v[12:13], v[174:175], v[62:63] op_sel:[0,0] op_sel_hi:[1,0]
    v_pk_mul_f32 v[16:17], v[178:179], v[62:63] op_sel:[0,0] op_sel_hi:[1,0]
    v_exp_f32 v10, v10
    v_exp_f32 v14, v14
    v_exp_f32 v11, v11
    v_exp_f32 v15, v15
    v_exp_f32 v12, v12
    v_exp_f32 v16, v16
    v_exp_f32 v13, v13
    v_exp_f32 v17, v17
    v_pk_mul_f32 v[188:189], v[172:173], v[188:189] op_sel:[0,0] op_sel_hi:[1,1]
    v_pk_mul_f32 v[192:193], v[176:177], v[192:193] op_sel:[0,0] op_sel_hi:[1,1]
    v_pk_mul_f32 v[190:191], v[174:175], v[190:191] op_sel:[0,0] op_sel_hi:[1,1]
    v_pk_mul_f32 v[194:195], v[178:179], v[194:195] op_sel:[0,0] op_sel_hi:[1,1]
    v_pk_fma_f32 v[10:11], v[10:11], v[60:61], v[60:61] op_sel:[0,1,1] op_sel_hi:[1,1,1]
    v_pk_fma_f32 v[14:15], v[14:15], v[60:61], v[60:61] op_sel:[0,1,1] op_sel_hi:[1,1,1]
    v_pk_fma_f32 v[12:13], v[12:13], v[60:61], v[60:61] op_sel:[0,1,1] op_sel_hi:[1,1,1]
    v_pk_fma_f32 v[16:17], v[16:17], v[60:61], v[60:61] op_sel:[0,1,1] op_sel_hi:[1,1,1]
    v_rcp_f32 v10, v10
    v_rcp_f32 v14, v14
    v_rcp_f32 v11, v11
    v_rcp_f32 v15, v15
    v_rcp_f32 v12, v12
    v_rcp_f32 v16, v16
    v_rcp_f32 v13, v13
    v_rcp_f32 v17, v17
    v_pk_mul_f32 v[188:189], v[188:189], v[10:11] op_sel:[0,0] op_sel_hi:[1,1]
    v_pk_mul_f32 v[192:193], v[192:193], v[14:15] op_sel:[0,0] op_sel_hi:[1,1]
    v_pk_mul_f32 v[190:191], v[190:191], v[12:13] op_sel:[0,0] op_sel_hi:[1,1]
    v_pk_mul_f32 v[194:195], v[194:195], v[16:17] op_sel:[0,0] op_sel_hi:[1,1]
    v_cvt_pk_bf16_f32 v6, v188, v189
    v_cvt_pk_bf16_f32 v8, v192, v193
    v_cvt_pk_bf16_f32 v7, v190, v191
    v_cvt_pk_bf16_f32 v9, v194, v195
    s_add_u32 s70, s67, 443392
    buffer_store_dwordx4 v[6:9], v19, s[40:43], s70 offen sc1
    v_pk_fma_f32 v[196:197], v[24:25], v[56:57], v[196:197] op_sel:[0,0,0] op_sel_hi:[1,0,1]
    v_pk_fma_f32 v[200:201], v[28:29], v[56:57], v[200:201] op_sel:[0,0,0] op_sel_hi:[1,0,1]
    v_pk_fma_f32 v[198:199], v[26:27], v[56:57], v[198:199] op_sel:[0,0,0] op_sel_hi:[1,0,1]
    v_pk_fma_f32 v[202:203], v[30:31], v[56:57], v[202:203] op_sel:[0,0,0] op_sel_hi:[1,0,1]
    v_pk_fma_f32 v[212:213], v[40:41], v[56:57], v[212:213] op_sel:[0,0,0] op_sel_hi:[1,0,1]
    v_pk_fma_f32 v[216:217], v[44:45], v[56:57], v[216:217] op_sel:[0,0,0] op_sel_hi:[1,0,1]
    v_pk_fma_f32 v[214:215], v[42:43], v[56:57], v[214:215] op_sel:[0,0,0] op_sel_hi:[1,0,1]
    v_pk_fma_f32 v[218:219], v[46:47], v[56:57], v[218:219] op_sel:[0,0,0] op_sel_hi:[1,0,1]
    v_pk_mul_f32 v[10:11], v[196:197], v[58:59] op_sel:[0,0] op_sel_hi:[1,0]
    v_pk_mul_f32 v[14:15], v[200:201], v[58:59] op_sel:[0,0] op_sel_hi:[1,0]
    v_pk_mul_f32 v[12:13], v[198:199], v[58:59] op_sel:[0,0] op_sel_hi:[1,0]
    v_pk_mul_f32 v[16:17], v[202:203], v[58:59] op_sel:[0,0] op_sel_hi:[1,0]
    v_exp_f32 v10, v10
    v_exp_f32 v14, v14
    v_exp_f32 v11, v11
    v_exp_f32 v15, v15
    v_exp_f32 v12, v12
    v_exp_f32 v16, v16
    v_exp_f32 v13, v13
    v_exp_f32 v17, v17
    v_pk_mul_f32 v[212:213], v[196:197], v[212:213] op_sel:[0,0] op_sel_hi:[1,1]
    v_pk_mul_f32 v[216:217], v[200:201], v[216:217] op_sel:[0,0] op_sel_hi:[1,1]
    v_pk_mul_f32 v[214:215], v[198:199], v[214:215] op_sel:[0,0] op_sel_hi:[1,1]
    v_pk_mul_f32 v[218:219], v[202:203], v[218:219] op_sel:[0,0] op_sel_hi:[1,1]
    v_pk_fma_f32 v[10:11], v[10:11], v[56:57], v[56:57] op_sel:[0,1,1] op_sel_hi:[1,1,1]
    v_pk_fma_f32 v[14:15], v[14:15], v[56:57], v[56:57] op_sel:[0,1,1] op_sel_hi:[1,1,1]
    v_pk_fma_f32 v[12:13], v[12:13], v[56:57], v[56:57] op_sel:[0,1,1] op_sel_hi:[1,1,1]
    v_pk_fma_f32 v[16:17], v[16:17], v[56:57], v[56:57] op_sel:[0,1,1] op_sel_hi:[1,1,1]
    v_rcp_f32 v10, v10
    v_rcp_f32 v14, v14
    v_rcp_f32 v11, v11
    v_rcp_f32 v15, v15
    v_rcp_f32 v12, v12
    v_rcp_f32 v16, v16
    v_rcp_f32 v13, v13
    v_rcp_f32 v17, v17
    v_pk_mul_f32 v[212:213], v[212:213], v[10:11] op_sel:[0,0] op_sel_hi:[1,1]
    v_pk_mul_f32 v[216:217], v[216:217], v[14:15] op_sel:[0,0] op_sel_hi:[1,1]
    v_pk_mul_f32 v[214:215], v[214:215], v[12:13] op_sel:[0,0] op_sel_hi:[1,1]
    v_pk_mul_f32 v[218:219], v[218:219], v[16:17] op_sel:[0,0] op_sel_hi:[1,1]
    v_cvt_pk_bf16_f32 v2, v212, v213
    v_cvt_pk_bf16_f32 v4, v216, v217
    v_cvt_pk_bf16_f32 v3, v214, v215
    v_cvt_pk_bf16_f32 v5, v218, v219
    s_add_u32 s70, s67, 589824
    buffer_store_dwordx4 v[2:5], v19, s[40:43], s70 offen sc1
    v_pk_fma_f32 v[204:205], v[32:33], v[56:57], v[204:205] op_sel:[0,0,0] op_sel_hi:[1,0,1]
    v_pk_fma_f32 v[208:209], v[36:37], v[56:57], v[208:209] op_sel:[0,0,0] op_sel_hi:[1,0,1]
    v_accvgpr_read_b32 v60, a106
    v_pk_fma_f32 v[206:207], v[34:35], v[56:57], v[206:207] op_sel:[0,0,0] op_sel_hi:[1,0,1]
    v_pk_fma_f32 v[210:211], v[38:39], v[56:57], v[210:211] op_sel:[0,0,0] op_sel_hi:[1,0,1]
    v_accvgpr_read_b32 v61, a107
    v_pk_fma_f32 v[220:221], v[48:49], v[56:57], v[220:221] op_sel:[0,0,0] op_sel_hi:[1,0,1]
    v_pk_fma_f32 v[224:225], v[52:53], v[56:57], v[224:225] op_sel:[0,0,0] op_sel_hi:[1,0,1]
    v_rsq_f32_e64 v63, v61
    v_pk_fma_f32 v[222:223], v[50:51], v[56:57], v[222:223] op_sel:[0,0,0] op_sel_hi:[1,0,1]
    v_pk_fma_f32 v[226:227], v[54:55], v[56:57], v[226:227] op_sel:[0,0,0] op_sel_hi:[1,0,1]
    s_nop 0
    v_pk_mul_f32 v[10:11], v[204:205], v[58:59] op_sel:[0,0] op_sel_hi:[1,0]
    v_pk_mul_f32 v[14:15], v[208:209], v[58:59] op_sel:[0,0] op_sel_hi:[1,0]
    v_mul_f32 v62, s69, v63
    v_pk_mul_f32 v[12:13], v[206:207], v[58:59] op_sel:[0,0] op_sel_hi:[1,0]
    v_pk_mul_f32 v[16:17], v[210:211], v[58:59] op_sel:[0,0] op_sel_hi:[1,0]
    v_exp_f32 v10, v10
    v_exp_f32 v14, v14
    v_exp_f32 v11, v11
    v_exp_f32 v15, v15
    v_exp_f32 v12, v12
    v_exp_f32 v16, v16
    v_exp_f32 v13, v13
    v_exp_f32 v17, v17
    v_pk_mul_f32 v[220:221], v[204:205], v[220:221] op_sel:[0,0] op_sel_hi:[1,1]
    v_pk_mul_f32 v[224:225], v[208:209], v[224:225] op_sel:[0,0] op_sel_hi:[1,1]
    v_pk_mul_f32 v[222:223], v[206:207], v[222:223] op_sel:[0,0] op_sel_hi:[1,1]
    v_pk_mul_f32 v[226:227], v[210:211], v[226:227] op_sel:[0,0] op_sel_hi:[1,1]
    v_pk_fma_f32 v[10:11], v[10:11], v[56:57], v[56:57] op_sel:[0,1,1] op_sel_hi:[1,1,1]
    v_pk_fma_f32 v[14:15], v[14:15], v[56:57], v[56:57] op_sel:[0,1,1] op_sel_hi:[1,1,1]
    v_pk_fma_f32 v[12:13], v[12:13], v[56:57], v[56:57] op_sel:[0,1,1] op_sel_hi:[1,1,1]
    v_pk_fma_f32 v[16:17], v[16:17], v[56:57], v[56:57] op_sel:[0,1,1] op_sel_hi:[1,1,1]
    v_rcp_f32 v10, v10
    v_rcp_f32 v14, v14
    v_rcp_f32 v11, v11
    v_rcp_f32 v15, v15
    v_rcp_f32 v12, v12
    v_rcp_f32 v16, v16
    v_rcp_f32 v13, v13
    v_rcp_f32 v17, v17
    v_pk_mul_f32 v[220:221], v[220:221], v[10:11] op_sel:[0,0] op_sel_hi:[1,1]
    v_pk_mul_f32 v[224:225], v[224:225], v[14:15] op_sel:[0,0] op_sel_hi:[1,1]
    v_pk_mul_f32 v[222:223], v[222:223], v[12:13] op_sel:[0,0] op_sel_hi:[1,1]
    v_pk_mul_f32 v[226:227], v[226:227], v[16:17] op_sel:[0,0] op_sel_hi:[1,1]
    v_cvt_pk_bf16_f32 v6, v220, v221
    v_cvt_pk_bf16_f32 v8, v224, v225
    v_cvt_pk_bf16_f32 v7, v222, v223
    v_cvt_pk_bf16_f32 v9, v226, v227
    s_add_u32 s70, s67, 590848
    buffer_store_dwordx4 v[6:9], v19, s[40:43], s70 offen sc1
    v_pk_fma_f32 v[228:229], v[24:25], v[60:61], v[228:229] op_sel:[0,0,0] op_sel_hi:[1,0,1]
    v_pk_fma_f32 v[232:233], v[28:29], v[60:61], v[232:233] op_sel:[0,0,0] op_sel_hi:[1,0,1]
    v_pk_fma_f32 v[230:231], v[26:27], v[60:61], v[230:231] op_sel:[0,0,0] op_sel_hi:[1,0,1]
    v_pk_fma_f32 v[234:235], v[30:31], v[60:61], v[234:235] op_sel:[0,0,0] op_sel_hi:[1,0,1]
    v_pk_fma_f32 v[244:245], v[40:41], v[60:61], v[244:245] op_sel:[0,0,0] op_sel_hi:[1,0,1]
    v_pk_fma_f32 v[248:249], v[44:45], v[60:61], v[248:249] op_sel:[0,0,0] op_sel_hi:[1,0,1]
    v_pk_fma_f32 v[246:247], v[42:43], v[60:61], v[246:247] op_sel:[0,0,0] op_sel_hi:[1,0,1]
    v_pk_fma_f32 v[250:251], v[46:47], v[60:61], v[250:251] op_sel:[0,0,0] op_sel_hi:[1,0,1]
    v_pk_mul_f32 v[10:11], v[228:229], v[62:63] op_sel:[0,0] op_sel_hi:[1,0]
    v_pk_mul_f32 v[14:15], v[232:233], v[62:63] op_sel:[0,0] op_sel_hi:[1,0]
    v_pk_mul_f32 v[12:13], v[230:231], v[62:63] op_sel:[0,0] op_sel_hi:[1,0]
    v_pk_mul_f32 v[16:17], v[234:235], v[62:63] op_sel:[0,0] op_sel_hi:[1,0]
    v_exp_f32 v10, v10
    v_exp_f32 v14, v14
    v_exp_f32 v11, v11
    v_exp_f32 v15, v15
    v_exp_f32 v12, v12
    v_exp_f32 v16, v16
    v_exp_f32 v13, v13
    v_exp_f32 v17, v17
    v_pk_mul_f32 v[244:245], v[228:229], v[244:245] op_sel:[0,0] op_sel_hi:[1,1]
    v_pk_mul_f32 v[248:249], v[232:233], v[248:249] op_sel:[0,0] op_sel_hi:[1,1]
    v_pk_mul_f32 v[246:247], v[230:231], v[246:247] op_sel:[0,0] op_sel_hi:[1,1]
    v_pk_mul_f32 v[250:251], v[234:235], v[250:251] op_sel:[0,0] op_sel_hi:[1,1]
    v_pk_fma_f32 v[10:11], v[10:11], v[60:61], v[60:61] op_sel:[0,1,1] op_sel_hi:[1,1,1]
    v_pk_fma_f32 v[14:15], v[14:15], v[60:61], v[60:61] op_sel:[0,1,1] op_sel_hi:[1,1,1]
    v_pk_fma_f32 v[12:13], v[12:13], v[60:61], v[60:61] op_sel:[0,1,1] op_sel_hi:[1,1,1]
    v_pk_fma_f32 v[16:17], v[16:17], v[60:61], v[60:61] op_sel:[0,1,1] op_sel_hi:[1,1,1]
    v_rcp_f32 v10, v10
    v_rcp_f32 v14, v14
    v_rcp_f32 v11, v11
    v_rcp_f32 v15, v15
    v_rcp_f32 v12, v12
    v_rcp_f32 v16, v16
    v_rcp_f32 v13, v13
    v_rcp_f32 v17, v17
    v_pk_mul_f32 v[244:245], v[244:245], v[10:11] op_sel:[0,0] op_sel_hi:[1,1]
    v_pk_mul_f32 v[248:249], v[248:249], v[14:15] op_sel:[0,0] op_sel_hi:[1,1]
    v_pk_mul_f32 v[246:247], v[246:247], v[12:13] op_sel:[0,0] op_sel_hi:[1,1]
    v_pk_mul_f32 v[250:251], v[250:251], v[16:17] op_sel:[0,0] op_sel_hi:[1,1]
    v_cvt_pk_bf16_f32 v2, v244, v245
    v_cvt_pk_bf16_f32 v4, v248, v249
    v_cvt_pk_bf16_f32 v3, v246, v247
    v_cvt_pk_bf16_f32 v5, v250, v251
    s_add_u32 s70, s67, 737280
    buffer_store_dwordx4 v[2:5], v19, s[40:43], s70 offen sc1
    v_accvgpr_read_b32 v68, a132
    v_accvgpr_read_b32 v72, a136
    v_accvgpr_read_b32 v56, a108
    v_accvgpr_read_b32 v69, a133
    v_accvgpr_read_b32 v73, a137
    v_accvgpr_read_b32 v57, a109
    v_accvgpr_read_b32 v70, a134
    v_accvgpr_read_b32 v74, a138
    v_rsq_f32_e64 v59, v57
    v_accvgpr_read_b32 v71, a135
    v_accvgpr_read_b32 v75, a139
    s_nop 0
    v_pk_fma_f32 v[236:237], v[32:33], v[60:61], v[236:237] op_sel:[0,0,0] op_sel_hi:[1,0,1]
    v_pk_fma_f32 v[240:241], v[36:37], v[60:61], v[240:241] op_sel:[0,0,0] op_sel_hi:[1,0,1]
    v_mul_f32 v58, s69, v59
    v_pk_fma_f32 v[238:239], v[34:35], v[60:61], v[238:239] op_sel:[0,0,0] op_sel_hi:[1,0,1]
    v_pk_fma_f32 v[242:243], v[38:39], v[60:61], v[242:243] op_sel:[0,0,0] op_sel_hi:[1,0,1]
    v_pk_fma_f32 v[68:69], v[48:49], v[60:61], v[68:69] op_sel:[0,0,0] op_sel_hi:[1,0,1]
    v_pk_fma_f32 v[72:73], v[52:53], v[60:61], v[72:73] op_sel:[0,0,0] op_sel_hi:[1,0,1]
    v_pk_fma_f32 v[70:71], v[50:51], v[60:61], v[70:71] op_sel:[0,0,0] op_sel_hi:[1,0,1]
    v_pk_fma_f32 v[74:75], v[54:55], v[60:61], v[74:75] op_sel:[0,0,0] op_sel_hi:[1,0,1]
    v_pk_mul_f32 v[10:11], v[236:237], v[62:63] op_sel:[0,0] op_sel_hi:[1,0]
    v_pk_mul_f32 v[14:15], v[240:241], v[62:63] op_sel:[0,0] op_sel_hi:[1,0]
    v_pk_mul_f32 v[12:13], v[238:239], v[62:63] op_sel:[0,0] op_sel_hi:[1,0]
    v_pk_mul_f32 v[16:17], v[242:243], v[62:63] op_sel:[0,0] op_sel_hi:[1,0]
    v_exp_f32 v10, v10
    v_exp_f32 v14, v14
    v_exp_f32 v11, v11
    v_exp_f32 v15, v15
    v_exp_f32 v12, v12
    v_exp_f32 v16, v16
    v_exp_f32 v13, v13
    v_exp_f32 v17, v17
    v_pk_mul_f32 v[68:69], v[236:237], v[68:69] op_sel:[0,0] op_sel_hi:[1,1]
    v_pk_mul_f32 v[72:73], v[240:241], v[72:73] op_sel:[0,0] op_sel_hi:[1,1]
    v_pk_mul_f32 v[70:71], v[238:239], v[70:71] op_sel:[0,0] op_sel_hi:[1,1]
    v_pk_mul_f32 v[74:75], v[242:243], v[74:75] op_sel:[0,0] op_sel_hi:[1,1]
    v_pk_fma_f32 v[10:11], v[10:11], v[60:61], v[60:61] op_sel:[0,1,1] op_sel_hi:[1,1,1]
    v_pk_fma_f32 v[14:15], v[14:15], v[60:61], v[60:61] op_sel:[0,1,1] op_sel_hi:[1,1,1]
    v_pk_fma_f32 v[12:13], v[12:13], v[60:61], v[60:61] op_sel:[0,1,1] op_sel_hi:[1,1,1]
    v_pk_fma_f32 v[16:17], v[16:17], v[60:61], v[60:61] op_sel:[0,1,1] op_sel_hi:[1,1,1]
    v_rcp_f32 v10, v10
    v_rcp_f32 v14, v14
    v_rcp_f32 v11, v11
    v_rcp_f32 v15, v15
    v_rcp_f32 v12, v12
    v_rcp_f32 v16, v16
    v_rcp_f32 v13, v13
    v_rcp_f32 v17, v17
    v_pk_mul_f32 v[68:69], v[68:69], v[10:11] op_sel:[0,0] op_sel_hi:[1,1]
    v_pk_mul_f32 v[72:73], v[72:73], v[14:15] op_sel:[0,0] op_sel_hi:[1,1]
    v_pk_mul_f32 v[70:71], v[70:71], v[12:13] op_sel:[0,0] op_sel_hi:[1,1]
    v_pk_mul_f32 v[74:75], v[74:75], v[16:17] op_sel:[0,0] op_sel_hi:[1,1]
    v_cvt_pk_bf16_f32 v6, v68, v69
    v_cvt_pk_bf16_f32 v8, v72, v73
    v_cvt_pk_bf16_f32 v7, v70, v71
    v_cvt_pk_bf16_f32 v9, v74, v75
    s_add_u32 s70, s67, 738304
    buffer_store_dwordx4 v[6:9], v19, s[40:43], s70 offen sc1
    v_accvgpr_read_b32 v76, a140
    v_accvgpr_read_b32 v84, a144
    v_accvgpr_read_b32 v77, a141
    v_accvgpr_read_b32 v85, a145
    v_accvgpr_read_b32 v78, a142
    v_accvgpr_read_b32 v86, a146
    v_accvgpr_read_b32 v79, a143
    v_accvgpr_read_b32 v87, a147
    v_accvgpr_read_b32 v80, a156
    v_accvgpr_read_b32 v88, a160
    v_accvgpr_read_b32 v81, a157
    v_accvgpr_read_b32 v89, a161
    v_accvgpr_read_b32 v82, a158
    v_accvgpr_read_b32 v90, a162
    v_accvgpr_read_b32 v83, a159
    v_accvgpr_read_b32 v91, a163
    v_pk_fma_f32 v[76:77], v[24:25], v[56:57], v[76:77] op_sel:[0,0,0] op_sel_hi:[1,0,1]
    v_pk_fma_f32 v[84:85], v[28:29], v[56:57], v[84:85] op_sel:[0,0,0] op_sel_hi:[1,0,1]
    v_pk_fma_f32 v[78:79], v[26:27], v[56:57], v[78:79] op_sel:[0,0,0] op_sel_hi:[1,0,1]
    v_pk_fma_f32 v[86:87], v[30:31], v[56:57], v[86:87] op_sel:[0,0,0] op_sel_hi:[1,0,1]
    v_pk_fma_f32 v[80:81], v[40:41], v[56:57], v[80:81] op_sel:[0,0,0] op_sel_hi:[1,0,1]
    v_pk_fma_f32 v[88:89], v[44:45], v[56:57], v[88:89] op_sel:[0,0,0] op_sel_hi:[1,0,1]
    v_pk_fma_f32 v[82:83], v[42:43], v[56:57], v[82:83] op_sel:[0,0,0] op_sel_hi:[1,0,1]
    v_pk_fma_f32 v[90:91], v[46:47], v[56:57], v[90:91] op_sel:[0,0,0] op_sel_hi:[1,0,1]
    v_pk_mul_f32 v[10:11], v[76:77], v[58:59] op_sel:[0,0] op_sel_hi:[1,0]
    v_pk_mul_f32 v[14:15], v[84:85], v[58:59] op_sel:[0,0] op_sel_hi:[1,0]
    v_pk_mul_f32 v[12:13], v[78:79], v[58:59] op_sel:[0,0] op_sel_hi:[1,0]
    v_pk_mul_f32 v[16:17], v[86:87], v[58:59] op_sel:[0,0] op_sel_hi:[1,0]
    v_exp_f32 v10, v10
    v_exp_f32 v14, v14
    v_exp_f32 v11, v11
    v_exp_f32 v15, v15
    v_exp_f32 v12, v12
    v_exp_f32 v16, v16
    v_exp_f32 v13, v13
    v_exp_f32 v17, v17
    v_pk_mul_f32 v[80:81], v[76:77], v[80:81] op_sel:[0,0] op_sel_hi:[1,1]
    v_pk_mul_f32 v[88:89], v[84:85], v[88:89] op_sel:[0,0] op_sel_hi:[1,1]
    v_pk_mul_f32 v[82:83], v[78:79], v[82:83] op_sel:[0,0] op_sel_hi:[1,1]
    v_pk_mul_f32 v[90:91], v[86:87], v[90:91] op_sel:[0,0] op_sel_hi:[1,1]
    v_pk_fma_f32 v[10:11], v[10:11], v[56:57], v[56:57] op_sel:[0,1,1] op_sel_hi:[1,1,1]
    v_pk_fma_f32 v[14:15], v[14:15], v[56:57], v[56:57] op_sel:[0,1,1] op_sel_hi:[1,1,1]
    v_pk_fma_f32 v[12:13], v[12:13], v[56:57], v[56:57] op_sel:[0,1,1] op_sel_hi:[1,1,1]
    v_pk_fma_f32 v[16:17], v[16:17], v[56:57], v[56:57] op_sel:[0,1,1] op_sel_hi:[1,1,1]
    v_rcp_f32 v10, v10
    v_rcp_f32 v14, v14
    v_rcp_f32 v11, v11
    v_rcp_f32 v15, v15
    v_rcp_f32 v12, v12
    v_rcp_f32 v16, v16
    v_rcp_f32 v13, v13
    v_rcp_f32 v17, v17
    v_pk_mul_f32 v[80:81], v[80:81], v[10:11] op_sel:[0,0] op_sel_hi:[1,1]
    v_pk_mul_f32 v[88:89], v[88:89], v[14:15] op_sel:[0,0] op_sel_hi:[1,1]
    v_pk_mul_f32 v[82:83], v[82:83], v[12:13] op_sel:[0,0] op_sel_hi:[1,1]
    v_pk_mul_f32 v[90:91], v[90:91], v[16:17] op_sel:[0,0] op_sel_hi:[1,1]
    v_cvt_pk_bf16_f32 v2, v80, v81
    v_cvt_pk_bf16_f32 v4, v88, v89
    v_cvt_pk_bf16_f32 v3, v82, v83
    v_cvt_pk_bf16_f32 v5, v90, v91
    s_add_u32 s70, s67, 884736
    buffer_store_dwordx4 v[2:5], v19, s[40:43], s70 offen sc1
    v_accvgpr_read_b32 v92, a148
    v_accvgpr_read_b32 v68, a152
    v_accvgpr_read_b32 v60, a110
    v_accvgpr_read_b32 v93, a149
    v_accvgpr_read_b32 v69, a153
    v_accvgpr_read_b32 v61, a111
    v_accvgpr_read_b32 v94, a150
    v_accvgpr_read_b32 v70, a154
    v_rsq_f32_e64 v63, v61
    v_accvgpr_read_b32 v95, a151
    v_accvgpr_read_b32 v71, a155
    s_nop 0
    v_accvgpr_read_b32 v96, a164
    v_accvgpr_read_b32 v72, a168
    v_mul_f32 v62, s69, v63
    v_accvgpr_read_b32 v97, a165
    v_accvgpr_read_b32 v73, a169
    v_accvgpr_read_b32 v98, a166
    v_accvgpr_read_b32 v74, a170
    v_accvgpr_read_b32 v99, a167
    v_accvgpr_read_b32 v75, a171
    v_pk_fma_f32 v[92:93], v[32:33], v[56:57], v[92:93] op_sel:[0,0,0] op_sel_hi:[1,0,1]
    v_pk_fma_f32 v[68:69], v[36:37], v[56:57], v[68:69] op_sel:[0,0,0] op_sel_hi:[1,0,1]
    v_pk_fma_f32 v[94:95], v[34:35], v[56:57], v[94:95] op_sel:[0,0,0] op_sel_hi:[1,0,1]
    v_pk_fma_f32 v[70:71], v[38:39], v[56:57], v[70:71] op_sel:[0,0,0] op_sel_hi:[1,0,1]
    v_pk_fma_f32 v[96:97], v[48:49], v[56:57], v[96:97] op_sel:[0,0,0] op_sel_hi:[1,0,1]
    v_pk_fma_f32 v[72:73], v[52:53], v[56:57], v[72:73] op_sel:[0,0,0] op_sel_hi:[1,0,1]
    v_pk_fma_f32 v[98:99], v[50:51], v[56:57], v[98:99] op_sel:[0,0,0] op_sel_hi:[1,0,1]
    v_pk_fma_f32 v[74:75], v[54:55], v[56:57], v[74:75] op_sel:[0,0,0] op_sel_hi:[1,0,1]
    v_pk_mul_f32 v[10:11], v[92:93], v[58:59] op_sel:[0,0] op_sel_hi:[1,0]
    v_pk_mul_f32 v[14:15], v[68:69], v[58:59] op_sel:[0,0] op_sel_hi:[1,0]
    v_pk_mul_f32 v[12:13], v[94:95], v[58:59] op_sel:[0,0] op_sel_hi:[1,0]
    v_pk_mul_f32 v[16:17], v[70:71], v[58:59] op_sel:[0,0] op_sel_hi:[1,0]
    v_exp_f32 v10, v10
    v_exp_f32 v14, v14
    v_exp_f32 v11, v11
    v_exp_f32 v15, v15
    v_exp_f32 v12, v12
    v_exp_f32 v16, v16
    v_exp_f32 v13, v13
    v_exp_f32 v17, v17
    v_pk_mul_f32 v[96:97], v[92:93], v[96:97] op_sel:[0,0] op_sel_hi:[1,1]
    v_pk_mul_f32 v[72:73], v[68:69], v[72:73] op_sel:[0,0] op_sel_hi:[1,1]
    v_pk_mul_f32 v[98:99], v[94:95], v[98:99] op_sel:[0,0] op_sel_hi:[1,1]
    v_pk_mul_f32 v[74:75], v[70:71], v[74:75] op_sel:[0,0] op_sel_hi:[1,1]
    v_pk_fma_f32 v[10:11], v[10:11], v[56:57], v[56:57] op_sel:[0,1,1] op_sel_hi:[1,1,1]
    v_pk_fma_f32 v[14:15], v[14:15], v[56:57], v[56:57] op_sel:[0,1,1] op_sel_hi:[1,1,1]
    v_pk_fma_f32 v[12:13], v[12:13], v[56:57], v[56:57] op_sel:[0,1,1] op_sel_hi:[1,1,1]
    v_pk_fma_f32 v[16:17], v[16:17], v[56:57], v[56:57] op_sel:[0,1,1] op_sel_hi:[1,1,1]
    v_rcp_f32 v10, v10
    v_rcp_f32 v14, v14
    v_rcp_f32 v11, v11
    v_rcp_f32 v15, v15
    v_rcp_f32 v12, v12
    v_rcp_f32 v16, v16
    v_rcp_f32 v13, v13
    v_rcp_f32 v17, v17
    v_pk_mul_f32 v[96:97], v[96:97], v[10:11] op_sel:[0,0] op_sel_hi:[1,1]
    v_pk_mul_f32 v[72:73], v[72:73], v[14:15] op_sel:[0,0] op_sel_hi:[1,1]
    v_pk_mul_f32 v[98:99], v[98:99], v[12:13] op_sel:[0,0] op_sel_hi:[1,1]
    v_pk_mul_f32 v[74:75], v[74:75], v[16:17] op_sel:[0,0] op_sel_hi:[1,1]
    v_cvt_pk_bf16_f32 v6, v96, v97
    v_cvt_pk_bf16_f32 v8, v72, v73
    v_cvt_pk_bf16_f32 v7, v98, v99
    v_cvt_pk_bf16_f32 v9, v74, v75
    s_add_u32 s70, s67, 885760
    buffer_store_dwordx4 v[6:9], v19, s[40:43], s70 offen sc1
    v_accvgpr_read_b32 v76, a172
    v_accvgpr_read_b32 v84, a176
    v_accvgpr_read_b32 v77, a173
    v_accvgpr_read_b32 v85, a177
    v_accvgpr_read_b32 v78, a174
    v_accvgpr_read_b32 v86, a178
    v_accvgpr_read_b32 v79, a175
    v_accvgpr_read_b32 v87, a179
    v_accvgpr_read_b32 v80, a188
    v_accvgpr_read_b32 v88, a192
    v_accvgpr_read_b32 v81, a189
    v_accvgpr_read_b32 v89, a193
    v_accvgpr_read_b32 v82, a190
    v_accvgpr_read_b32 v90, a194
    v_accvgpr_read_b32 v83, a191
    v_accvgpr_read_b32 v91, a195
    v_pk_fma_f32 v[76:77], v[24:25], v[60:61], v[76:77] op_sel:[0,0,0] op_sel_hi:[1,0,1]
    v_pk_fma_f32 v[84:85], v[28:29], v[60:61], v[84:85] op_sel:[0,0,0] op_sel_hi:[1,0,1]
    v_pk_fma_f32 v[78:79], v[26:27], v[60:61], v[78:79] op_sel:[0,0,0] op_sel_hi:[1,0,1]
    v_pk_fma_f32 v[86:87], v[30:31], v[60:61], v[86:87] op_sel:[0,0,0] op_sel_hi:[1,0,1]
    v_pk_fma_f32 v[80:81], v[40:41], v[60:61], v[80:81] op_sel:[0,0,0] op_sel_hi:[1,0,1]
    v_pk_fma_f32 v[88:89], v[44:45], v[60:61], v[88:89] op_sel:[0,0,0] op_sel_hi:[1,0,1]
    v_pk_fma_f32 v[82:83], v[42:43], v[60:61], v[82:83] op_sel:[0,0,0] op_sel_hi:[1,0,1]
    v_pk_fma_f32 v[90:91], v[46:47], v[60:61], v[90:91] op_sel:[0,0,0] op_sel_hi:[1,0,1]
    v_pk_mul_f32 v[10:11], v[76:77], v[62:63] op_sel:[0,0] op_sel_hi:[1,0]
    v_pk_mul_f32 v[14:15], v[84:85], v[62:63] op_sel:[0,0] op_sel_hi:[1,0]
    v_pk_mul_f32 v[12:13], v[78:79], v[62:63] op_sel:[0,0] op_sel_hi:[1,0]
    v_pk_mul_f32 v[16:17], v[86:87], v[62:63] op_sel:[0,0] op_sel_hi:[1,0]
    v_exp_f32 v10, v10
    v_exp_f32 v14, v14
    v_exp_f32 v11, v11
    v_exp_f32 v15, v15
    v_exp_f32 v12, v12
    v_exp_f32 v16, v16
    v_exp_f32 v13, v13
    v_exp_f32 v17, v17
    v_pk_mul_f32 v[80:81], v[76:77], v[80:81] op_sel:[0,0] op_sel_hi:[1,1]
    v_pk_mul_f32 v[88:89], v[84:85], v[88:89] op_sel:[0,0] op_sel_hi:[1,1]
    v_pk_mul_f32 v[82:83], v[78:79], v[82:83] op_sel:[0,0] op_sel_hi:[1,1]
    v_pk_mul_f32 v[90:91], v[86:87], v[90:91] op_sel:[0,0] op_sel_hi:[1,1]
    v_pk_fma_f32 v[10:11], v[10:11], v[60:61], v[60:61] op_sel:[0,1,1] op_sel_hi:[1,1,1]
    v_pk_fma_f32 v[14:15], v[14:15], v[60:61], v[60:61] op_sel:[0,1,1] op_sel_hi:[1,1,1]
    v_pk_fma_f32 v[12:13], v[12:13], v[60:61], v[60:61] op_sel:[0,1,1] op_sel_hi:[1,1,1]
    v_pk_fma_f32 v[16:17], v[16:17], v[60:61], v[60:61] op_sel:[0,1,1] op_sel_hi:[1,1,1]
    v_rcp_f32 v10, v10
    v_rcp_f32 v14, v14
    v_rcp_f32 v11, v11
    v_rcp_f32 v15, v15
    v_rcp_f32 v12, v12
    v_rcp_f32 v16, v16
    v_rcp_f32 v13, v13
    v_rcp_f32 v17, v17
    v_pk_mul_f32 v[80:81], v[80:81], v[10:11] op_sel:[0,0] op_sel_hi:[1,1]
    v_pk_mul_f32 v[88:89], v[88:89], v[14:15] op_sel:[0,0] op_sel_hi:[1,1]
    v_pk_mul_f32 v[82:83], v[82:83], v[12:13] op_sel:[0,0] op_sel_hi:[1,1]
    v_pk_mul_f32 v[90:91], v[90:91], v[16:17] op_sel:[0,0] op_sel_hi:[1,1]
    v_cvt_pk_bf16_f32 v2, v80, v81
    v_cvt_pk_bf16_f32 v4, v88, v89
    v_cvt_pk_bf16_f32 v3, v82, v83
    v_cvt_pk_bf16_f32 v5, v90, v91
    s_add_u32 s70, s67, 1032192
    buffer_store_dwordx4 v[2:5], v19, s[40:43], s70 offen sc1
    v_accvgpr_read_b32 v92, a180
    v_accvgpr_read_b32 v68, a184
    v_accvgpr_read_b32 v93, a181
    v_accvgpr_read_b32 v69, a185
    v_accvgpr_read_b32 v94, a182
    v_accvgpr_read_b32 v70, a186
    v_accvgpr_read_b32 v95, a183
    v_accvgpr_read_b32 v71, a187
    v_accvgpr_read_b32 v96, a196
    v_accvgpr_read_b32 v72, a200
    v_accvgpr_read_b32 v97, a197
    v_accvgpr_read_b32 v73, a201
    v_accvgpr_read_b32 v98, a198
    v_accvgpr_read_b32 v74, a202
    v_accvgpr_read_b32 v99, a199
    v_accvgpr_read_b32 v75, a203
    v_pk_fma_f32 v[92:93], v[32:33], v[60:61], v[92:93] op_sel:[0,0,0] op_sel_hi:[1,0,1]
    v_pk_fma_f32 v[68:69], v[36:37], v[60:61], v[68:69] op_sel:[0,0,0] op_sel_hi:[1,0,1]
    v_pk_fma_f32 v[94:95], v[34:35], v[60:61], v[94:95] op_sel:[0,0,0] op_sel_hi:[1,0,1]
    v_pk_fma_f32 v[70:71], v[38:39], v[60:61], v[70:71] op_sel:[0,0,0] op_sel_hi:[1,0,1]
    v_pk_fma_f32 v[96:97], v[48:49], v[60:61], v[96:97] op_sel:[0,0,0] op_sel_hi:[1,0,1]
    v_pk_fma_f32 v[72:73], v[52:53], v[60:61], v[72:73] op_sel:[0,0,0] op_sel_hi:[1,0,1]
    v_pk_fma_f32 v[98:99], v[50:51], v[60:61], v[98:99] op_sel:[0,0,0] op_sel_hi:[1,0,1]
    v_pk_fma_f32 v[74:75], v[54:55], v[60:61], v[74:75] op_sel:[0,0,0] op_sel_hi:[1,0,1]
    v_pk_mul_f32 v[10:11], v[92:93], v[62:63] op_sel:[0,0] op_sel_hi:[1,0]
    v_pk_mul_f32 v[14:15], v[68:69], v[62:63] op_sel:[0,0] op_sel_hi:[1,0]
    v_pk_mul_f32 v[12:13], v[94:95], v[62:63] op_sel:[0,0] op_sel_hi:[1,0]
    v_pk_mul_f32 v[16:17], v[70:71], v[62:63] op_sel:[0,0] op_sel_hi:[1,0]
    v_exp_f32 v10, v10
    v_exp_f32 v14, v14
    v_exp_f32 v11, v11
    v_exp_f32 v15, v15
    v_exp_f32 v12, v12
    v_exp_f32 v16, v16
    v_exp_f32 v13, v13
    v_exp_f32 v17, v17
    v_pk_mul_f32 v[96:97], v[92:93], v[96:97] op_sel:[0,0] op_sel_hi:[1,1]
    v_pk_mul_f32 v[72:73], v[68:69], v[72:73] op_sel:[0,0] op_sel_hi:[1,1]
    v_pk_mul_f32 v[98:99], v[94:95], v[98:99] op_sel:[0,0] op_sel_hi:[1,1]
    v_pk_mul_f32 v[74:75], v[70:71], v[74:75] op_sel:[0,0] op_sel_hi:[1,1]
    v_pk_fma_f32 v[10:11], v[10:11], v[60:61], v[60:61] op_sel:[0,1,1] op_sel_hi:[1,1,1]
    v_pk_fma_f32 v[14:15], v[14:15], v[60:61], v[60:61] op_sel:[0,1,1] op_sel_hi:[1,1,1]
    v_pk_fma_f32 v[12:13], v[12:13], v[60:61], v[60:61] op_sel:[0,1,1] op_sel_hi:[1,1,1]
    v_pk_fma_f32 v[16:17], v[16:17], v[60:61], v[60:61] op_sel:[0,1,1] op_sel_hi:[1,1,1]
    v_rcp_f32 v10, v10
    v_rcp_f32 v14, v14
    v_rcp_f32 v11, v11
    v_rcp_f32 v15, v15
    v_rcp_f32 v12, v12
    v_rcp_f32 v16, v16
    v_rcp_f32 v13, v13
    v_rcp_f32 v17, v17
    v_pk_mul_f32 v[96:97], v[96:97], v[10:11] op_sel:[0,0] op_sel_hi:[1,1]
    v_pk_mul_f32 v[72:73], v[72:73], v[14:15] op_sel:[0,0] op_sel_hi:[1,1]
    v_pk_mul_f32 v[98:99], v[98:99], v[12:13] op_sel:[0,0] op_sel_hi:[1,1]
    v_pk_mul_f32 v[74:75], v[74:75], v[16:17] op_sel:[0,0] op_sel_hi:[1,1]
    v_cvt_pk_bf16_f32 v6, v96, v97
    v_cvt_pk_bf16_f32 v8, v72, v73
    v_cvt_pk_bf16_f32 v7, v98, v99
    v_cvt_pk_bf16_f32 v9, v74, v75
    s_add_u32 s70, s67, 1033216
    buffer_store_dwordx4 v[6:9], v19, s[40:43], s70 offen sc1
proj_kernel_ffn_end:
    s_endpgm
proj_kernel_ffn_pfend:
proj_kernel_qkv:
    s_getpc_b64 s[74:75]
proj_kernel_qkv_pfpc:
    s_add_u32 s74, s74, proj_kernel_qkv_pfstart-proj_kernel_qkv_pfpc
    s_addc_u32 s75, s75, 0
    v_lshlrev_b32 v19, 7, v0
    v_min_u32 v20, proj_kernel_qkv_pfend-proj_kernel_qkv_pfstart-4, v19
    global_load_dword v74, v20, s[74:75]
    v_add_u32 v19, 8192, v19
    v_min_u32 v20, proj_kernel_qkv_pfend-proj_kernel_qkv_pfstart-4, v19
    global_load_dword v74, v20, s[74:75]
    v_add_u32 v19, 8192, v19
    v_min_u32 v20, proj_kernel_qkv_pfend-proj_kernel_qkv_pfstart-4, v19
    global_load_dword v74, v20, s[74:75]
proj_kernel_qkv_pfstart:
    s_waitcnt lgkmcnt(0)
    s_mov_b32 s28, s4
    s_mov_b32 s29, s5
    s_mov_b32 s30, 4194304
    s_mov_b32 s31, 0x20000
    s_lshl_b32 s68, s20, 8
    s_lshl_b32 s69, s21, 3
    s_add_u32 s68, s68, s69
    s_lshl_b32 s69, s22, 1
    s_add_u32 s68, s68, s69
    s_lshl_b32 s69, s68, 11
    v_lshlrev_b32 v18, 4, v0
    buffer_load_dwordx4 v[28:31], v18, s[28:31], s69 offen offset:0
    buffer_load_dwordx4 v[32:35], v18, s[28:31], s69 offen offset:1024
    buffer_load_dwordx4 v[36:39], v18, s[28:31], s69 offen offset:2048
    buffer_load_dwordx4 v[40:43], v18, s[28:31], s69 offen offset:3072
    s_lshl_b32 s66, s68, 3
    s_mov_b32 s32, s6
    s_mov_b32 s33, s7
    s_nop 0
    s_mov_b32 s34, 2097152
    s_mov_b32 s35, 0x20000
    s_add_u32 s36, s6, 256
    s_addc_u32 s37, s7, 0
    s_mov_b32 s38, 2096896
    s_mov_b32 s39, 0x20000
    s_sub_u32 s25, s21, 28
    s_lshl_b32 s67, s25, 9
    s_cmp_ge_u32 s22, 2
    s_cselect_b32 s44, s10, s8
    s_cselect_b32 s45, s11, s9
    s_mov_b32 s46, 65536
    s_mov_b32 s47, 0x20000
    s_add_u32 s48, s18, 29626368
    s_addc_u32 s49, s19, 0
    s_mov_b32 s50, 20480
    s_mov_b32 s51, 0x20000
    s_or_b32 s68, s2, s22
    s_cmp_eq_u32 s68, 0
    s_cbranch_scc0 proj_kernel_qkv_nozero
    v_lshrrev_b32 v21, 2, v0
    v_lshlrev_b32 v21, 8, v21
    v_and_b32_e64 v20, 3, v0
    v_lshl_add_u32 v21, v20, 4, v21
    v_mov_b32 v60, 0
    v_mov_b32 v61, 0
    v_mov_b32 v62, 0
    v_mov_b32 v63, 0
    s_mov_b32 s68, 16384
    buffer_store_dwordx4 v[60:63], v21, s[48:51], s68 offen
proj_kernel_qkv_nozero:
    s_mov_b32 s52, 65536
    v_lshrrev_b32 v19, 4, v0
    v_and_b32 v20, 15, v0
    s_and_b32 s70, s22, 1
    s_lshl_b32 s70, s70, 2
    v_or_b32 v21, s70, v19
    v_lshrrev_b32 v22, 1, v20
    v_xor_b32 v22, v22, v21
    v_lshlrev_b32 v22, 5, v22
    v_and_b32_e64 v21, 1, v20
    v_lshl_add_u32 v22, v21, 4, v22
    s_lshl_b32 s69, s22, 3
    v_add_u32 v21, s69, v19
    v_mul_u32_u24 v21, 2048, v21
    v_add3_u32 v1, v21, v22, s67
    v_add_u32 v2, 7168, v1
    v_lshrrev_b32 v19, 3, v0
    v_and_b32 v20, 7, v0
    s_lshl_b32 s68, s20, 8
    s_lshl_b32 s69, s25, 5
    s_lshl_b32 s70, s22, 5
    s_add_u32 s70, s70, 0
    v_add_u32_e64 v21, s70, v19
    v_bfe_u32 v22, v21, 1, 3
    v_xor_b32 v22, v22, v20
    v_xor_b32 v21, s69, v21
    v_add_u32 v21, s68, v21
    v_lshlrev_b32 v21, 11, v21
    v_lshl_add_u32 v21, v22, 4, v21
    v_mov_b32 v3, v21
    s_lshl_b32 s70, s22, 5
    s_add_u32 s70, s70, 8
    v_add_u32 v21, s70, v19
    v_bfe_u32 v22, v21, 1, 3
    v_xor_b32 v22, v22, v20
    v_xor_b32 v21, s69, v21
    v_add_u32 v21, s68, v21
    v_lshlrev_b32 v21, 11, v21
    v_lshl_add_u32 v21, v22, 4, v21
    v_subrev_u32 v4, 1024, v21
    s_lshl_b32 s70, s22, 5
    s_add_u32 s70, s70, 16
    v_add_u32_e64 v21, s70, v19
    v_bfe_u32 v22, v21, 1, 3
    v_xor_b32 v22, v22, v20
    v_xor_b32 v21, s69, v21
    v_add_u32 v21, s68, v21
    v_lshlrev_b32 v21, 11, v21
    v_lshl_add_u32 v21, v22, 4, v21
    v_subrev_u32 v5, 2048, v21
    s_lshl_b32 s70, s22, 5
    s_add_u32 s70, s70, 24
    v_add_u32_e64 v21, s70, v19
    v_bfe_u32 v22, v21, 1, 3
    v_xor_b32 v22, v22, v20
    v_xor_b32 v21, s69, v21
    v_add_u32 v21, s68, v21
    v_lshlrev_b32 v21, 11, v21
    v_lshl_add_u32 v21, v22, 4, v21
    v_subrev_u32 v6, 3072, v21
    v_lshrrev_b32 v19, 2, v0
    v_and_b32 v20, 3, v0
    v_bfe_u32 v21, v0, 5, 1
    v_lshlrev_b32 v21, 1, v21
    v_xor_b32 v20, v20, v21
    s_and_b32 s70, s22, 1
    s_lshl_b32 s70, s70, 10
    v_lshlrev_b32_e64 v19, 6, v19
    v_lshl_add_u32 v19, v20, 4, v19
    v_add_u32 v23, s70, v19
    s_lshl_b32 s64, s22, 10
    s_add_u32 s64, s64, 49152
    s_lshl_b32 s59, s22, 11
    s_lshl_b32 s60, s22, 12
    s_add_u32 s60, s60, 65536
    s_mov_b32 s58, 0
    s_mov_b32 s54, 0
    s_add_u32 s72, s58, s60
    s_mov_b32 m0, s72
    s_nop 0
    s_nop 0
    buffer_load_dwordx4 v3, s[28:31], s54 offen offset:0 lds
    buffer_load_dwordx4 v4, s[28:31], s54 offen offset:1024 lds
    buffer_load_dwordx4 v5, s[28:31], s54 offen offset:2048 lds
    buffer_load_dwordx4 v6, s[28:31], s54 offen offset:3072 lds
    s_mov_b32 s56, 0
    s_mov_b32 s53, 0
    s_mov_b32 s63, 0
    s_add_u32 m0, s56, s59
    s_nop 0
    s_nop 0
    buffer_load_dwordx4 v1, s[32:35], s53 offen offset:0 lds
    buffer_load_dwordx4 v2, s[32:35], s53 offen offset:1024 lds
    s_add_u32 m0, m0, 8192
    s_nop 0
    buffer_load_dwordx4 v1, s[36:39], s53 offen offset:0 lds
    buffer_load_dwordx4 v2, s[36:39], s53 offen offset:1024 lds
    s_lshr_b32 s72, s56, 2
    s_add_u32 m0, s72, s64
    s_nop 0
    buffer_load_dwordx4 v23, s[44:47], s63 offen lds
    s_mov_b32 s58, 0
    s_mov_b32 s54, 262144
    s_add_u32 s72, s58, s60
    s_add_u32 m0, s72, 16384
    s_nop 0
    s_nop 0
    buffer_load_dwordx4 v3, s[28:31], s54 offen offset:0 lds
    buffer_load_dwordx4 v4, s[28:31], s54 offen offset:1024 lds
    buffer_load_dwordx4 v5, s[28:31], s54 offen offset:2048 lds
    buffer_load_dwordx4 v6, s[28:31], s54 offen offset:3072 lds
    s_mov_b32 s56, 16384
    s_mov_b32 s53, 65536
    s_mov_b32 s63, 2048
    s_add_u32 m0, s56, s59
    s_nop 0
    buffer_load_dwordx4 v1, s[32:35], s53 offen offset:0 lds
    buffer_load_dwordx4 v2, s[32:35], s53 offen offset:1024 lds
    s_add_u32 m0, m0, 8192
    s_nop 0
    buffer_load_dwordx4 v1, s[36:39], s53 offen offset:0 lds
    buffer_load_dwordx4 v2, s[36:39], s53 offen offset:1024 lds
    s_lshr_b32 s72, s56, 2
    s_add_u32 m0, s72, s64
    s_nop 0
    buffer_load_dwordx4 v23, s[44:47], s63 offen lds
    s_mov_b32 s58, 32768
    s_mov_b32 s54, 128
    s_add_u32 s72, s58, s60
    s_mov_b32 m0, s72
    s_nop 0
    s_nop 0
    buffer_load_dwordx4 v3, s[28:31], s54 offen offset:0 lds
    buffer_load_dwordx4 v4, s[28:31], s54 offen offset:1024 lds
    buffer_load_dwordx4 v5, s[28:31], s54 offen offset:2048 lds
    buffer_load_dwordx4 v6, s[28:31], s54 offen offset:3072 lds
    s_mov_b32 s58, 32768
    s_mov_b32 s54, 262272
    s_add_u32 s72, s58, s60
    s_add_u32 m0, s72, 16384
    s_nop 0
    buffer_load_dwordx4 v3, s[28:31], s54 offen offset:0 lds
    buffer_load_dwordx4 v4, s[28:31], s54 offen offset:1024 lds
    buffer_load_dwordx4 v5, s[28:31], s54 offen offset:2048 lds
    buffer_load_dwordx4 v6, s[28:31], s54 offen offset:3072 lds
    s_mov_b32 s56, 32768
    s_mov_b32 s53, 131072
    s_mov_b32 s63, 4096
    s_add_u32 m0, s56, s59
    s_nop 0
    buffer_load_dwordx4 v1, s[32:35], s53 offen offset:0 lds
    buffer_load_dwordx4 v2, s[32:35], s53 offen offset:1024 lds
    s_add_u32 m0, m0, 8192
    s_nop 0
    buffer_load_dwordx4 v1, s[36:39], s53 offen offset:0 lds
    buffer_load_dwordx4 v2, s[36:39], s53 offen offset:1024 lds
    s_lshr_b32 s72, s56, 2
    s_add_u32 m0, s72, s64
    s_nop 0
    buffer_load_dwordx4 v23, s[44:47], s63 offen lds
    v_and_b32 v19, 15, v0
    s_lshl_b32 s71, s20, 8
    s_lshl_b32 s72, s23, 7
    s_add_u32 s71, s71, s72
    v_add_u32 v19, s71, v19
    v_lshlrev_b32 v70, 3, v19
    s_xor_b32 s76, s25, 0
    s_lshl_b32 s76, s76, 8
    s_xor_b32 s77, s25, 1
    s_lshl_b32 s77, s77, 8
    s_xor_b32 s78, s25, 2
    s_lshl_b32 s78, s78, 8
    s_xor_b32 s79, s25, 3
    s_lshl_b32 s79, s79, 8
    v_lshrrev_b32_e64 v19, 4, v0
    v_bfe_u32 v20, v0, 2, 2
    v_and_b32_e64 v21, 1, v19
    v_lshl_or_b32 v22, v21, 2, v20
    v_lshl_add_u32 v19, v19, 3, v20
    v_and_b32 v20, 3, v0
    v_lshlrev_b32 v24, 6, v19
    v_lshl_add_u32 v24, v20, 3, v24
    v_lshl_add_u32 v24, v21, 5, v24
    s_lshl_b32 s68, s24, 11
    s_add_u32 s68, s68, 49152
    v_add_u32 v24, s68, v24
    v_lshlrev_b32_e64 v19, 8, v19
    v_lshl_add_u32 v19, v20, 3, v19
    s_lshl_b32 s68, s24, 2
    s_add_u32 s69, s68, 0
    v_xor_b32_e64 v21, s69, v22
    v_lshl_add_u32 v7, v21, 5, v19
    s_add_u32 s69, s68, 1
    v_xor_b32 v21, s69, v22
    v_lshl_add_u32 v8, v21, 5, v19
    s_add_u32 s69, s68, 2
    v_xor_b32 v21, s69, v22
    v_lshl_add_u32 v9, v21, 5, v19
    s_add_u32 s69, s68, 3
    v_xor_b32 v21, s69, v22
    v_lshl_add_u32 v10, v21, 5, v19
    v_and_b32 v19, 15, v0
    v_lshrrev_b32 v20, 4, v0
    v_lshrrev_b32 v21, 1, v19
    v_xor_b32_e64 v21, v21, v20
    s_lshl_b32 s68, s23, 14
    s_add_u32 s68, s68, 65536
    v_lshlrev_b32 v19, 7, v19
    v_add_u32 v19, s68, v19
    v_lshl_add_u32 v15, v21, 4, v19
    v_xor_b32_e64 v21, 4, v21
    v_lshl_add_u32 v16, v21, 4, v19
    v_mov_b32_e64 v19, s65
    v_accvgpr_write_b32 a128, v19
    v_accvgpr_write_b32 a129, v19
    v_accvgpr_write_b32 a130, v19
    v_accvgpr_write_b32 a131, v19
    s_waitcnt vmcnt(31)
    s_nop 0
    s_mov_b32 s68, 0xffff0000
    s_mov_b32 s69, 0x3a800000
    s_mov_b32 s70, 0x3727c5ac
    v_lshlrev_b32 v82, 16, v28
    v_lshlrev_b32 v98, 16, v36
    v_and_b32 v83, s68, v28
    v_and_b32 v99, s68, v36
    v_lshlrev_b32 v84, 16, v29
    v_lshlrev_b32 v100, 16, v37
    v_and_b32 v85, s68, v29
    v_and_b32 v101, s68, v37
    v_lshlrev_b32 v86, 16, v30
    v_lshlrev_b32 v102, 16, v38
    v_and_b32 v87, s68, v30
    v_and_b32 v103, s68, v38
    v_lshlrev_b32 v88, 16, v31
    v_lshlrev_b32 v104, 16, v39
    v_and_b32 v89, s68, v31
    v_and_b32 v105, s68, v39
    v_lshlrev_b32 v90, 16, v32
    v_lshlrev_b32 v106, 16, v40
    v_and_b32 v91, s68, v32
    v_and_b32 v107, s68, v40
    v_lshlrev_b32 v92, 16, v33
    v_lshlrev_b32 v108, 16, v41
    v_and_b32 v93, s68, v33
    v_and_b32 v109, s68, v41
    v_lshlrev_b32 v94, 16, v34
    v_lshlrev_b32 v110, 16, v42
    v_and_b32 v95, s68, v34
    v_and_b32 v111, s68, v42
    v_lshlrev_b32 v96, 16, v35
    v_lshlrev_b32 v112, 16, v43
    v_and_b32 v97, s68, v35
    v_and_b32 v113, s68, v43
    v_pk_add_f32 v[64:65], v[82:83], v[84:85] op_sel:[0,0] op_sel_hi:[1,1]
    v_pk_add_f32 v[66:67], v[98:99], v[100:101] op_sel:[0,0] op_sel_hi:[1,1]
    v_pk_add_f32 v[64:65], v[64:65], v[86:87] op_sel:[0,0] op_sel_hi:[1,1]
    v_pk_add_f32 v[66:67], v[66:67], v[102:103] op_sel:[0,0] op_sel_hi:[1,1]
    v_pk_add_f32 v[64:65], v[64:65], v[88:89] op_sel:[0,0] op_sel_hi:[1,1]
    v_pk_add_f32 v[66:67], v[66:67], v[104:105] op_sel:[0,0] op_sel_hi:[1,1]
    v_pk_add_f32 v[64:65], v[64:65], v[90:91] op_sel:[0,0] op_sel_hi:[1,1]
    v_pk_add_f32 v[66:67], v[66:67], v[106:107] op_sel:[0,0] op_sel_hi:[1,1]
    v_pk_add_f32 v[64:65], v[64:65], v[92:93] op_sel:[0,0] op_sel_hi:[1,1]
    v_pk_add_f32 v[66:67], v[66:67], v[108:109] op_sel:[0,0] op_sel_hi:[1,1]
    v_pk_add_f32 v[64:65], v[64:65], v[94:95] op_sel:[0,0] op_sel_hi:[1,1]
    v_pk_add_f32 v[66:67], v[66:67], v[110:111] op_sel:[0,0] op_sel_hi:[1,1]
    v_pk_add_f32 v[64:65], v[64:65], v[96:97] op_sel:[0,0] op_sel_hi:[1,1]
    v_pk_add_f32 v[66:67], v[66:67], v[112:113] op_sel:[0,0] op_sel_hi:[1,1]
    v_add_f32 v64, v64, v65
    v_add_f32 v66, v66, v67
    s_nop 0
    s_nop 0
    v_add_f32_dpp v64, v64, v64 quad_perm:[1,0,3,2] row_mask:0xf bank_mask:0xf
    v_add_f32_dpp v66, v66, v66 quad_perm:[1,0,3,2] row_mask:0xf bank_mask:0xf
    s_nop 0
    v_add_f32_dpp v64, v64, v64 quad_perm:[2,3,0,1] row_mask:0xf bank_mask:0xf
    v_add_f32_dpp v66, v66, v66 quad_perm:[2,3,0,1] row_mask:0xf bank_mask:0xf
    s_nop 0
    v_add_f32_dpp v64, v64, v64 row_half_mirror row_mask:0xf bank_mask:0xf
    v_add_f32_dpp v66, v66, v66 row_half_mirror row_mask:0xf bank_mask:0xf
    s_nop 0
    v_add_f32_dpp v64, v64, v64 row_mirror row_mask:0xf bank_mask:0xf
    v_add_f32_dpp v66, v66, v66 row_mirror row_mask:0xf bank_mask:0xf
    v_mov_b32 v68, v64
    v_mov_b32 v69, v66
    s_nop 0
    v_permlane16_swap_b32 v64, v68
    v_permlane16_swap_b32 v66, v69
    s_nop 0
    v_add_f32 v64, v64, v68
    v_add_f32 v66, v66, v69
    v_mov_b32 v68, v64
    v_mov_b32 v69, v66
    s_nop 0
    v_permlane32_swap_b32 v64, v68
    v_permlane32_swap_b32 v66, v69
    s_nop 0
    v_add_f32 v64, v64, v68
    v_add_f32 v66, v66, v69
    v_mul_f32 v60, s69, v64
    v_mul_f32 v62, s69, v66
    v_sub_f32 v60, 0, v60
    v_sub_f32_e64 v62, 0, v62
    v_pk_add_f32 v[82:83], v[82:83], v[60:61] op_sel:[0,0] op_sel_hi:[1,0]
    v_pk_add_f32 v[98:99], v[98:99], v[62:63] op_sel:[0,0] op_sel_hi:[1,0]
    v_pk_add_f32 v[84:85], v[84:85], v[60:61] op_sel:[0,0] op_sel_hi:[1,0]
    v_pk_add_f32 v[100:101], v[100:101], v[62:63] op_sel:[0,0] op_sel_hi:[1,0]
    v_pk_add_f32 v[86:87], v[86:87], v[60:61] op_sel:[0,0] op_sel_hi:[1,0]
    v_pk_add_f32 v[102:103], v[102:103], v[62:63] op_sel:[0,0] op_sel_hi:[1,0]
    v_pk_add_f32 v[88:89], v[88:89], v[60:61] op_sel:[0,0] op_sel_hi:[1,0]
    v_pk_add_f32 v[104:105], v[104:105], v[62:63] op_sel:[0,0] op_sel_hi:[1,0]
    v_pk_add_f32 v[90:91], v[90:91], v[60:61] op_sel:[0,0] op_sel_hi:[1,0]
    v_pk_add_f32 v[106:107], v[106:107], v[62:63] op_sel:[0,0] op_sel_hi:[1,0]
    v_pk_add_f32 v[92:93], v[92:93], v[60:61] op_sel:[0,0] op_sel_hi:[1,0]
    v_pk_add_f32 v[108:109], v[108:109], v[62:63] op_sel:[0,0] op_sel_hi:[1,0]
    v_pk_add_f32 v[94:95], v[94:95], v[60:61] op_sel:[0,0] op_sel_hi:[1,0]
    v_pk_add_f32 v[110:111], v[110:111], v[62:63] op_sel:[0,0] op_sel_hi:[1,0]
    v_pk_add_f32 v[96:97], v[96:97], v[60:61] op_sel:[0,0] op_sel_hi:[1,0]
    v_pk_add_f32 v[112:113], v[112:113], v[62:63] op_sel:[0,0] op_sel_hi:[1,0]
    v_pk_mul_f32 v[64:65], v[82:83], v[82:83] op_sel:[0,0] op_sel_hi:[1,1]
    v_pk_mul_f32 v[66:67], v[98:99], v[98:99] op_sel:[0,0] op_sel_hi:[1,1]
    v_pk_fma_f32 v[64:65], v[84:85], v[84:85], v[64:65] op_sel:[0,0,0] op_sel_hi:[1,1,1]
    v_pk_fma_f32 v[66:67], v[100:101], v[100:101], v[66:67] op_sel:[0,0,0] op_sel_hi:[1,1,1]
    v_pk_fma_f32 v[64:65], v[86:87], v[86:87], v[64:65] op_sel:[0,0,0] op_sel_hi:[1,1,1]
    v_pk_fma_f32 v[66:67], v[102:103], v[102:103], v[66:67] op_sel:[0,0,0] op_sel_hi:[1,1,1]
    v_pk_fma_f32 v[64:65], v[88:89], v[88:89], v[64:65] op_sel:[0,0,0] op_sel_hi:[1,1,1]
    v_pk_fma_f32 v[66:67], v[104:105], v[104:105], v[66:67] op_sel:[0,0,0] op_sel_hi:[1,1,1]
    v_pk_fma_f32 v[64:65], v[90:91], v[90:91], v[64:65] op_sel:[0,0,0] op_sel_hi:[1,1,1]
    v_pk_fma_f32 v[66:67], v[106:107], v[106:107], v[66:67] op_sel:[0,0,0] op_sel_hi:[1,1,1]
    v_pk_fma_f32 v[64:65], v[92:93], v[92:93], v[64:65] op_sel:[0,0,0] op_sel_hi:[1,1,1]
    v_pk_fma_f32 v[66:67], v[108:109], v[108:109], v[66:67] op_sel:[0,0,0] op_sel_hi:[1,1,1]
    v_pk_fma_f32 v[64:65], v[94:95], v[94:95], v[64:65] op_sel:[0,0,0] op_sel_hi:[1,1,1]
    v_pk_fma_f32 v[66:67], v[110:111], v[110:111], v[66:67] op_sel:[0,0,0] op_sel_hi:[1,1,1]
    v_pk_fma_f32 v[64:65], v[96:97], v[96:97], v[64:65] op_sel:[0,0,0] op_sel_hi:[1,1,1]
    v_pk_fma_f32 v[66:67], v[112:113], v[112:113], v[66:67] op_sel:[0,0,0] op_sel_hi:[1,1,1]
    v_add_f32 v64, v64, v65
    v_add_f32 v66, v66, v67
    s_nop 0
    s_nop 0
    v_add_f32_dpp v64, v64, v64 quad_perm:[1,0,3,2] row_mask:0xf bank_mask:0xf
    v_add_f32_dpp v66, v66, v66 quad_perm:[1,0,3,2] row_mask:0xf bank_mask:0xf
    s_nop 0
    v_add_f32_dpp v64, v64, v64 quad_perm:[2,3,0,1] row_mask:0xf bank_mask:0xf
    v_add_f32_dpp v66, v66, v66 quad_perm:[2,3,0,1] row_mask:0xf bank_mask:0xf
    s_nop 0
    v_add_f32_dpp v64, v64, v64 row_half_mirror row_mask:0xf bank_mask:0xf
    v_add_f32_dpp v66, v66, v66 row_half_mirror row_mask:0xf bank_mask:0xf
    s_nop 0
    v_add_f32_dpp v64, v64, v64 row_mirror row_mask:0xf bank_mask:0xf
    v_add_f32_dpp v66, v66, v66 row_mirror row_mask:0xf bank_mask:0xf
    v_mov_b32 v68, v64
    v_mov_b32 v69, v66
    s_nop 0
    v_permlane16_swap_b32 v64, v68
    v_permlane16_swap_b32 v66, v69
    s_nop 0
    v_add_f32 v64, v64, v68
    v_add_f32 v66, v66, v69
    v_mov_b32 v68, v64
    v_mov_b32 v69, v66
    s_nop 0
    v_permlane32_swap_b32 v64, v68
    v_permlane32_swap_b32 v66, v69
    s_nop 0
    v_add_f32 v64, v64, v68
    v_add_f32 v66, v66, v69
    v_mov_b32 v61, s70
    v_mov_b32 v63, s70
    v_fmac_f32 v61, s69, v64
    v_fmac_f32 v63, s69, v66
    v_mov_b32 v19, s66
    v_cmp_eq_u32 vcc, 0, v0
    s_and_saveexec_b64 s[4:5], vcc
    buffer_store_dwordx4 v[60:63], v19, s[48:51], 0 offen sc0 sc1
    s_mov_b64 exec, s[4:5]
    s_waitcnt vmcnt(19)
    s_barrier
    v_mov_b32 v25, v24
    v_xor_b32_e64 v26, 32, v24
    ds_read_b128 a[48:51], v15 offset:0
    ds_read_b64_tr_b16 v[28:29], v7 offset:0
    ds_read_b64_tr_b16 v[30:31], v7 offset:1024
    ds_read_b64_tr_b16 v[44:45], v7 offset:8192
    ds_read_b64_tr_b16 v[46:47], v7 offset:9216
    ds_read_b64_tr_b16 v[32:33], v8 offset:0
    ds_read_b64_tr_b16 v[34:35], v8 offset:1024
    ds_read_b64_tr_b16 v[48:49], v8 offset:8192
    ds_read_b64_tr_b16 v[50:51], v8 offset:9216
    ds_read_b64_tr_b16 v[36:37], v9 offset:0
    ds_read_b64_tr_b16 v[38:39], v9 offset:1024
    ds_read_b64_tr_b16 v[52:53], v9 offset:8192
    ds_read_b64_tr_b16 v[54:55], v9 offset:9216
    ds_read_b64_tr_b16 v[40:41], v10 offset:0
    ds_read_b64_tr_b16 v[42:43], v10 offset:1024
    ds_read_b64_tr_b16 v[56:57], v10 offset:8192
    ds_read_b64_tr_b16 v[58:59], v10 offset:9216
    ds_read_b64_tr_b16 a[32:33], v25
    ds_read_b64_tr_b16 a[34:35], v25 offset:256
    ds_read_b64_tr_b16 a[36:37], v26
    ds_read_b64_tr_b16 a[38:39], v26 offset:256
    ds_read_b128 a[52:55], v15 offset:2048
    ds_read_b128 a[56:59], v15 offset:4096
    ds_read_b128 a[60:63], v15 offset:6144
    ds_read_b128 a[64:67], v15 offset:8192
    ds_read_b128 a[68:71], v15 offset:10240
    ds_read_b128 a[72:75], v15 offset:12288
    ds_read_b128 a[76:79], v15 offset:14336
    s_waitcnt vmcnt(14) lgkmcnt(0)
    s_barrier
    s_mov_b32 s55, 16384
    s_mov_b32 s56, 0
    s_mov_b32 s53, 196608
    s_mov_b32 s63, 6144
    s_mov_b32 s57, 0
    s_mov_b32 s58, 65536
    s_mov_b32 s54, 262400
    s_mov_b32 s61, 16
    s_cmp_eq_u32 s22, 0
    s_cselect_b32 s62, 32780, 12
    v_add_u32 v11, s55, v7
    v_add_u32 v12, s55, v8
    v_add_u32 v13, s55, v9
    v_add_u32 v14, s55, v10
    v_add_u32 v17, s57, v16
    s_lshr_b32 s71, s55, 2
    v_add_u32 v25, s71, v24
    v_xor_b32 v26, 32, v25
    s_cmp_eq_u32 s23, 0
    s_cbranch_scc0 proj_kernel_qkv_first1
proj_kernel_qkv_first0:
    v_mfma_f32_16x16x32_bf16 v[74:77], v[28:31], a[48:51], 0
    ds_read_b128 a[80:83], v17 offset:0
    s_mov_b32 s58, 65536
    v_mfma_f32_16x16x32_bf16 v[78:81], v[32:35], a[48:51], 0
    s_mov_b32 s54, 256
    v_mfma_f32_16x16x32_bf16 v[82:85], v[36:39], a[48:51], 0
    ds_read_b64_tr_b16 a[0:1], v11 offset:0
    v_mfma_f32_16x16x32_bf16 v[86:89], v[40:43], a[48:51], 0
    s_add_u32 s72, s58, s60
    v_mfma_f32_16x16x32_bf16 v[90:93], v[44:47], a[48:51], 0
    ds_read_b64_tr_b16 a[2:3], v11 offset:1024
    s_mov_b32 m0, s72
    v_mfma_f32_16x16x32_bf16 v[94:97], v[48:51], a[48:51], 0
    v_mfma_f32_16x16x32_bf16 v[98:101], v[52:55], a[48:51], 0
    ds_read_b64_tr_b16 a[16:17], v11 offset:8192
    s_nop 0
    v_mfma_f32_16x16x32_bf16 v[102:105], v[56:59], a[48:51], 0
    v_mfma_f32_16x16x32_bf16 a[232:235], a[32:35], a[48:51], 0
    ds_read_b64_tr_b16 a[18:19], v11 offset:9216
    buffer_load_dwordx4 v3, s[28:31], s54 offen offset:0 lds
    v_mfma_f32_16x16x32_bf16 a[240:243], a[36:39], a[48:51], 0
    buffer_load_dwordx4 v4, s[28:31], s54 offen offset:1024 lds
    v_mfma_f32_16x16x32_bf16 v[106:109], v[28:31], a[52:55], 0
    v_mfma_f32_16x16x32_bf16 v[110:113], v[32:35], a[52:55], 0
    ds_read_b64_tr_b16 a[4:5], v12 offset:0
    buffer_load_dwordx4 v5, s[28:31], s54 offen offset:2048 lds
    v_mfma_f32_16x16x32_bf16 v[114:117], v[36:39], a[52:55], 0
    buffer_load_dwordx4 v6, s[28:31], s54 offen offset:3072 lds
    v_mfma_f32_16x16x32_bf16 v[118:121], v[40:43], a[52:55], 0
    ds_read_b64_tr_b16 a[6:7], v12 offset:1024
    v_mfma_f32_16x16x32_bf16 v[122:125], v[44:47], a[52:55], 0
    s_mov_b32 s54, 262400
    v_mfma_f32_16x16x32_bf16 v[126:129], v[48:51], a[52:55], 0
    ds_read_b64_tr_b16 a[20:21], v12 offset:8192
    v_mfma_f32_16x16x32_bf16 v[130:133], v[52:55], a[52:55], 0
    s_add_u32 m0, s56, s59
    v_mfma_f32_16x16x32_bf16 v[134:137], v[56:59], a[52:55], 0
    ds_read_b64_tr_b16 a[22:23], v12 offset:9216
    s_nop 0
    v_mfma_f32_16x16x32_bf16 a[236:239], a[32:35], a[52:55], 0
    v_mfma_f32_16x16x32_bf16 a[244:247], a[36:39], a[52:55], 0
    ds_read_b64_tr_b16 a[8:9], v13 offset:0
    buffer_load_dwordx4 v1, s[32:35], s53 offen offset:0 lds
    v_mfma_f32_16x16x32_bf16 v[138:141], v[28:31], a[56:59], 0
    buffer_load_dwordx4 v2, s[32:35], s53 offen offset:1024 lds
    v_mfma_f32_16x16x32_bf16 v[142:145], v[32:35], a[56:59], 0
    v_mfma_f32_16x16x32_bf16 v[146:149], v[36:39], a[56:59], 0
    ds_read_b64_tr_b16 a[10:11], v13 offset:1024
    s_add_u32 m0, m0, 8192
    v_mfma_f32_16x16x32_bf16 v[150:153], v[40:43], a[56:59], 0
    v_mfma_f32_16x16x32_bf16 v[154:157], v[44:47], a[56:59], 0
    ds_read_b64_tr_b16 a[24:25], v13 offset:8192
    s_nop 0
    v_mfma_f32_16x16x32_bf16 v[158:161], v[48:51], a[56:59], 0
    buffer_load_dwordx4 v1, s[36:39], s53 offen offset:0 lds
    v_mfma_f32_16x16x32_bf16 v[162:165], v[52:55], a[56:59], 0
    ds_read_b64_tr_b16 a[26:27], v13 offset:9216
    v_mfma_f32_16x16x32_bf16 v[166:169], v[56:59], a[56:59], 0
    buffer_load_dwordx4 v2, s[36:39], s53 offen offset:1024 lds
    v_mfma_f32_16x16x32_bf16 a[132:135], v[28:31], a[128:131], 0
    ds_read_b64_tr_b16 a[12:13], v14 offset:0
    s_lshr_b32 s72, s56, 2
    v_mfma_f32_16x16x32_bf16 v[170:173], v[28:31], a[60:63], 0
    v_mfma_f32_16x16x32_bf16 v[174:177], v[32:35], a[60:63], 0
    s_add_u32 m0, s72, s64
    v_mfma_f32_16x16x32_bf16 v[178:181], v[36:39], a[60:63], 0
    ds_read_b64_tr_b16 a[14:15], v14 offset:1024
    v_mfma_f32_16x16x32_bf16 v[182:185], v[40:43], a[60:63], 0
    s_nop 0
    v_mfma_f32_16x16x32_bf16 v[186:189], v[44:47], a[60:63], 0
    ds_read_b64_tr_b16 a[28:29], v14 offset:8192
    buffer_load_dwordx4 v23, s[44:47], s63 offen lds
    v_mfma_f32_16x16x32_bf16 v[190:193], v[48:51], a[60:63], 0
    v_mfma_f32_16x16x32_bf16 v[194:197], v[52:55], a[60:63], 0
    ds_read_b64_tr_b16 a[30:31], v14 offset:9216
    s_add_u32 s63, s63, 2048
    v_mfma_f32_16x16x32_bf16 v[198:201], v[56:59], a[60:63], 0
    s_add_u32 s53, s53, s52
    v_mfma_f32_16x16x32_bf16 a[136:139], v[32:35], a[128:131], 0
    ds_read_b64_tr_b16 a[40:41], v25
    v_mfma_f32_16x16x32_bf16 v[202:205], v[28:31], a[64:67], 0
    s_mov_b32 s56, s55
    v_mfma_f32_16x16x32_bf16 v[206:209], v[32:35], a[64:67], 0
    ds_read_b64_tr_b16 a[42:43], v25 offset:256
    v_mfma_f32_16x16x32_bf16 v[210:213], v[36:39], a[64:67], 0
    s_add_u32 s55, s55, 16384
    v_mfma_f32_16x16x32_bf16 v[214:217], v[40:43], a[64:67], 0
    s_cmp_eq_u32 s55, 49152
    v_mfma_f32_16x16x32_bf16 v[218:221], v[44:47], a[64:67], 0
    ds_read_b64_tr_b16 a[44:45], v26
    v_mfma_f32_16x16x32_bf16 v[222:225], v[48:51], a[64:67], 0
    s_cselect_b32 s55, 0, s55
    v_mfma_f32_16x16x32_bf16 v[226:229], v[52:55], a[64:67], 0
    ds_read_b64_tr_b16 a[46:47], v26 offset:256
    s_add_u32 s72, s58, s60
    v_mfma_f32_16x16x32_bf16 v[230:233], v[56:59], a[64:67], 0
    v_mfma_f32_16x16x32_bf16 a[140:143], v[36:39], a[128:131], 0
    ds_read_b128 a[84:87], v17 offset:2048
    s_add_u32 m0, s72, 16384
    v_mfma_f32_16x16x32_bf16 v[234:237], v[28:31], a[68:71], 0
    v_mfma_f32_16x16x32_bf16 v[238:241], v[32:35], a[68:71], 0
    ds_read_b128 a[88:91], v17 offset:4096
    s_nop 0
    v_mfma_f32_16x16x32_bf16 v[242:245], v[36:39], a[68:71], 0
    buffer_load_dwordx4 v3, s[28:31], s54 offen offset:0 lds
    v_mfma_f32_16x16x32_bf16 v[246:249], v[40:43], a[68:71], 0
    ds_read_b128 a[92:95], v17 offset:6144
    v_mfma_f32_16x16x32_bf16 a[152:155], v[44:47], a[68:71], 0
    buffer_load_dwordx4 v4, s[28:31], s54 offen offset:1024 lds
    v_mfma_f32_16x16x32_bf16 a[156:159], v[48:51], a[68:71], 0
    buffer_load_dwordx4 v5, s[28:31], s54 offen offset:2048 lds
    v_mfma_f32_16x16x32_bf16 a[160:163], v[52:55], a[68:71], 0
    ds_read_b128 a[96:99], v17 offset:8192
    v_mfma_f32_16x16x32_bf16 a[164:167], v[56:59], a[68:71], 0
    buffer_load_dwordx4 v6, s[28:31], s54 offen offset:3072 lds
    v_mfma_f32_16x16x32_bf16 a[144:147], v[40:43], a[128:131], 0
    ds_read_b128 a[100:103], v17 offset:10240
    v_mfma_f32_16x16x32_bf16 a[168:171], v[28:31], a[72:75], 0
    s_add_u32 s54, s54, -262016
    v_mfma_f32_16x16x32_bf16 a[172:175], v[32:35], a[72:75], 0
    ds_read_b128 a[104:107], v17 offset:12288
    s_mov_b32 s58, s57
    v_mfma_f32_16x16x32_bf16 a[176:179], v[36:39], a[72:75], 0
    v_mfma_f32_16x16x32_bf16 a[180:183], v[40:43], a[72:75], 0
    ds_read_b128 a[108:111], v17 offset:14336
    s_and_b32 s71, s54, 0x3ffff
    v_mfma_f32_16x16x32_bf16 a[184:187], v[44:47], a[72:75], 0
    s_cmp_ge_u32 s71, 2048
    v_mfma_f32_16x16x32_bf16 a[188:191], v[48:51], a[72:75], 0
    v_mfma_f32_16x16x32_bf16 a[192:195], v[52:55], a[72:75], 0
    s_cselect_b32 s54, 0x40000000, s54
    v_mfma_f32_16x16x32_bf16 a[196:199], v[56:59], a[72:75], 0
    v_mfma_f32_16x16x32_bf16 a[148:151], a[32:35], a[128:131], 0
    s_add_u32 s57, s57, 32768
    v_mfma_f32_16x16x32_bf16 a[200:203], v[28:31], a[76:79], 0
    s_cmp_eq_u32 s57, 98304
    v_mfma_f32_16x16x32_bf16 a[204:207], v[32:35], a[76:79], 0
    v_mfma_f32_16x16x32_bf16 a[208:211], v[36:39], a[76:79], 0
    s_cselect_b32 s57, 0, s57
    v_add_u32 v11, s55, v7
    v_mfma_f32_16x16x32_bf16 a[212:215], v[40:43], a[76:79], 0
    v_add_u32_e64 v12, s55, v8
    v_mfma_f32_16x16x32_bf16 a[216:219], v[44:47], a[76:79], 0
    v_add_u32_e64 v13, s55, v9
    v_mfma_f32_16x16x32_bf16 a[220:223], v[48:51], a[76:79], 0
    v_add_u32_e64 v14, s55, v10
    v_mfma_f32_16x16x32_bf16 a[224:227], v[52:55], a[76:79], 0
    v_add_u32_e64 v17, s57, v15
    v_mfma_f32_16x16x32_bf16 a[228:231], v[56:59], a[76:79], 0
    s_lshr_b32 s71, s55, 2
    v_add_u32 v25, s71, v24
    v_xor_b32 v26, 32, v25
    s_waitcnt vmcnt(14) lgkmcnt(0)
    s_barrier
    s_branch proj_kernel_qkv_mid0
proj_kernel_qkv_loop0:
    s_bitcmp1_b32 s62, s61
    s_cbranch_scc1 proj_kernel_qkv_event
proj_kernel_qkv_resume0:
    v_mfma_f32_16x16x32_bf16 v[74:77], v[28:31], a[48:51], v[74:77]
    ds_read_b128 a[80:83], v17 offset:0
    s_add_u32 m0, s56, s59
    v_mfma_f32_16x16x32_bf16 v[78:81], v[32:35], a[48:51], v[78:81]
    v_mfma_f32_16x16x32_bf16 v[82:85], v[36:39], a[48:51], v[82:85]
    ds_read_b64_tr_b16 a[0:1], v11 offset:0
    s_nop 0
    v_mfma_f32_16x16x32_bf16 v[86:89], v[40:43], a[48:51], v[86:89]
    v_mfma_f32_16x16x32_bf16 v[90:93], v[44:47], a[48:51], v[90:93]
    ds_read_b64_tr_b16 a[2:3], v11 offset:1024
    buffer_load_dwordx4 v1, s[32:35], s53 offen offset:0 lds
    v_mfma_f32_16x16x32_bf16 v[94:97], v[48:51], a[48:51], v[94:97]
    v_mfma_f32_16x16x32_bf16 v[98:101], v[52:55], a[48:51], v[98:101]
    ds_read_b64_tr_b16 a[16:17], v11 offset:8192
    buffer_load_dwordx4 v2, s[32:35], s53 offen offset:1024 lds
    v_mfma_f32_16x16x32_bf16 v[102:105], v[56:59], a[48:51], v[102:105]
    v_mfma_f32_16x16x32_bf16 a[232:235], a[32:35], a[48:51], a[232:235]
    ds_read_b64_tr_b16 a[18:19], v11 offset:9216
    s_add_u32 m0, m0, 8192
    v_mfma_f32_16x16x32_bf16 a[240:243], a[36:39], a[48:51], a[240:243]
    v_mfma_f32_16x16x32_bf16 v[106:109], v[28:31], a[52:55], v[106:109]
    s_nop 0
    v_mfma_f32_16x16x32_bf16 v[110:113], v[32:35], a[52:55], v[110:113]
    ds_read_b64_tr_b16 a[4:5], v12 offset:0
    v_mfma_f32_16x16x32_bf16 v[114:117], v[36:39], a[52:55], v[114:117]
    buffer_load_dwordx4 v1, s[36:39], s53 offen offset:0 lds
    v_mfma_f32_16x16x32_bf16 v[118:121], v[40:43], a[52:55], v[118:121]
    ds_read_b64_tr_b16 a[6:7], v12 offset:1024
    v_mfma_f32_16x16x32_bf16 v[122:125], v[44:47], a[52:55], v[122:125]
    buffer_load_dwordx4 v2, s[36:39], s53 offen offset:1024 lds
    v_mfma_f32_16x16x32_bf16 v[126:129], v[48:51], a[52:55], v[126:129]
    ds_read_b64_tr_b16 a[20:21], v12 offset:8192
    v_mfma_f32_16x16x32_bf16 v[130:133], v[52:55], a[52:55], v[130:133]
    s_lshr_b32 s72, s56, 2
    v_mfma_f32_16x16x32_bf16 v[134:137], v[56:59], a[52:55], v[134:137]
    ds_read_b64_tr_b16 a[22:23], v12 offset:9216
    v_mfma_f32_16x16x32_bf16 a[236:239], a[32:35], a[52:55], a[236:239]
    s_add_u32 m0, s72, s64
    v_mfma_f32_16x16x32_bf16 a[244:247], a[36:39], a[52:55], a[244:247]
    ds_read_b64_tr_b16 a[8:9], v13 offset:0
    v_mfma_f32_16x16x32_bf16 v[138:141], v[28:31], a[56:59], v[138:141]
    s_nop 0
    v_mfma_f32_16x16x32_bf16 v[142:145], v[32:35], a[56:59], v[142:145]
    v_mfma_f32_16x16x32_bf16 v[146:149], v[36:39], a[56:59], v[146:149]
    ds_read_b64_tr_b16 a[10:11], v13 offset:1024
    v_mfma_f32_16x16x32_bf16 v[150:153], v[40:43], a[56:59], v[150:153]
    buffer_load_dwordx4 v23, s[44:47], s63 offen lds
    v_mfma_f32_16x16x32_bf16 v[154:157], v[44:47], a[56:59], v[154:157]
    ds_read_b64_tr_b16 a[24:25], v13 offset:8192
    v_mfma_f32_16x16x32_bf16 v[158:161], v[48:51], a[56:59], v[158:161]
    s_add_u32 s63, s63, 2048
    v_mfma_f32_16x16x32_bf16 v[162:165], v[52:55], a[56:59], v[162:165]
    ds_read_b64_tr_b16 a[26:27], v13 offset:9216
    v_mfma_f32_16x16x32_bf16 v[166:169], v[56:59], a[56:59], v[166:169]
    s_add_u32 s53, s53, s52
    v_mfma_f32_16x16x32_bf16 a[132:135], v[28:31], a[128:131], a[132:135]
    ds_read_b64_tr_b16 a[12:13], v14 offset:0
    v_mfma_f32_16x16x32_bf16 v[170:173], v[28:31], a[60:63], v[170:173]
    s_mov_b32 s56, s55
    v_mfma_f32_16x16x32_bf16 v[174:177], v[32:35], a[60:63], v[174:177]
    v_mfma_f32_16x16x32_bf16 v[178:181], v[36:39], a[60:63], v[178:181]
    ds_read_b64_tr_b16 a[14:15], v14 offset:1024
    s_add_u32 s55, s55, 16384
    v_mfma_f32_16x16x32_bf16 v[182:185], v[40:43], a[60:63], v[182:185]
    v_mfma_f32_16x16x32_bf16 v[186:189], v[44:47], a[60:63], v[186:189]
    ds_read_b64_tr_b16 a[28:29], v14 offset:8192
    s_cmp_eq_u32 s55, 49152
    v_mfma_f32_16x16x32_bf16 v[190:193], v[48:51], a[60:63], v[190:193]
    v_mfma_f32_16x16x32_bf16 v[194:197], v[52:55], a[60:63], v[194:197]
    ds_read_b64_tr_b16 a[30:31], v14 offset:9216
    s_cselect_b32 s55, 0, s55
    v_mfma_f32_16x16x32_bf16 v[198:201], v[56:59], a[60:63], v[198:201]
    v_mfma_f32_16x16x32_bf16 a[136:139], v[32:35], a[128:131], a[136:139]
    ds_read_b64_tr_b16 a[40:41], v25
    s_add_u32 s72, s58, s60
    v_mfma_f32_16x16x32_bf16 v[202:205], v[28:31], a[64:67], v[202:205]
    v_mfma_f32_16x16x32_bf16 v[206:209], v[32:35], a[64:67], v[206:209]
    ds_read_b64_tr_b16 a[42:43], v25 offset:256
    s_add_u32 m0, s72, 16384
    v_mfma_f32_16x16x32_bf16 v[210:213], v[36:39], a[64:67], v[210:213]
    v_mfma_f32_16x16x32_bf16 v[214:217], v[40:43], a[64:67], v[214:217]
    s_nop 0
    v_mfma_f32_16x16x32_bf16 v[218:221], v[44:47], a[64:67], v[218:221]
    ds_read_b64_tr_b16 a[44:45], v26
    v_mfma_f32_16x16x32_bf16 v[222:225], v[48:51], a[64:67], v[222:225]
    buffer_load_dwordx4 v3, s[28:31], s54 offen offset:0 lds
    v_mfma_f32_16x16x32_bf16 v[226:229], v[52:55], a[64:67], v[226:229]
    ds_read_b64_tr_b16 a[46:47], v26 offset:256
    v_mfma_f32_16x16x32_bf16 v[230:233], v[56:59], a[64:67], v[230:233]
    v_mfma_f32_16x16x32_bf16 a[140:143], v[36:39], a[128:131], a[140:143]
    ds_read_b128 a[84:87], v17 offset:2048
    buffer_load_dwordx4 v4, s[28:31], s54 offen offset:1024 lds
    v_mfma_f32_16x16x32_bf16 v[234:237], v[28:31], a[68:71], v[234:237]
    v_mfma_f32_16x16x32_bf16 v[238:241], v[32:35], a[68:71], v[238:241]
    ds_read_b128 a[88:91], v17 offset:4096
    buffer_load_dwordx4 v5, s[28:31], s54 offen offset:2048 lds
    v_mfma_f32_16x16x32_bf16 v[242:245], v[36:39], a[68:71], v[242:245]
    v_mfma_f32_16x16x32_bf16 v[246:249], v[40:43], a[68:71], v[246:249]
    ds_read_b128 a[92:95], v17 offset:6144
    buffer_load_dwordx4 v6, s[28:31], s54 offen offset:3072 lds
    v_mfma_f32_16x16x32_bf16 a[152:155], v[44:47], a[68:71], a[152:155]
    v_mfma_f32_16x16x32_bf16 a[156:159], v[48:51], a[68:71], a[156:159]
    s_add_u32 s54, s54, -262016
    v_mfma_f32_16x16x32_bf16 a[160:163], v[52:55], a[68:71], a[160:163]
    ds_read_b128 a[96:99], v17 offset:8192
    v_mfma_f32_16x16x32_bf16 a[164:167], v[56:59], a[68:71], a[164:167]
    s_mov_b32 s58, s57
    v_mfma_f32_16x16x32_bf16 a[144:147], v[40:43], a[128:131], a[144:147]
    ds_read_b128 a[100:103], v17 offset:10240
    v_mfma_f32_16x16x32_bf16 a[168:171], v[28:31], a[72:75], a[168:171]
    s_and_b32 s71, s54, 0x3ffff
    v_mfma_f32_16x16x32_bf16 a[172:175], v[32:35], a[72:75], a[172:175]
    ds_read_b128 a[104:107], v17 offset:12288
    v_mfma_f32_16x16x32_bf16 a[176:179], v[36:39], a[72:75], a[176:179]
    s_cmp_ge_u32 s71, 2048
    v_mfma_f32_16x16x32_bf16 a[180:183], v[40:43], a[72:75], a[180:183]
    ds_read_b128 a[108:111], v17 offset:14336
    v_mfma_f32_16x16x32_bf16 a[184:187], v[44:47], a[72:75], a[184:187]
    s_cselect_b32 s54, 0x40000000, s54
    v_mfma_f32_16x16x32_bf16 a[188:191], v[48:51], a[72:75], a[188:191]
    v_mfma_f32_16x16x32_bf16 a[192:195], v[52:55], a[72:75], a[192:195]
    s_add_u32 s57, s57, 32768
    v_mfma_f32_16x16x32_bf16 a[196:199], v[56:59], a[72:75], a[196:199]
    v_mfma_f32_16x16x32_bf16 a[148:151], a[32:35], a[128:131], a[148:151]
    s_cmp_eq_u32 s57, 98304
    v_mfma_f32_16x16x32_bf16 a[200:203], v[28:31], a[76:79], a[200:203]
    v_mfma_f32_16x16x32_bf16 a[204:207], v[32:35], a[76:79], a[204:207]
    s_cselect_b32 s57, 0, s57
    v_add_u32_e64 v11, s55, v7
    v_mfma_f32_16x16x32_bf16 a[208:211], v[36:39], a[76:79], a[208:211]
    v_add_u32_e64 v12, s55, v8
    v_mfma_f32_16x16x32_bf16 a[212:215], v[40:43], a[76:79], a[212:215]
    v_add_u32_e64 v13, s55, v9
    v_mfma_f32_16x16x32_bf16 a[216:219], v[44:47], a[76:79], a[216:219]
    v_add_u32_e64 v14, s55, v10
    v_mfma_f32_16x16x32_bf16 a[220:223], v[48:51], a[76:79], a[220:223]
    v_add_u32_e64 v17, s57, v15
    v_mfma_f32_16x16x32_bf16 a[224:227], v[52:55], a[76:79], a[224:227]
    s_lshr_b32 s71, s55, 2
    v_mfma_f32_16x16x32_bf16 a[228:231], v[56:59], a[76:79], a[228:231]
    v_add_u32 v25, s71, v24
    v_xor_b32 v26, 32, v25
    s_waitcnt vmcnt(13) lgkmcnt(0)
    s_barrier
proj_kernel_qkv_mid0:
    v_mfma_f32_16x16x32_bf16 v[74:77], a[0:3], a[80:83], v[74:77]
    ds_read_b128 a[48:51], v17 offset:0
    s_add_u32 m0, s56, s59
    v_mfma_f32_16x16x32_bf16 v[78:81], a[4:7], a[80:83], v[78:81]
    v_mfma_f32_16x16x32_bf16 v[82:85], a[8:11], a[80:83], v[82:85]
    ds_read_b64_tr_b16 v[28:29], v11 offset:0
    s_nop 0
    v_mfma_f32_16x16x32_bf16 v[86:89], a[12:15], a[80:83], v[86:89]
    v_mfma_f32_16x16x32_bf16 v[90:93], a[16:19], a[80:83], v[90:93]
    ds_read_b64_tr_b16 v[30:31], v11 offset:1024
    v_mfma_f32_16x16x32_bf16 v[94:97], a[20:23], a[80:83], v[94:97]
    buffer_load_dwordx4 v1, s[32:35], s53 offen offset:0 lds
    v_mfma_f32_16x16x32_bf16 v[98:101], a[24:27], a[80:83], v[98:101]
    ds_read_b64_tr_b16 v[44:45], v11 offset:8192
    v_mfma_f32_16x16x32_bf16 v[102:105], a[28:31], a[80:83], v[102:105]
    buffer_load_dwordx4 v2, s[32:35], s53 offen offset:1024 lds
    v_mfma_f32_16x16x32_bf16 a[232:235], a[40:43], a[80:83], a[232:235]
    ds_read_b64_tr_b16 v[46:47], v11 offset:9216
    v_mfma_f32_16x16x32_bf16 a[240:243], a[44:47], a[80:83], a[240:243]
    v_mfma_f32_16x16x32_bf16 v[106:109], a[0:3], a[84:87], v[106:109]
    s_add_u32 m0, m0, 8192
    v_mfma_f32_16x16x32_bf16 v[110:113], a[4:7], a[84:87], v[110:113]
    ds_read_b64_tr_b16 v[32:33], v12 offset:0
    v_mfma_f32_16x16x32_bf16 v[114:117], a[8:11], a[84:87], v[114:117]
    v_mfma_f32_16x16x32_bf16 v[118:121], a[12:15], a[84:87], v[118:121]
    ds_read_b64_tr_b16 v[34:35], v12 offset:1024
    s_nop 0
    v_mfma_f32_16x16x32_bf16 v[122:125], a[16:19], a[84:87], v[122:125]
    v_mfma_f32_16x16x32_bf16 v[126:129], a[20:23], a[84:87], v[126:129]
    ds_read_b64_tr_b16 v[48:49], v12 offset:8192
    buffer_load_dwordx4 v1, s[36:39], s53 offen offset:0 lds
    v_mfma_f32_16x16x32_bf16 v[130:133], a[24:27], a[84:87], v[130:133]
    v_mfma_f32_16x16x32_bf16 v[134:137], a[28:31], a[84:87], v[134:137]
    ds_read_b64_tr_b16 v[50:51], v12 offset:9216
    v_mfma_f32_16x16x32_bf16 a[236:239], a[40:43], a[84:87], a[236:239]
    buffer_load_dwordx4 v2, s[36:39], s53 offen offset:1024 lds
    v_mfma_f32_16x16x32_bf16 a[244:247], a[44:47], a[84:87], a[244:247]
    ds_read_b64_tr_b16 v[36:37], v13 offset:0
    v_mfma_f32_16x16x32_bf16 v[138:141], a[0:3], a[88:91], v[138:141]
    v_mfma_f32_16x16x32_bf16 v[142:145], a[4:7], a[88:91], v[142:145]
    s_lshr_b32 s72, s56, 2
    v_mfma_f32_16x16x32_bf16 v[146:149], a[8:11], a[88:91], v[146:149]
    ds_read_b64_tr_b16 v[38:39], v13 offset:1024
    v_mfma_f32_16x16x32_bf16 v[150:153], a[12:15], a[88:91], v[150:153]
    s_add_u32 m0, s72, s64
    v_mfma_f32_16x16x32_bf16 v[154:157], a[16:19], a[88:91], v[154:157]
    ds_read_b64_tr_b16 v[52:53], v13 offset:8192
    v_mfma_f32_16x16x32_bf16 v[158:161], a[20:23], a[88:91], v[158:161]
    v_mfma_f32_16x16x32_bf16 v[162:165], a[24:27], a[88:91], v[162:165]
    ds_read_b64_tr_b16 v[54:55], v13 offset:9216
    s_nop 0
    v_mfma_f32_16x16x32_bf16 v[166:169], a[28:31], a[88:91], v[166:169]
    v_mfma_f32_16x16x32_bf16 a[132:135], a[0:3], a[128:131], a[132:135]
    ds_read_b64_tr_b16 v[40:41], v14 offset:0
    v_mfma_f32_16x16x32_bf16 v[170:173], a[0:3], a[92:95], v[170:173]
    buffer_load_dwordx4 v23, s[44:47], s63 offen lds
    v_mfma_f32_16x16x32_bf16 v[174:177], a[4:7], a[92:95], v[174:177]
    v_mfma_f32_16x16x32_bf16 v[178:181], a[8:11], a[92:95], v[178:181]
    ds_read_b64_tr_b16 v[42:43], v14 offset:1024
    s_add_u32 s63, s63, 2048
    v_mfma_f32_16x16x32_bf16 v[182:185], a[12:15], a[92:95], v[182:185]
    v_mfma_f32_16x16x32_bf16 v[186:189], a[16:19], a[92:95], v[186:189]
    ds_read_b64_tr_b16 v[56:57], v14 offset:8192
    v_mfma_f32_16x16x32_bf16 v[190:193], a[20:23], a[92:95], v[190:193]
    s_add_u32 s53, s53, s52
    v_mfma_f32_16x16x32_bf16 v[194:197], a[24:27], a[92:95], v[194:197]
    ds_read_b64_tr_b16 v[58:59], v14 offset:9216
    v_mfma_f32_16x16x32_bf16 v[198:201], a[28:31], a[92:95], v[198:201]
    v_mfma_f32_16x16x32_bf16 a[136:139], a[4:7], a[128:131], a[136:139]
    ds_read_b64_tr_b16 a[32:33], v25
    s_mov_b32 s56, s55
    v_mfma_f32_16x16x32_bf16 v[202:205], a[0:3], a[96:99], v[202:205]
    v_mfma_f32_16x16x32_bf16 v[206:209], a[4:7], a[96:99], v[206:209]
    ds_read_b64_tr_b16 a[34:35], v25 offset:256
    s_add_u32 s55, s55, 16384
    v_mfma_f32_16x16x32_bf16 v[210:213], a[8:11], a[96:99], v[210:213]
    v_mfma_f32_16x16x32_bf16 v[214:217], a[12:15], a[96:99], v[214:217]
    v_mfma_f32_16x16x32_bf16 v[218:221], a[16:19], a[96:99], v[218:221]
    ds_read_b64_tr_b16 a[36:37], v26
    s_cmp_eq_u32 s55, 49152
    v_mfma_f32_16x16x32_bf16 v[222:225], a[20:23], a[96:99], v[222:225]
    v_mfma_f32_16x16x32_bf16 v[226:229], a[24:27], a[96:99], v[226:229]
    ds_read_b64_tr_b16 a[38:39], v26 offset:256
    v_mfma_f32_16x16x32_bf16 v[230:233], a[28:31], a[96:99], v[230:233]
    s_cselect_b32 s55, 0, s55
    v_mfma_f32_16x16x32_bf16 a[140:143], a[8:11], a[128:131], a[140:143]
    ds_read_b128 a[52:55], v17 offset:2048
    v_mfma_f32_16x16x32_bf16 v[234:237], a[0:3], a[100:103], v[234:237]
    s_add_u32 s72, s58, s60
    v_mfma_f32_16x16x32_bf16 v[238:241], a[4:7], a[100:103], v[238:241]
    ds_read_b128 a[56:59], v17 offset:4096
    v_mfma_f32_16x16x32_bf16 v[242:245], a[8:11], a[100:103], v[242:245]
    v_mfma_f32_16x16x32_bf16 v[246:249], a[12:15], a[100:103], v[246:249]
    ds_read_b128 a[60:63], v17 offset:6144
    s_mov_b32 m0, s72
    v_mfma_f32_16x16x32_bf16 a[152:155], a[16:19], a[100:103], a[152:155]
    v_mfma_f32_16x16x32_bf16 a[156:159], a[20:23], a[100:103], a[156:159]
    v_mfma_f32_16x16x32_bf16 a[160:163], a[24:27], a[100:103], a[160:163]
    ds_read_b128 a[64:67], v17 offset:8192
    s_nop 0
    v_mfma_f32_16x16x32_bf16 a[164:167], a[28:31], a[100:103], a[164:167]
    v_mfma_f32_16x16x32_bf16 a[144:147], a[12:15], a[128:131], a[144:147]
    ds_read_b128 a[68:71], v17 offset:10240
    buffer_load_dwordx4 v3, s[28:31], s54 offen offset:0 lds
    v_mfma_f32_16x16x32_bf16 a[168:171], a[0:3], a[104:107], a[168:171]
    v_mfma_f32_16x16x32_bf16 a[172:175], a[4:7], a[104:107], a[172:175]
    ds_read_b128 a[72:75], v17 offset:12288
    v_mfma_f32_16x16x32_bf16 a[176:179], a[8:11], a[104:107], a[176:179]
    buffer_load_dwordx4 v4, s[28:31], s54 offen offset:1024 lds
    v_mfma_f32_16x16x32_bf16 a[180:183], a[12:15], a[104:107], a[180:183]
    ds_read_b128 a[76:79], v17 offset:14336
    v_mfma_f32_16x16x32_bf16 a[184:187], a[16:19], a[104:107], a[184:187]
    v_mfma_f32_16x16x32_bf16 a[188:191], a[20:23], a[104:107], a[188:191]
    buffer_load_dwordx4 v5, s[28:31], s54 offen offset:2048 lds
    v_mfma_f32_16x16x32_bf16 a[192:195], a[24:27], a[104:107], a[192:195]
    v_mfma_f32_16x16x32_bf16 a[196:199], a[28:31], a[104:107], a[196:199]
    buffer_load_dwordx4 v6, s[28:31], s54 offen offset:3072 lds
    v_mfma_f32_16x16x32_bf16 a[148:151], a[40:43], a[128:131], a[148:151]
    v_mfma_f32_16x16x32_bf16 a[200:203], a[0:3], a[108:111], a[200:203]
    v_mfma_f32_16x16x32_bf16 a[204:207], a[4:7], a[108:111], a[204:207]
    s_add_u32 s54, s54, 262144
    v_add_u32 v11, s55, v7
    v_mfma_f32_16x16x32_bf16 a[208:211], a[8:11], a[108:111], a[208:211]
    v_add_u32_e64 v12, s55, v8
    v_mfma_f32_16x16x32_bf16 a[212:215], a[12:15], a[108:111], a[212:215]
    v_add_u32_e64 v13, s55, v9
    v_mfma_f32_16x16x32_bf16 a[216:219], a[16:19], a[108:111], a[216:219]
    v_add_u32_e64 v14, s55, v10
    v_mfma_f32_16x16x32_bf16 a[220:223], a[20:23], a[108:111], a[220:223]
    v_add_u32_e64 v17, s57, v16
    v_mfma_f32_16x16x32_bf16 a[224:227], a[24:27], a[108:111], a[224:227]
    s_lshr_b32 s71, s55, 2
    v_mfma_f32_16x16x32_bf16 a[228:231], a[28:31], a[108:111], a[228:231]
    v_add_u32 v25, s71, v24
    v_xor_b32 v26, 32, v25
    s_waitcnt vmcnt(13) lgkmcnt(0)
    s_barrier
proj_kernel_qkv_iend0:
    s_sub_u32 s61, s61, 1
    s_cmp_lg_u32 s61, 0
    s_cbranch_scc1 proj_kernel_qkv_loop0
    s_branch proj_kernel_qkv_epi
proj_kernel_qkv_first1:
    v_mfma_f32_16x16x32_bf16 v[74:77], v[28:31], a[48:51], 0
    ds_read_b128 a[80:83], v17 offset:0
    s_mov_b32 s58, 65536
    v_mfma_f32_16x16x32_bf16 v[78:81], v[32:35], a[48:51], 0
    s_mov_b32 s54, 256
    v_mfma_f32_16x16x32_bf16 v[82:85], v[36:39], a[48:51], 0
    ds_read_b64_tr_b16 a[0:1], v11 offset:0
    v_mfma_f32_16x16x32_bf16 v[86:89], v[40:43], a[48:51], 0
    s_add_u32 s72, s58, s60
    v_mfma_f32_16x16x32_bf16 v[90:93], v[44:47], a[48:51], 0
    ds_read_b64_tr_b16 a[2:3], v11 offset:1024
    s_mov_b32 m0, s72
    v_mfma_f32_16x16x32_bf16 v[94:97], v[48:51], a[48:51], 0
    v_mfma_f32_16x16x32_bf16 v[98:101], v[52:55], a[48:51], 0
    ds_read_b64_tr_b16 a[16:17], v11 offset:8192
    s_nop 0
    v_mfma_f32_16x16x32_bf16 v[102:105], v[56:59], a[48:51], 0
    v_mfma_f32_16x16x32_bf16 a[232:235], a[32:35], a[48:51], 0
    ds_read_b64_tr_b16 a[18:19], v11 offset:9216
    buffer_load_dwordx4 v3, s[28:31], s54 offen offset:0 lds
    v_mfma_f32_16x16x32_bf16 a[240:243], a[36:39], a[48:51], 0
    buffer_load_dwordx4 v4, s[28:31], s54 offen offset:1024 lds
    v_mfma_f32_16x16x32_bf16 v[106:109], v[28:31], a[52:55], 0
    v_mfma_f32_16x16x32_bf16 v[110:113], v[32:35], a[52:55], 0
    ds_read_b64_tr_b16 a[4:5], v12 offset:0
    buffer_load_dwordx4 v5, s[28:31], s54 offen offset:2048 lds
    v_mfma_f32_16x16x32_bf16 v[114:117], v[36:39], a[52:55], 0
    buffer_load_dwordx4 v6, s[28:31], s54 offen offset:3072 lds
    v_mfma_f32_16x16x32_bf16 v[118:121], v[40:43], a[52:55], 0
    ds_read_b64_tr_b16 a[6:7], v12 offset:1024
    v_mfma_f32_16x16x32_bf16 v[122:125], v[44:47], a[52:55], 0
    s_mov_b32 s54, 262400
    v_mfma_f32_16x16x32_bf16 v[126:129], v[48:51], a[52:55], 0
    ds_read_b64_tr_b16 a[20:21], v12 offset:8192
    v_mfma_f32_16x16x32_bf16 v[130:133], v[52:55], a[52:55], 0
    s_add_u32 m0, s56, s59
    v_mfma_f32_16x16x32_bf16 v[134:137], v[56:59], a[52:55], 0
    ds_read_b64_tr_b16 a[22:23], v12 offset:9216
    s_nop 0
    v_mfma_f32_16x16x32_bf16 a[236:239], a[32:35], a[52:55], 0
    v_mfma_f32_16x16x32_bf16 a[244:247], a[36:39], a[52:55], 0
    ds_read_b64_tr_b16 a[8:9], v13 offset:0
    buffer_load_dwordx4 v1, s[32:35], s53 offen offset:0 lds
    v_mfma_f32_16x16x32_bf16 v[138:141], v[28:31], a[56:59], 0
    buffer_load_dwordx4 v2, s[32:35], s53 offen offset:1024 lds
    v_mfma_f32_16x16x32_bf16 v[142:145], v[32:35], a[56:59], 0
    v_mfma_f32_16x16x32_bf16 v[146:149], v[36:39], a[56:59], 0
    ds_read_b64_tr_b16 a[10:11], v13 offset:1024
    s_add_u32 m0, m0, 8192
    v_mfma_f32_16x16x32_bf16 v[150:153], v[40:43], a[56:59], 0
    v_mfma_f32_16x16x32_bf16 v[154:157], v[44:47], a[56:59], 0
    ds_read_b64_tr_b16 a[24:25], v13 offset:8192
    s_nop 0
    v_mfma_f32_16x16x32_bf16 v[158:161], v[48:51], a[56:59], 0
    buffer_load_dwordx4 v1, s[36:39], s53 offen offset:0 lds
    v_mfma_f32_16x16x32_bf16 v[162:165], v[52:55], a[56:59], 0
    ds_read_b64_tr_b16 a[26:27], v13 offset:9216
    v_mfma_f32_16x16x32_bf16 v[166:169], v[56:59], a[56:59], 0
    buffer_load_dwordx4 v2, s[36:39], s53 offen offset:1024 lds
    v_mfma_f32_16x16x32_bf16 a[132:135], v[44:47], a[128:131], 0
    ds_read_b64_tr_b16 a[12:13], v14 offset:0
    s_lshr_b32 s72, s56, 2
    v_mfma_f32_16x16x32_bf16 v[170:173], v[28:31], a[60:63], 0
    v_mfma_f32_16x16x32_bf16 v[174:177], v[32:35], a[60:63], 0
    s_add_u32 m0, s72, s64
    v_mfma_f32_16x16x32_bf16 v[178:181], v[36:39], a[60:63], 0
    ds_read_b64_tr_b16 a[14:15], v14 offset:1024
    v_mfma_f32_16x16x32_bf16 v[182:185], v[40:43], a[60:63], 0
    s_nop 0
    v_mfma_f32_16x16x32_bf16 v[186:189], v[44:47], a[60:63], 0
    ds_read_b64_tr_b16 a[28:29], v14 offset:8192
    buffer_load_dwordx4 v23, s[44:47], s63 offen lds
    v_mfma_f32_16x16x32_bf16 v[190:193], v[48:51], a[60:63], 0
    v_mfma_f32_16x16x32_bf16 v[194:197], v[52:55], a[60:63], 0
    ds_read_b64_tr_b16 a[30:31], v14 offset:9216
    s_add_u32 s63, s63, 2048
    v_mfma_f32_16x16x32_bf16 v[198:201], v[56:59], a[60:63], 0
    s_add_u32 s53, s53, s52
    v_mfma_f32_16x16x32_bf16 a[136:139], v[48:51], a[128:131], 0
    ds_read_b64_tr_b16 a[40:41], v25
    v_mfma_f32_16x16x32_bf16 v[202:205], v[28:31], a[64:67], 0
    s_mov_b32 s56, s55
    v_mfma_f32_16x16x32_bf16 v[206:209], v[32:35], a[64:67], 0
    ds_read_b64_tr_b16 a[42:43], v25 offset:256
    v_mfma_f32_16x16x32_bf16 v[210:213], v[36:39], a[64:67], 0
    s_add_u32 s55, s55, 16384
    v_mfma_f32_16x16x32_bf16 v[214:217], v[40:43], a[64:67], 0
    s_cmp_eq_u32 s55, 49152
    v_mfma_f32_16x16x32_bf16 v[218:221], v[44:47], a[64:67], 0
    ds_read_b64_tr_b16 a[44:45], v26
    v_mfma_f32_16x16x32_bf16 v[222:225], v[48:51], a[64:67], 0
    s_cselect_b32 s55, 0, s55
    v_mfma_f32_16x16x32_bf16 v[226:229], v[52:55], a[64:67], 0
    ds_read_b64_tr_b16 a[46:47], v26 offset:256
    s_add_u32 s72, s58, s60
    v_mfma_f32_16x16x32_bf16 v[230:233], v[56:59], a[64:67], 0
    v_mfma_f32_16x16x32_bf16 a[140:143], v[52:55], a[128:131], 0
    ds_read_b128 a[84:87], v17 offset:2048
    s_add_u32 m0, s72, 16384
    v_mfma_f32_16x16x32_bf16 v[234:237], v[28:31], a[68:71], 0
    v_mfma_f32_16x16x32_bf16 v[238:241], v[32:35], a[68:71], 0
    ds_read_b128 a[88:91], v17 offset:4096
    s_nop 0
    v_mfma_f32_16x16x32_bf16 v[242:245], v[36:39], a[68:71], 0
    buffer_load_dwordx4 v3, s[28:31], s54 offen offset:0 lds
    v_mfma_f32_16x16x32_bf16 v[246:249], v[40:43], a[68:71], 0
    ds_read_b128 a[92:95], v17 offset:6144
    v_mfma_f32_16x16x32_bf16 a[152:155], v[44:47], a[68:71], 0
    buffer_load_dwordx4 v4, s[28:31], s54 offen offset:1024 lds
    v_mfma_f32_16x16x32_bf16 a[156:159], v[48:51], a[68:71], 0
    buffer_load_dwordx4 v5, s[28:31], s54 offen offset:2048 lds
    v_mfma_f32_16x16x32_bf16 a[160:163], v[52:55], a[68:71], 0
    ds_read_b128 a[96:99], v17 offset:8192
    v_mfma_f32_16x16x32_bf16 a[164:167], v[56:59], a[68:71], 0
    buffer_load_dwordx4 v6, s[28:31], s54 offen offset:3072 lds
    v_mfma_f32_16x16x32_bf16 a[144:147], v[56:59], a[128:131], 0
    ds_read_b128 a[100:103], v17 offset:10240
    v_mfma_f32_16x16x32_bf16 a[168:171], v[28:31], a[72:75], 0
    s_add_u32 s54, s54, -262016
    v_mfma_f32_16x16x32_bf16 a[172:175], v[32:35], a[72:75], 0
    ds_read_b128 a[104:107], v17 offset:12288
    s_mov_b32 s58, s57
    v_mfma_f32_16x16x32_bf16 a[176:179], v[36:39], a[72:75], 0
    v_mfma_f32_16x16x32_bf16 a[180:183], v[40:43], a[72:75], 0
    ds_read_b128 a[108:111], v17 offset:14336
    s_and_b32 s71, s54, 0x3ffff
    v_mfma_f32_16x16x32_bf16 a[184:187], v[44:47], a[72:75], 0
    s_cmp_ge_u32 s71, 2048
    v_mfma_f32_16x16x32_bf16 a[188:191], v[48:51], a[72:75], 0
    v_mfma_f32_16x16x32_bf16 a[192:195], v[52:55], a[72:75], 0
    s_cselect_b32 s54, 0x40000000, s54
    v_mfma_f32_16x16x32_bf16 a[196:199], v[56:59], a[72:75], 0
    v_mfma_f32_16x16x32_bf16 a[148:151], a[36:39], a[128:131], 0
    s_add_u32 s57, s57, 32768
    v_mfma_f32_16x16x32_bf16 a[200:203], v[28:31], a[76:79], 0
    s_cmp_eq_u32 s57, 98304
    v_mfma_f32_16x16x32_bf16 a[204:207], v[32:35], a[76:79], 0
    v_mfma_f32_16x16x32_bf16 a[208:211], v[36:39], a[76:79], 0
    s_cselect_b32 s57, 0, s57
    v_add_u32_e64 v11, s55, v7
    v_mfma_f32_16x16x32_bf16 a[212:215], v[40:43], a[76:79], 0
    v_add_u32_e64 v12, s55, v8
    v_mfma_f32_16x16x32_bf16 a[216:219], v[44:47], a[76:79], 0
    v_add_u32_e64 v13, s55, v9
    v_mfma_f32_16x16x32_bf16 a[220:223], v[48:51], a[76:79], 0
    v_add_u32_e64 v14, s55, v10
    v_mfma_f32_16x16x32_bf16 a[224:227], v[52:55], a[76:79], 0
    v_add_u32_e64 v17, s57, v15
    v_mfma_f32_16x16x32_bf16 a[228:231], v[56:59], a[76:79], 0
    s_lshr_b32 s71, s55, 2
    v_add_u32 v25, s71, v24
    v_xor_b32 v26, 32, v25
    s_waitcnt vmcnt(14) lgkmcnt(0)
    s_barrier
    s_branch proj_kernel_qkv_mid1
proj_kernel_qkv_loop1:
    s_bitcmp1_b32 s62, s61
    s_cbranch_scc1 proj_kernel_qkv_event
proj_kernel_qkv_resume1:
    v_mfma_f32_16x16x32_bf16 v[74:77], v[28:31], a[48:51], v[74:77]
    ds_read_b128 a[80:83], v17 offset:0
    s_add_u32 m0, s56, s59
    v_mfma_f32_16x16x32_bf16 v[78:81], v[32:35], a[48:51], v[78:81]
    v_mfma_f32_16x16x32_bf16 v[82:85], v[36:39], a[48:51], v[82:85]
    ds_read_b64_tr_b16 a[0:1], v11 offset:0
    s_nop 0
    v_mfma_f32_16x16x32_bf16 v[86:89], v[40:43], a[48:51], v[86:89]
    v_mfma_f32_16x16x32_bf16 v[90:93], v[44:47], a[48:51], v[90:93]
    ds_read_b64_tr_b16 a[2:3], v11 offset:1024
    buffer_load_dwordx4 v1, s[32:35], s53 offen offset:0 lds
    v_mfma_f32_16x16x32_bf16 v[94:97], v[48:51], a[48:51], v[94:97]
    v_mfma_f32_16x16x32_bf16 v[98:101], v[52:55], a[48:51], v[98:101]
    ds_read_b64_tr_b16 a[16:17], v11 offset:8192
    buffer_load_dwordx4 v2, s[32:35], s53 offen offset:1024 lds
    v_mfma_f32_16x16x32_bf16 v[102:105], v[56:59], a[48:51], v[102:105]
    v_mfma_f32_16x16x32_bf16 a[232:235], a[32:35], a[48:51], a[232:235]
    ds_read_b64_tr_b16 a[18:19], v11 offset:9216
    s_add_u32 m0, m0, 8192
    v_mfma_f32_16x16x32_bf16 a[240:243], a[36:39], a[48:51], a[240:243]
    v_mfma_f32_16x16x32_bf16 v[106:109], v[28:31], a[52:55], v[106:109]
    s_nop 0
    v_mfma_f32_16x16x32_bf16 v[110:113], v[32:35], a[52:55], v[110:113]
    ds_read_b64_tr_b16 a[4:5], v12 offset:0
    v_mfma_f32_16x16x32_bf16 v[114:117], v[36:39], a[52:55], v[114:117]
    buffer_load_dwordx4 v1, s[36:39], s53 offen offset:0 lds
    v_mfma_f32_16x16x32_bf16 v[118:121], v[40:43], a[52:55], v[118:121]
    ds_read_b64_tr_b16 a[6:7], v12 offset:1024
    v_mfma_f32_16x16x32_bf16 v[122:125], v[44:47], a[52:55], v[122:125]
    buffer_load_dwordx4 v2, s[36:39], s53 offen offset:1024 lds
    v_mfma_f32_16x16x32_bf16 v[126:129], v[48:51], a[52:55], v[126:129]
    ds_read_b64_tr_b16 a[20:21], v12 offset:8192
    v_mfma_f32_16x16x32_bf16 v[130:133], v[52:55], a[52:55], v[130:133]
    s_lshr_b32 s72, s56, 2
    v_mfma_f32_16x16x32_bf16 v[134:137], v[56:59], a[52:55], v[134:137]
    ds_read_b64_tr_b16 a[22:23], v12 offset:9216
    v_mfma_f32_16x16x32_bf16 a[236:239], a[32:35], a[52:55], a[236:239]
    s_add_u32 m0, s72, s64
    v_mfma_f32_16x16x32_bf16 a[244:247], a[36:39], a[52:55], a[244:247]
    ds_read_b64_tr_b16 a[8:9], v13 offset:0
    v_mfma_f32_16x16x32_bf16 v[138:141], v[28:31], a[56:59], v[138:141]
    s_nop 0
    v_mfma_f32_16x16x32_bf16 v[142:145], v[32:35], a[56:59], v[142:145]
    v_mfma_f32_16x16x32_bf16 v[146:149], v[36:39], a[56:59], v[146:149]
    ds_read_b64_tr_b16 a[10:11], v13 offset:1024
    v_mfma_f32_16x16x32_bf16 v[150:153], v[40:43], a[56:59], v[150:153]
    buffer_load_dwordx4 v23, s[44:47], s63 offen lds
    v_mfma_f32_16x16x32_bf16 v[154:157], v[44:47], a[56:59], v[154:157]
    ds_read_b64_tr_b16 a[24:25], v13 offset:8192
    v_mfma_f32_16x16x32_bf16 v[158:161], v[48:51], a[56:59], v[158:161]
    s_add_u32 s63, s63, 2048
    v_mfma_f32_16x16x32_bf16 v[162:165], v[52:55], a[56:59], v[162:165]
    ds_read_b64_tr_b16 a[26:27], v13 offset:9216
    v_mfma_f32_16x16x32_bf16 v[166:169], v[56:59], a[56:59], v[166:169]
    s_add_u32 s53, s53, s52
    v_mfma_f32_16x16x32_bf16 a[132:135], v[44:47], a[128:131], a[132:135]
    ds_read_b64_tr_b16 a[12:13], v14 offset:0
    v_mfma_f32_16x16x32_bf16 v[170:173], v[28:31], a[60:63], v[170:173]
    s_mov_b32 s56, s55
    v_mfma_f32_16x16x32_bf16 v[174:177], v[32:35], a[60:63], v[174:177]
    v_mfma_f32_16x16x32_bf16 v[178:181], v[36:39], a[60:63], v[178:181]
    ds_read_b64_tr_b16 a[14:15], v14 offset:1024
    s_add_u32 s55, s55, 16384
    v_mfma_f32_16x16x32_bf16 v[182:185], v[40:43], a[60:63], v[182:185]
    v_mfma_f32_16x16x32_bf16 v[186:189], v[44:47], a[60:63], v[186:189]
    ds_read_b64_tr_b16 a[28:29], v14 offset:8192
    s_cmp_eq_u32 s55, 49152
    v_mfma_f32_16x16x32_bf16 v[190:193], v[48:51], a[60:63], v[190:193]
    v_mfma_f32_16x16x32_bf16 v[194:197], v[52:55], a[60:63], v[194:197]
    ds_read_b64_tr_b16 a[30:31], v14 offset:9216
    s_cselect_b32 s55, 0, s55
    v_mfma_f32_16x16x32_bf16 v[198:201], v[56:59], a[60:63], v[198:201]
    v_mfma_f32_16x16x32_bf16 a[136:139], v[48:51], a[128:131], a[136:139]
    ds_read_b64_tr_b16 a[40:41], v25
    s_add_u32 s72, s58, s60
    v_mfma_f32_16x16x32_bf16 v[202:205], v[28:31], a[64:67], v[202:205]
    v_mfma_f32_16x16x32_bf16 v[206:209], v[32:35], a[64:67], v[206:209]
    ds_read_b64_tr_b16 a[42:43], v25 offset:256
    s_add_u32 m0, s72, 16384
    v_mfma_f32_16x16x32_bf16 v[210:213], v[36:39], a[64:67], v[210:213]
    v_mfma_f32_16x16x32_bf16 v[214:217], v[40:43], a[64:67], v[214:217]
    s_nop 0
    v_mfma_f32_16x16x32_bf16 v[218:221], v[44:47], a[64:67], v[218:221]
    ds_read_b64_tr_b16 a[44:45], v26
    v_mfma_f32_16x16x32_bf16 v[222:225], v[48:51], a[64:67], v[222:225]
    buffer_load_dwordx4 v3, s[28:31], s54 offen offset:0 lds
    v_mfma_f32_16x16x32_bf16 v[226:229], v[52:55], a[64:67], v[226:229]
    ds_read_b64_tr_b16 a[46:47], v26 offset:256
    v_mfma_f32_16x16x32_bf16 v[230:233], v[56:59], a[64:67], v[230:233]
    v_mfma_f32_16x16x32_bf16 a[140:143], v[52:55], a[128:131], a[140:143]
    ds_read_b128 a[84:87], v17 offset:2048
    buffer_load_dwordx4 v4, s[28:31], s54 offen offset:1024 lds
    v_mfma_f32_16x16x32_bf16 v[234:237], v[28:31], a[68:71], v[234:237]
    v_mfma_f32_16x16x32_bf16 v[238:241], v[32:35], a[68:71], v[238:241]
    ds_read_b128 a[88:91], v17 offset:4096
    buffer_load_dwordx4 v5, s[28:31], s54 offen offset:2048 lds
    v_mfma_f32_16x16x32_bf16 v[242:245], v[36:39], a[68:71], v[242:245]
    v_mfma_f32_16x16x32_bf16 v[246:249], v[40:43], a[68:71], v[246:249]
    ds_read_b128 a[92:95], v17 offset:6144
    buffer_load_dwordx4 v6, s[28:31], s54 offen offset:3072 lds
    v_mfma_f32_16x16x32_bf16 a[152:155], v[44:47], a[68:71], a[152:155]
    v_mfma_f32_16x16x32_bf16 a[156:159], v[48:51], a[68:71], a[156:159]
    s_add_u32 s54, s54, -262016
    v_mfma_f32_16x16x32_bf16 a[160:163], v[52:55], a[68:71], a[160:163]
    ds_read_b128 a[96:99], v17 offset:8192
    v_mfma_f32_16x16x32_bf16 a[164:167], v[56:59], a[68:71], a[164:167]
    s_mov_b32 s58, s57
    v_mfma_f32_16x16x32_bf16 a[144:147], v[56:59], a[128:131], a[144:147]
    ds_read_b128 a[100:103], v17 offset:10240
    v_mfma_f32_16x16x32_bf16 a[168:171], v[28:31], a[72:75], a[168:171]
    s_and_b32 s71, s54, 0x3ffff
    v_mfma_f32_16x16x32_bf16 a[172:175], v[32:35], a[72:75], a[172:175]
    ds_read_b128 a[104:107], v17 offset:12288
    v_mfma_f32_16x16x32_bf16 a[176:179], v[36:39], a[72:75], a[176:179]
    s_cmp_ge_u32 s71, 2048
    v_mfma_f32_16x16x32_bf16 a[180:183], v[40:43], a[72:75], a[180:183]
    ds_read_b128 a[108:111], v17 offset:14336
    v_mfma_f32_16x16x32_bf16 a[184:187], v[44:47], a[72:75], a[184:187]
    s_cselect_b32 s54, 0x40000000, s54
    v_mfma_f32_16x16x32_bf16 a[188:191], v[48:51], a[72:75], a[188:191]
    v_mfma_f32_16x16x32_bf16 a[192:195], v[52:55], a[72:75], a[192:195]
    s_add_u32 s57, s57, 32768
    v_mfma_f32_16x16x32_bf16 a[196:199], v[56:59], a[72:75], a[196:199]
    v_mfma_f32_16x16x32_bf16 a[148:151], a[36:39], a[128:131], a[148:151]
    s_cmp_eq_u32 s57, 98304
    v_mfma_f32_16x16x32_bf16 a[200:203], v[28:31], a[76:79], a[200:203]
    v_mfma_f32_16x16x32_bf16 a[204:207], v[32:35], a[76:79], a[204:207]
    s_cselect_b32 s57, 0, s57
    v_add_u32_e64 v11, s55, v7
    v_mfma_f32_16x16x32_bf16 a[208:211], v[36:39], a[76:79], a[208:211]
    v_add_u32_e64 v12, s55, v8
    v_mfma_f32_16x16x32_bf16 a[212:215], v[40:43], a[76:79], a[212:215]
    v_add_u32_e64 v13, s55, v9
    v_mfma_f32_16x16x32_bf16 a[216:219], v[44:47], a[76:79], a[216:219]
    v_add_u32_e64 v14, s55, v10
    v_mfma_f32_16x16x32_bf16 a[220:223], v[48:51], a[76:79], a[220:223]
    v_add_u32_e64 v17, s57, v15
    v_mfma_f32_16x16x32_bf16 a[224:227], v[52:55], a[76:79], a[224:227]
    s_lshr_b32 s71, s55, 2
    v_mfma_f32_16x16x32_bf16 a[228:231], v[56:59], a[76:79], a[228:231]
    v_add_u32 v25, s71, v24
    v_xor_b32 v26, 32, v25
    s_waitcnt vmcnt(13) lgkmcnt(0)
    s_barrier
proj_kernel_qkv_mid1:
    v_mfma_f32_16x16x32_bf16 v[74:77], a[0:3], a[80:83], v[74:77]
    ds_read_b128 a[48:51], v17 offset:0
    s_add_u32 m0, s56, s59
    v_mfma_f32_16x16x32_bf16 v[78:81], a[4:7], a[80:83], v[78:81]
    v_mfma_f32_16x16x32_bf16 v[82:85], a[8:11], a[80:83], v[82:85]
    ds_read_b64_tr_b16 v[28:29], v11 offset:0
    s_nop 0
    v_mfma_f32_16x16x32_bf16 v[86:89], a[12:15], a[80:83], v[86:89]
    v_mfma_f32_16x16x32_bf16 v[90:93], a[16:19], a[80:83], v[90:93]
    ds_read_b64_tr_b16 v[30:31], v11 offset:1024
    v_mfma_f32_16x16x32_bf16 v[94:97], a[20:23], a[80:83], v[94:97]
    buffer_load_dwordx4 v1, s[32:35], s53 offen offset:0 lds
    v_mfma_f32_16x16x32_bf16 v[98:101], a[24:27], a[80:83], v[98:101]
    ds_read_b64_tr_b16 v[44:45], v11 offset:8192
    v_mfma_f32_16x16x32_bf16 v[102:105], a[28:31], a[80:83], v[102:105]
    buffer_load_dwordx4 v2, s[32:35], s53 offen offset:1024 lds
    v_mfma_f32_16x16x32_bf16 a[232:235], a[40:43], a[80:83], a[232:235]
    ds_read_b64_tr_b16 v[46:47], v11 offset:9216
    v_mfma_f32_16x16x32_bf16 a[240:243], a[44:47], a[80:83], a[240:243]
    v_mfma_f32_16x16x32_bf16 v[106:109], a[0:3], a[84:87], v[106:109]
    s_add_u32 m0, m0, 8192
    v_mfma_f32_16x16x32_bf16 v[110:113], a[4:7], a[84:87], v[110:113]
    ds_read_b64_tr_b16 v[32:33], v12 offset:0
    v_mfma_f32_16x16x32_bf16 v[114:117], a[8:11], a[84:87], v[114:117]
    v_mfma_f32_16x16x32_bf16 v[118:121], a[12:15], a[84:87], v[118:121]
    ds_read_b64_tr_b16 v[34:35], v12 offset:1024
    s_nop 0
    v_mfma_f32_16x16x32_bf16 v[122:125], a[16:19], a[84:87], v[122:125]
    v_mfma_f32_16x16x32_bf16 v[126:129], a[20:23], a[84:87], v[126:129]
    ds_read_b64_tr_b16 v[48:49], v12 offset:8192
    buffer_load_dwordx4 v1, s[36:39], s53 offen offset:0 lds
    v_mfma_f32_16x16x32_bf16 v[130:133], a[24:27], a[84:87], v[130:133]
    v_mfma_f32_16x16x32_bf16 v[134:137], a[28:31], a[84:87], v[134:137]
    ds_read_b64_tr_b16 v[50:51], v12 offset:9216
    v_mfma_f32_16x16x32_bf16 a[236:239], a[40:43], a[84:87], a[236:239]
    buffer_load_dwordx4 v2, s[36:39], s53 offen offset:1024 lds
    v_mfma_f32_16x16x32_bf16 a[244:247], a[44:47], a[84:87], a[244:247]
    ds_read_b64_tr_b16 v[36:37], v13 offset:0
    v_mfma_f32_16x16x32_bf16 v[138:141], a[0:3], a[88:91], v[138:141]
    v_mfma_f32_16x16x32_bf16 v[142:145], a[4:7], a[88:91], v[142:145]
    s_lshr_b32 s72, s56, 2
    v_mfma_f32_16x16x32_bf16 v[146:149], a[8:11], a[88:91], v[146:149]
    ds_read_b64_tr_b16 v[38:39], v13 offset:1024
    v_mfma_f32_16x16x32_bf16 v[150:153], a[12:15], a[88:91], v[150:153]
    s_add_u32 m0, s72, s64
    v_mfma_f32_16x16x32_bf16 v[154:157], a[16:19], a[88:91], v[154:157]
    ds_read_b64_tr_b16 v[52:53], v13 offset:8192
    v_mfma_f32_16x16x32_bf16 v[158:161], a[20:23], a[88:91], v[158:161]
    v_mfma_f32_16x16x32_bf16 v[162:165], a[24:27], a[88:91], v[162:165]
    ds_read_b64_tr_b16 v[54:55], v13 offset:9216
    s_nop 0
    v_mfma_f32_16x16x32_bf16 v[166:169], a[28:31], a[88:91], v[166:169]
    v_mfma_f32_16x16x32_bf16 a[132:135], a[16:19], a[128:131], a[132:135]
    ds_read_b64_tr_b16 v[40:41], v14 offset:0
    v_mfma_f32_16x16x32_bf16 v[170:173], a[0:3], a[92:95], v[170:173]
    buffer_load_dwordx4 v23, s[44:47], s63 offen lds
    v_mfma_f32_16x16x32_bf16 v[174:177], a[4:7], a[92:95], v[174:177]
    v_mfma_f32_16x16x32_bf16 v[178:181], a[8:11], a[92:95], v[178:181]
    ds_read_b64_tr_b16 v[42:43], v14 offset:1024
    s_add_u32 s63, s63, 2048
    v_mfma_f32_16x16x32_bf16 v[182:185], a[12:15], a[92:95], v[182:185]
    v_mfma_f32_16x16x32_bf16 v[186:189], a[16:19], a[92:95], v[186:189]
    ds_read_b64_tr_b16 v[56:57], v14 offset:8192
    v_mfma_f32_16x16x32_bf16 v[190:193], a[20:23], a[92:95], v[190:193]
    s_add_u32 s53, s53, s52
    v_mfma_f32_16x16x32_bf16 v[194:197], a[24:27], a[92:95], v[194:197]
    ds_read_b64_tr_b16 v[58:59], v14 offset:9216
    v_mfma_f32_16x16x32_bf16 v[198:201], a[28:31], a[92:95], v[198:201]
    v_mfma_f32_16x16x32_bf16 a[136:139], a[20:23], a[128:131], a[136:139]
    ds_read_b64_tr_b16 a[32:33], v25
    s_mov_b32 s56, s55
    v_mfma_f32_16x16x32_bf16 v[202:205], a[0:3], a[96:99], v[202:205]
    v_mfma_f32_16x16x32_bf16 v[206:209], a[4:7], a[96:99], v[206:209]
    ds_read_b64_tr_b16 a[34:35], v25 offset:256
    s_add_u32 s55, s55, 16384
    v_mfma_f32_16x16x32_bf16 v[210:213], a[8:11], a[96:99], v[210:213]
    v_mfma_f32_16x16x32_bf16 v[214:217], a[12:15], a[96:99], v[214:217]
    v_mfma_f32_16x16x32_bf16 v[218:221], a[16:19], a[96:99], v[218:221]
    ds_read_b64_tr_b16 a[36:37], v26
    s_cmp_eq_u32 s55, 49152
    v_mfma_f32_16x16x32_bf16 v[222:225], a[20:23], a[96:99], v[222:225]
    v_mfma_f32_16x16x32_bf16 v[226:229], a[24:27], a[96:99], v[226:229]
    ds_read_b64_tr_b16 a[38:39], v26 offset:256
    v_mfma_f32_16x16x32_bf16 v[230:233], a[28:31], a[96:99], v[230:233]
    s_cselect_b32 s55, 0, s55
    v_mfma_f32_16x16x32_bf16 a[140:143], a[24:27], a[128:131], a[140:143]
    ds_read_b128 a[52:55], v17 offset:2048
    v_mfma_f32_16x16x32_bf16 v[234:237], a[0:3], a[100:103], v[234:237]
    s_add_u32 s72, s58, s60
    v_mfma_f32_16x16x32_bf16 v[238:241], a[4:7], a[100:103], v[238:241]
    ds_read_b128 a[56:59], v17 offset:4096
    v_mfma_f32_16x16x32_bf16 v[242:245], a[8:11], a[100:103], v[242:245]
    v_mfma_f32_16x16x32_bf16 v[246:249], a[12:15], a[100:103], v[246:249]
    ds_read_b128 a[60:63], v17 offset:6144
    s_mov_b32 m0, s72
    v_mfma_f32_16x16x32_bf16 a[152:155], a[16:19], a[100:103], a[152:155]
    v_mfma_f32_16x16x32_bf16 a[156:159], a[20:23], a[100:103], a[156:159]
    v_mfma_f32_16x16x32_bf16 a[160:163], a[24:27], a[100:103], a[160:163]
    ds_read_b128 a[64:67], v17 offset:8192
    s_nop 0
    v_mfma_f32_16x16x32_bf16 a[164:167], a[28:31], a[100:103], a[164:167]
    v_mfma_f32_16x16x32_bf16 a[144:147], a[28:31], a[128:131], a[144:147]
    ds_read_b128 a[68:71], v17 offset:10240
    buffer_load_dwordx4 v3, s[28:31], s54 offen offset:0 lds
    v_mfma_f32_16x16x32_bf16 a[168:171], a[0:3], a[104:107], a[168:171]
    v_mfma_f32_16x16x32_bf16 a[172:175], a[4:7], a[104:107], a[172:175]
    ds_read_b128 a[72:75], v17 offset:12288
    v_mfma_f32_16x16x32_bf16 a[176:179], a[8:11], a[104:107], a[176:179]
    buffer_load_dwordx4 v4, s[28:31], s54 offen offset:1024 lds
    v_mfma_f32_16x16x32_bf16 a[180:183], a[12:15], a[104:107], a[180:183]
    ds_read_b128 a[76:79], v17 offset:14336
    v_mfma_f32_16x16x32_bf16 a[184:187], a[16:19], a[104:107], a[184:187]
    v_mfma_f32_16x16x32_bf16 a[188:191], a[20:23], a[104:107], a[188:191]
    buffer_load_dwordx4 v5, s[28:31], s54 offen offset:2048 lds
    v_mfma_f32_16x16x32_bf16 a[192:195], a[24:27], a[104:107], a[192:195]
    v_mfma_f32_16x16x32_bf16 a[196:199], a[28:31], a[104:107], a[196:199]
    buffer_load_dwordx4 v6, s[28:31], s54 offen offset:3072 lds
    v_mfma_f32_16x16x32_bf16 a[148:151], a[44:47], a[128:131], a[148:151]
    v_mfma_f32_16x16x32_bf16 a[200:203], a[0:3], a[108:111], a[200:203]
    v_mfma_f32_16x16x32_bf16 a[204:207], a[4:7], a[108:111], a[204:207]
    s_add_u32 s54, s54, 262144
    v_add_u32 v11, s55, v7
    v_mfma_f32_16x16x32_bf16 a[208:211], a[8:11], a[108:111], a[208:211]
    v_add_u32_e64 v12, s55, v8
    v_mfma_f32_16x16x32_bf16 a[212:215], a[12:15], a[108:111], a[212:215]
    v_add_u32_e64 v13, s55, v9
    v_mfma_f32_16x16x32_bf16 a[216:219], a[16:19], a[108:111], a[216:219]
    v_add_u32_e64 v14, s55, v10
    v_mfma_f32_16x16x32_bf16 a[220:223], a[20:23], a[108:111], a[220:223]
    v_add_u32_e64 v17, s57, v16
    v_mfma_f32_16x16x32_bf16 a[224:227], a[24:27], a[108:111], a[224:227]
    s_lshr_b32 s71, s55, 2
    v_mfma_f32_16x16x32_bf16 a[228:231], a[28:31], a[108:111], a[228:231]
    v_add_u32 v25, s71, v24
    v_xor_b32 v26, 32, v25
    s_waitcnt vmcnt(13) lgkmcnt(0)
    s_barrier
proj_kernel_qkv_iend1:
    s_sub_u32 s61, s61, 1
    s_cmp_lg_u32 s61, 0
    s_cbranch_scc1 proj_kernel_qkv_loop1
    s_branch proj_kernel_qkv_epi
proj_kernel_qkv_resume:
    s_cmp_eq_u32 s23, 0
    s_cbranch_scc1 proj_kernel_qkv_resume0
    s_branch proj_kernel_qkv_resume1
proj_kernel_qkv_event:
    s_cmp_eq_u32 s61, 15
    s_cbranch_scc0 proj_kernel_qkv_ev2
    s_lshl_b32 s71, s20, 5
    s_add_u32 s71, s71, s21
    v_mov_b32 v19, s71
    v_mov_b32 v20, 1
    v_cmp_eq_u32 vcc, 0, v0
    s_and_saveexec_b64 s[4:5], vcc
    global_store_byte v19, v20, s[16:17] sc1
    s_mov_b64 exec, s[4:5]
    s_branch proj_kernel_qkv_resume
proj_kernel_qkv_ev2:
    v_and_b32 v19, 7, v0
    v_lshlrev_b32 v19, 2, v19
    s_lshl_b32 s71, s20, 5
    v_add_u32 v19, s71, v19
    s_cmp_eq_u32 s61, 3
    s_cbranch_scc0 proj_kernel_qkv_ev3
    global_load_dword v18, v19, s[16:17] offset:0 sc1
    s_getpc_b64 s[74:75]
proj_kernel_qkv_e_pfpc:
    s_add_u32 s74, s74, proj_kernel_qkv_epi-proj_kernel_qkv_e_pfpc
    s_addc_u32 s75, s75, 0
    v_lshlrev_b32_e64 v19, 7, v0
    v_min_u32 v20, proj_kernel_qkv_pfend-proj_kernel_qkv_epi-4, v19
    global_load_dword v68, v20, s[74:75]
    s_branch proj_kernel_qkv_resume
proj_kernel_qkv_ev3:
    s_mov_b32 s72, 0x40000
proj_kernel_qkv_ev3chk:
    v_cmp_eq_u32 vcc, 0x01010101, v18
    s_nop 3
    s_cmp_eq_u64 vcc, exec
    s_cbranch_scc1 proj_kernel_qkv_ev3ok
    s_sub_u32 s72, s72, 1
    s_cbranch_scc1 proj_kernel_qkv_ev3ok
    s_sleep 2
    global_load_dword v18, v19, s[16:17] offset:0 sc1
    s_waitcnt vmcnt(0)
    s_branch proj_kernel_qkv_ev3chk
proj_kernel_qkv_ev3ok:
    s_nop 0
    buffer_load_dwordx2 a[112:113], v70, s[48:51], s76 offen offset:0 sc0 sc1
    buffer_load_dwordx2 a[114:115], v70, s[48:51], s76 offen offset:128 sc0 sc1
    buffer_load_dwordx2 a[116:117], v70, s[48:51], s77 offen offset:0 sc0 sc1
    buffer_load_dwordx2 a[118:119], v70, s[48:51], s77 offen offset:128 sc0 sc1
    buffer_load_dwordx2 a[120:121], v70, s[48:51], s78 offen offset:0 sc0 sc1
    buffer_load_dwordx2 a[122:123], v70, s[48:51], s78 offen offset:128 sc0 sc1
    buffer_load_dwordx2 a[124:125], v70, s[48:51], s79 offen offset:0 sc0 sc1
    buffer_load_dwordx2 a[126:127], v70, s[48:51], s79 offen offset:128 sc0 sc1
    s_branch proj_kernel_qkv_resume
proj_kernel_qkv_epi:
    s_waitcnt vmcnt(0)
    s_barrier
    v_lshrrev_b32 v20, 4, v0
    v_lshlrev_b32 v20, 4, v20
    s_lshl_b32 s68, s24, 10
    v_add_u32 v20, s68, v20
    s_lshl_b32 s68, s23, 8
    v_add_u32_e64 v19, s68, v20
    ds_write_b128 v19, a[132:135] offset:0
    ds_write_b128 v19, a[136:139] offset:64
    ds_write_b128 v19, a[140:143] offset:128
    ds_write_b128 v19, a[144:147] offset:192
    s_lshl_b32 s68, s23, 6
    v_add_u32 v19, s68, v20
    ds_write_b128 v19, a[148:151] offset:512
    s_waitcnt lgkmcnt(0)
    s_barrier
    ds_read_b128 v[28:31], v20 offset:0
    ds_read_b128 v[32:35], v20 offset:64
    ds_read_b128 v[36:39], v20 offset:128
    ds_read_b128 v[40:43], v20 offset:192
    ds_read_b128 v[44:47], v20 offset:256
    ds_read_b128 v[48:51], v20 offset:320
    ds_read_b128 v[52:55], v20 offset:384
    ds_read_b128 v[56:59], v20 offset:448
    ds_read_b128 a[32:35], v20 offset:512
    ds_read_b128 a[36:39], v20 offset:576
    s_mov_b32 s69, 0x3e8293ee
    s_waitcnt lgkmcnt(0)
    v_lshlrev_b32 v19, 4, v0
    v_accvgpr_read_b32 v60, a112
    v_accvgpr_read_b32 v61, a113
    v_rsq_f32 v63, v61
    s_nop 0
    v_mul_f32_e64 v62, s69, v63
    s_add_u32 s40, s18, 25165824
    s_addc_u32 s41, s19, 0
    s_mov_b32 s42, 4194304
    s_mov_b32 s43, 0x20000
    v_lshrrev_b32 v20, 5, v0
    v_lshlrev_b32_e64 v20, 10, v20
    v_bfe_u32 v21, v0, 4, 1
    v_lshl_add_u32 v20, v21, 9, v20
    v_and_b32_e64 v21, 15, v0
    v_lshl_add_u32 v20, v21, 4, v20
    s_lshl_b32 s67, s25, 3
    s_lshl_b32 s68, s24, 1
    s_add_u32 s67, s67, s68
    s_lshl_b32 s67, s67, 17
    s_lshl_b32 s68, s20, 3
    s_lshl_b32 s70, s23, 2
    s_add_u32 s68, s68, s70
    s_lshl_b32 s68, s68, 11
    s_add_u32 s67, s67, s68
    s_xor_b32 s71, s25, 0
    s_lshl_b32 s71, s71, 11
    s_add_u32 s71, s71, s67
    v_pk_fma_f32 v[74:75], v[28:29], v[60:61], v[74:75] op_sel:[0,0,0] op_sel_hi:[1,0,1]
    v_pk_fma_f32 v[78:79], v[32:33], v[60:61], v[78:79] op_sel:[0,0,0] op_sel_hi:[1,0,1]
    v_pk_fma_f32 v[82:83], v[36:37], v[60:61], v[82:83] op_sel:[0,0,0] op_sel_hi:[1,0,1]
    v_pk_fma_f32 v[86:87], v[40:41], v[60:61], v[86:87] op_sel:[0,0,0] op_sel_hi:[1,0,1]
    v_pk_fma_f32 v[76:77], v[30:31], v[60:61], v[76:77] op_sel:[0,0,0] op_sel_hi:[1,0,1]
    v_pk_fma_f32 v[80:81], v[34:35], v[60:61], v[80:81] op_sel:[0,0,0] op_sel_hi:[1,0,1]
    v_pk_fma_f32 v[84:85], v[38:39], v[60:61], v[84:85] op_sel:[0,0,0] op_sel_hi:[1,0,1]
    v_pk_fma_f32 v[88:89], v[42:43], v[60:61], v[88:89] op_sel:[0,0,0] op_sel_hi:[1,0,1]
    v_pk_mul_f32 v[74:75], v[74:75], v[62:63] op_sel:[0,0] op_sel_hi:[1,0]
    v_pk_mul_f32 v[78:79], v[78:79], v[62:63] op_sel:[0,0] op_sel_hi:[1,0]
    v_pk_mul_f32 v[82:83], v[82:83], v[62:63] op_sel:[0,0] op_sel_hi:[1,0]
    v_pk_mul_f32 v[86:87], v[86:87], v[62:63] op_sel:[0,0] op_sel_hi:[1,0]
    v_pk_mul_f32 v[76:77], v[76:77], v[62:63] op_sel:[0,0] op_sel_hi:[1,0]
    v_pk_mul_f32 v[80:81], v[80:81], v[62:63] op_sel:[0,0] op_sel_hi:[1,0]
    v_pk_mul_f32 v[84:85], v[84:85], v[62:63] op_sel:[0,0] op_sel_hi:[1,0]
    v_pk_mul_f32 v[88:89], v[88:89], v[62:63] op_sel:[0,0] op_sel_hi:[1,0]
    v_cvt_pk_bf16_f32 v2, v74, v75
    v_cvt_pk_bf16_f32 v4, v78, v79
    v_cvt_pk_bf16_f32 v6, v82, v83
    v_cvt_pk_bf16_f32 v8, v86, v87
    v_cvt_pk_bf16_f32 v3, v76, v77
    v_cvt_pk_bf16_f32 v5, v80, v81
    v_cvt_pk_bf16_f32 v7, v84, v85
    v_cvt_pk_bf16_f32 v9, v88, v89
    s_add_u32 s70, s71, 0
    s_nop 0
    buffer_store_dwordx4 v[2:5], v19, s[40:43], s70 offen sc1
    s_add_u32 s70, s71, 131072
    buffer_store_dwordx4 v[6:9], v19, s[40:43], s70 offen sc1
    v_pk_fma_f32 v[90:91], v[44:45], v[60:61], v[90:91] op_sel:[0,0,0] op_sel_hi:[1,0,1]
    v_pk_fma_f32 v[94:95], v[48:49], v[60:61], v[94:95] op_sel:[0,0,0] op_sel_hi:[1,0,1]
    v_pk_fma_f32 v[98:99], v[52:53], v[60:61], v[98:99] op_sel:[0,0,0] op_sel_hi:[1,0,1]
    v_pk_fma_f32 v[102:103], v[56:57], v[60:61], v[102:103] op_sel:[0,0,0] op_sel_hi:[1,0,1]
    v_accvgpr_read_b32 v64, a114
    v_pk_fma_f32 v[92:93], v[46:47], v[60:61], v[92:93] op_sel:[0,0,0] op_sel_hi:[1,0,1]
    v_pk_fma_f32 v[96:97], v[50:51], v[60:61], v[96:97] op_sel:[0,0,0] op_sel_hi:[1,0,1]
    v_pk_fma_f32 v[100:101], v[54:55], v[60:61], v[100:101] op_sel:[0,0,0] op_sel_hi:[1,0,1]
    v_pk_fma_f32 v[104:105], v[58:59], v[60:61], v[104:105] op_sel:[0,0,0] op_sel_hi:[1,0,1]
    v_accvgpr_read_b32 v65, a115
    v_pk_mul_f32 v[90:91], v[90:91], v[62:63] op_sel:[0,0] op_sel_hi:[1,0]
    v_pk_mul_f32 v[94:95], v[94:95], v[62:63] op_sel:[0,0] op_sel_hi:[1,0]
    v_pk_mul_f32 v[98:99], v[98:99], v[62:63] op_sel:[0,0] op_sel_hi:[1,0]
    v_pk_mul_f32 v[102:103], v[102:103], v[62:63] op_sel:[0,0] op_sel_hi:[1,0]
    v_rsq_f32_e64 v67, v65
    v_pk_mul_f32 v[92:93], v[92:93], v[62:63] op_sel:[0,0] op_sel_hi:[1,0]
    v_pk_mul_f32 v[96:97], v[96:97], v[62:63] op_sel:[0,0] op_sel_hi:[1,0]
    v_pk_mul_f32 v[100:101], v[100:101], v[62:63] op_sel:[0,0] op_sel_hi:[1,0]
    v_pk_mul_f32 v[104:105], v[104:105], v[62:63] op_sel:[0,0] op_sel_hi:[1,0]
    s_nop 0
    s_nop 0
    v_cvt_pk_bf16_f32 v10, v90, v91
    v_cvt_pk_bf16_f32 v12, v94, v95
    v_cvt_pk_bf16_f32 v14, v98, v99
    v_cvt_pk_bf16_f32 v16, v102, v103
    v_mul_f32_e64 v66, s69, v67
    v_cvt_pk_bf16_f32 v11, v92, v93
    v_cvt_pk_bf16_f32 v13, v96, v97
    v_cvt_pk_bf16_f32 v15, v100, v101
    v_cvt_pk_bf16_f32 v17, v104, v105
    s_add_u32 s70, s71, 524288
    buffer_store_dwordx4 v[10:13], v19, s[40:43], s70 offen sc1
    s_add_u32 s70, s71, 655360
    buffer_store_dwordx4 v[14:17], v19, s[40:43], s70 offen sc1
    s_xor_b32 s71, s25, 0
    s_lshl_b32 s71, s71, 11
    s_add_u32 s71, s71, s67
    s_nop 0
    v_pk_fma_f32 v[106:107], v[28:29], v[64:65], v[106:107] op_sel:[0,0,0] op_sel_hi:[1,0,1]
    v_pk_fma_f32 v[110:111], v[32:33], v[64:65], v[110:111] op_sel:[0,0,0] op_sel_hi:[1,0,1]
    v_pk_fma_f32 v[114:115], v[36:37], v[64:65], v[114:115] op_sel:[0,0,0] op_sel_hi:[1,0,1]
    v_pk_fma_f32 v[118:119], v[40:41], v[64:65], v[118:119] op_sel:[0,0,0] op_sel_hi:[1,0,1]
    v_pk_fma_f32 v[108:109], v[30:31], v[64:65], v[108:109] op_sel:[0,0,0] op_sel_hi:[1,0,1]
    v_pk_fma_f32 v[112:113], v[34:35], v[64:65], v[112:113] op_sel:[0,0,0] op_sel_hi:[1,0,1]
    v_pk_fma_f32 v[116:117], v[38:39], v[64:65], v[116:117] op_sel:[0,0,0] op_sel_hi:[1,0,1]
    v_pk_fma_f32 v[120:121], v[42:43], v[64:65], v[120:121] op_sel:[0,0,0] op_sel_hi:[1,0,1]
    v_pk_mul_f32 v[106:107], v[106:107], v[66:67] op_sel:[0,0] op_sel_hi:[1,0]
    v_pk_mul_f32 v[110:111], v[110:111], v[66:67] op_sel:[0,0] op_sel_hi:[1,0]
    v_pk_mul_f32 v[114:115], v[114:115], v[66:67] op_sel:[0,0] op_sel_hi:[1,0]
    v_pk_mul_f32 v[118:119], v[118:119], v[66:67] op_sel:[0,0] op_sel_hi:[1,0]
    v_pk_mul_f32 v[108:109], v[108:109], v[66:67] op_sel:[0,0] op_sel_hi:[1,0]
    v_pk_mul_f32 v[112:113], v[112:113], v[66:67] op_sel:[0,0] op_sel_hi:[1,0]
    v_pk_mul_f32 v[116:117], v[116:117], v[66:67] op_sel:[0,0] op_sel_hi:[1,0]
    v_pk_mul_f32 v[120:121], v[120:121], v[66:67] op_sel:[0,0] op_sel_hi:[1,0]
    v_cvt_pk_bf16_f32 v2, v106, v107
    v_cvt_pk_bf16_f32 v4, v110, v111
    v_cvt_pk_bf16_f32 v6, v114, v115
    v_cvt_pk_bf16_f32 v8, v118, v119
    v_cvt_pk_bf16_f32 v3, v108, v109
    v_cvt_pk_bf16_f32 v5, v112, v113
    v_cvt_pk_bf16_f32 v7, v116, v117
    v_cvt_pk_bf16_f32 v9, v120, v121
    s_add_u32 s70, s71, 1024
    buffer_store_dwordx4 v[2:5], v19, s[40:43], s70 offen sc1
    s_add_u32 s70, s71, 132096
    buffer_store_dwordx4 v[6:9], v19, s[40:43], s70 offen sc1
    v_pk_fma_f32 v[122:123], v[44:45], v[64:65], v[122:123] op_sel:[0,0,0] op_sel_hi:[1,0,1]
    v_pk_fma_f32 v[126:127], v[48:49], v[64:65], v[126:127] op_sel:[0,0,0] op_sel_hi:[1,0,1]
    v_pk_fma_f32 v[130:131], v[52:53], v[64:65], v[130:131] op_sel:[0,0,0] op_sel_hi:[1,0,1]
    v_pk_fma_f32 v[134:135], v[56:57], v[64:65], v[134:135] op_sel:[0,0,0] op_sel_hi:[1,0,1]
    v_accvgpr_read_b32 v60, a116
    v_pk_fma_f32 v[124:125], v[46:47], v[64:65], v[124:125] op_sel:[0,0,0] op_sel_hi:[1,0,1]
    v_pk_fma_f32 v[128:129], v[50:51], v[64:65], v[128:129] op_sel:[0,0,0] op_sel_hi:[1,0,1]
    v_pk_fma_f32 v[132:133], v[54:55], v[64:65], v[132:133] op_sel:[0,0,0] op_sel_hi:[1,0,1]
    v_pk_fma_f32 v[136:137], v[58:59], v[64:65], v[136:137] op_sel:[0,0,0] op_sel_hi:[1,0,1]
    v_accvgpr_read_b32 v61, a117
    v_pk_mul_f32 v[122:123], v[122:123], v[66:67] op_sel:[0,0] op_sel_hi:[1,0]
    v_pk_mul_f32 v[126:127], v[126:127], v[66:67] op_sel:[0,0] op_sel_hi:[1,0]
    v_pk_mul_f32 v[130:131], v[130:131], v[66:67] op_sel:[0,0] op_sel_hi:[1,0]
    v_pk_mul_f32 v[134:135], v[134:135], v[66:67] op_sel:[0,0] op_sel_hi:[1,0]
    v_rsq_f32_e64 v63, v61
    v_pk_mul_f32 v[124:125], v[124:125], v[66:67] op_sel:[0,0] op_sel_hi:[1,0]
    v_pk_mul_f32 v[128:129], v[128:129], v[66:67] op_sel:[0,0] op_sel_hi:[1,0]
    v_pk_mul_f32 v[132:133], v[132:133], v[66:67] op_sel:[0,0] op_sel_hi:[1,0]
    v_pk_mul_f32 v[136:137], v[136:137], v[66:67] op_sel:[0,0] op_sel_hi:[1,0]
    s_nop 0
    s_nop 0
    v_cvt_pk_bf16_f32 v10, v122, v123
    v_cvt_pk_bf16_f32 v12, v126, v127
    v_cvt_pk_bf16_f32 v14, v130, v131
    v_cvt_pk_bf16_f32 v16, v134, v135
    v_mul_f32_e64 v62, s69, v63
    v_cvt_pk_bf16_f32 v11, v124, v125
    v_cvt_pk_bf16_f32 v13, v128, v129
    v_cvt_pk_bf16_f32 v15, v132, v133
    v_cvt_pk_bf16_f32 v17, v136, v137
    s_add_u32 s70, s71, 525312
    buffer_store_dwordx4 v[10:13], v19, s[40:43], s70 offen sc1
    s_add_u32 s70, s71, 656384
    buffer_store_dwordx4 v[14:17], v19, s[40:43], s70 offen sc1
    s_xor_b32 s71, s25, 1
    s_lshl_b32 s71, s71, 11
    s_add_u32 s71, s71, s67
    s_nop 0
    v_pk_fma_f32 v[138:139], v[28:29], v[60:61], v[138:139] op_sel:[0,0,0] op_sel_hi:[1,0,1]
    v_pk_fma_f32 v[142:143], v[32:33], v[60:61], v[142:143] op_sel:[0,0,0] op_sel_hi:[1,0,1]
    v_pk_fma_f32 v[146:147], v[36:37], v[60:61], v[146:147] op_sel:[0,0,0] op_sel_hi:[1,0,1]
    v_pk_fma_f32 v[150:151], v[40:41], v[60:61], v[150:151] op_sel:[0,0,0] op_sel_hi:[1,0,1]
    v_pk_fma_f32 v[140:141], v[30:31], v[60:61], v[140:141] op_sel:[0,0,0] op_sel_hi:[1,0,1]
    v_pk_fma_f32 v[144:145], v[34:35], v[60:61], v[144:145] op_sel:[0,0,0] op_sel_hi:[1,0,1]
    v_pk_fma_f32 v[148:149], v[38:39], v[60:61], v[148:149] op_sel:[0,0,0] op_sel_hi:[1,0,1]
    v_pk_fma_f32 v[152:153], v[42:43], v[60:61], v[152:153] op_sel:[0,0,0] op_sel_hi:[1,0,1]
    v_pk_mul_f32 v[138:139], v[138:139], v[62:63] op_sel:[0,0] op_sel_hi:[1,0]
    v_pk_mul_f32 v[142:143], v[142:143], v[62:63] op_sel:[0,0] op_sel_hi:[1,0]
    v_pk_mul_f32 v[146:147], v[146:147], v[62:63] op_sel:[0,0] op_sel_hi:[1,0]
    v_pk_mul_f32 v[150:151], v[150:151], v[62:63] op_sel:[0,0] op_sel_hi:[1,0]
    v_pk_mul_f32 v[140:141], v[140:141], v[62:63] op_sel:[0,0] op_sel_hi:[1,0]
    v_pk_mul_f32 v[144:145], v[144:145], v[62:63] op_sel:[0,0] op_sel_hi:[1,0]
    v_pk_mul_f32 v[148:149], v[148:149], v[62:63] op_sel:[0,0] op_sel_hi:[1,0]
    v_pk_mul_f32 v[152:153], v[152:153], v[62:63] op_sel:[0,0] op_sel_hi:[1,0]
    v_cvt_pk_bf16_f32 v2, v138, v139
    v_cvt_pk_bf16_f32 v4, v142, v143
    v_cvt_pk_bf16_f32 v6, v146, v147
    v_cvt_pk_bf16_f32 v8, v150, v151
    v_cvt_pk_bf16_f32 v3, v140, v141
    v_cvt_pk_bf16_f32 v5, v144, v145
    v_cvt_pk_bf16_f32 v7, v148, v149
    v_cvt_pk_bf16_f32 v9, v152, v153
    s_add_u32 s70, s71, 0
    s_nop 0
    buffer_store_dwordx4 v[2:5], v19, s[40:43], s70 offen sc1
    s_add_u32 s70, s71, 131072
    buffer_store_dwordx4 v[6:9], v19, s[40:43], s70 offen sc1
    v_pk_fma_f32 v[154:155], v[44:45], v[60:61], v[154:155] op_sel:[0,0,0] op_sel_hi:[1,0,1]
    v_pk_fma_f32 v[158:159], v[48:49], v[60:61], v[158:159] op_sel:[0,0,0] op_sel_hi:[1,0,1]
    v_pk_fma_f32 v[162:163], v[52:53], v[60:61], v[162:163] op_sel:[0,0,0] op_sel_hi:[1,0,1]
    v_pk_fma_f32 v[166:167], v[56:57], v[60:61], v[166:167] op_sel:[0,0,0] op_sel_hi:[1,0,1]
    v_accvgpr_read_b32 v64, a118
    v_pk_fma_f32 v[156:157], v[46:47], v[60:61], v[156:157] op_sel:[0,0,0] op_sel_hi:[1,0,1]
    v_pk_fma_f32 v[160:161], v[50:51], v[60:61], v[160:161] op_sel:[0,0,0] op_sel_hi:[1,0,1]
    v_pk_fma_f32 v[164:165], v[54:55], v[60:61], v[164:165] op_sel:[0,0,0] op_sel_hi:[1,0,1]
    v_pk_fma_f32 v[168:169], v[58:59], v[60:61], v[168:169] op_sel:[0,0,0] op_sel_hi:[1,0,1]
    v_accvgpr_read_b32 v65, a119
    v_pk_mul_f32 v[154:155], v[154:155], v[62:63] op_sel:[0,0] op_sel_hi:[1,0]
    v_pk_mul_f32 v[158:159], v[158:159], v[62:63] op_sel:[0,0] op_sel_hi:[1,0]
    v_pk_mul_f32 v[162:163], v[162:163], v[62:63] op_sel:[0,0] op_sel_hi:[1,0]
    v_pk_mul_f32 v[166:167], v[166:167], v[62:63] op_sel:[0,0] op_sel_hi:[1,0]
    v_rsq_f32_e64 v67, v65
    v_pk_mul_f32 v[156:157], v[156:157], v[62:63] op_sel:[0,0] op_sel_hi:[1,0]
    v_pk_mul_f32 v[160:161], v[160:161], v[62:63] op_sel:[0,0] op_sel_hi:[1,0]
    v_pk_mul_f32 v[164:165], v[164:165], v[62:63] op_sel:[0,0] op_sel_hi:[1,0]
    v_pk_mul_f32 v[168:169], v[168:169], v[62:63] op_sel:[0,0] op_sel_hi:[1,0]
    s_nop 0
    s_nop 0
    v_cvt_pk_bf16_f32 v10, v154, v155
    v_cvt_pk_bf16_f32 v12, v158, v159
    v_cvt_pk_bf16_f32 v14, v162, v163
    v_cvt_pk_bf16_f32 v16, v166, v167
    v_mul_f32_e64 v66, s69, v67
    v_cvt_pk_bf16_f32 v11, v156, v157
    v_cvt_pk_bf16_f32 v13, v160, v161
    v_cvt_pk_bf16_f32 v15, v164, v165
    v_cvt_pk_bf16_f32 v17, v168, v169
    s_add_u32 s70, s71, 524288
    buffer_store_dwordx4 v[10:13], v19, s[40:43], s70 offen sc1
    s_add_u32 s70, s71, 655360
    buffer_store_dwordx4 v[14:17], v19, s[40:43], s70 offen sc1
    s_xor_b32 s71, s25, 1
    s_lshl_b32 s71, s71, 11
    s_add_u32 s71, s71, s67
    s_nop 0
    v_pk_fma_f32 v[170:171], v[28:29], v[64:65], v[170:171] op_sel:[0,0,0] op_sel_hi:[1,0,1]
    v_pk_fma_f32 v[174:175], v[32:33], v[64:65], v[174:175] op_sel:[0,0,0] op_sel_hi:[1,0,1]
    v_pk_fma_f32 v[178:179], v[36:37], v[64:65], v[178:179] op_sel:[0,0,0] op_sel_hi:[1,0,1]
    v_pk_fma_f32 v[182:183], v[40:41], v[64:65], v[182:183] op_sel:[0,0,0] op_sel_hi:[1,0,1]
    v_pk_fma_f32 v[172:173], v[30:31], v[64:65], v[172:173] op_sel:[0,0,0] op_sel_hi:[1,0,1]
    v_pk_fma_f32 v[176:177], v[34:35], v[64:65], v[176:177] op_sel:[0,0,0] op_sel_hi:[1,0,1]
    v_pk_fma_f32 v[180:181], v[38:39], v[64:65], v[180:181] op_sel:[0,0,0] op_sel_hi:[1,0,1]
    v_pk_fma_f32 v[184:185], v[42:43], v[64:65], v[184:185] op_sel:[0,0,0] op_sel_hi:[1,0,1]
    v_pk_mul_f32 v[170:171], v[170:171], v[66:67] op_sel:[0,0] op_sel_hi:[1,0]
    v_pk_mul_f32 v[174:175], v[174:175], v[66:67] op_sel:[0,0] op_sel_hi:[1,0]
    v_pk_mul_f32 v[178:179], v[178:179], v[66:67] op_sel:[0,0] op_sel_hi:[1,0]
    v_pk_mul_f32 v[182:183], v[182:183], v[66:67] op_sel:[0,0] op_sel_hi:[1,0]
    v_pk_mul_f32 v[172:173], v[172:173], v[66:67] op_sel:[0,0] op_sel_hi:[1,0]
    v_pk_mul_f32 v[176:177], v[176:177], v[66:67] op_sel:[0,0] op_sel_hi:[1,0]
    v_pk_mul_f32 v[180:181], v[180:181], v[66:67] op_sel:[0,0] op_sel_hi:[1,0]
    v_pk_mul_f32 v[184:185], v[184:185], v[66:67] op_sel:[0,0] op_sel_hi:[1,0]
    v_cvt_pk_bf16_f32 v2, v170, v171
    v_cvt_pk_bf16_f32 v4, v174, v175
    v_cvt_pk_bf16_f32 v6, v178, v179
    v_cvt_pk_bf16_f32 v8, v182, v183
    v_cvt_pk_bf16_f32 v3, v172, v173
    v_cvt_pk_bf16_f32 v5, v176, v177
    v_cvt_pk_bf16_f32 v7, v180, v181
    v_cvt_pk_bf16_f32 v9, v184, v185
    s_add_u32 s70, s71, 1024
    buffer_store_dwordx4 v[2:5], v19, s[40:43], s70 offen sc1
    s_add_u32 s70, s71, 132096
    buffer_store_dwordx4 v[6:9], v19, s[40:43], s70 offen sc1
    v_pk_fma_f32 v[186:187], v[44:45], v[64:65], v[186:187] op_sel:[0,0,0] op_sel_hi:[1,0,1]
    v_pk_fma_f32 v[190:191], v[48:49], v[64:65], v[190:191] op_sel:[0,0,0] op_sel_hi:[1,0,1]
    v_pk_fma_f32 v[194:195], v[52:53], v[64:65], v[194:195] op_sel:[0,0,0] op_sel_hi:[1,0,1]
    v_pk_fma_f32 v[198:199], v[56:57], v[64:65], v[198:199] op_sel:[0,0,0] op_sel_hi:[1,0,1]
    v_accvgpr_read_b32 v60, a120
    v_pk_fma_f32 v[188:189], v[46:47], v[64:65], v[188:189] op_sel:[0,0,0] op_sel_hi:[1,0,1]
    v_pk_fma_f32 v[192:193], v[50:51], v[64:65], v[192:193] op_sel:[0,0,0] op_sel_hi:[1,0,1]
    v_pk_fma_f32 v[196:197], v[54:55], v[64:65], v[196:197] op_sel:[0,0,0] op_sel_hi:[1,0,1]
    v_pk_fma_f32 v[200:201], v[58:59], v[64:65], v[200:201] op_sel:[0,0,0] op_sel_hi:[1,0,1]
    v_accvgpr_read_b32 v61, a121
    v_pk_mul_f32 v[186:187], v[186:187], v[66:67] op_sel:[0,0] op_sel_hi:[1,0]
    v_pk_mul_f32 v[190:191], v[190:191], v[66:67] op_sel:[0,0] op_sel_hi:[1,0]
    v_pk_mul_f32 v[194:195], v[194:195], v[66:67] op_sel:[0,0] op_sel_hi:[1,0]
    v_pk_mul_f32 v[198:199], v[198:199], v[66:67] op_sel:[0,0] op_sel_hi:[1,0]
    v_rsq_f32_e64 v63, v61
    v_pk_mul_f32 v[188:189], v[188:189], v[66:67] op_sel:[0,0] op_sel_hi:[1,0]
    v_pk_mul_f32 v[192:193], v[192:193], v[66:67] op_sel:[0,0] op_sel_hi:[1,0]
    v_pk_mul_f32 v[196:197], v[196:197], v[66:67] op_sel:[0,0] op_sel_hi:[1,0]
    v_pk_mul_f32 v[200:201], v[200:201], v[66:67] op_sel:[0,0] op_sel_hi:[1,0]
    s_nop 0
    s_nop 0
    v_cvt_pk_bf16_f32 v10, v186, v187
    v_cvt_pk_bf16_f32 v12, v190, v191
    v_cvt_pk_bf16_f32 v14, v194, v195
    v_cvt_pk_bf16_f32 v16, v198, v199
    v_mul_f32_e64 v62, s69, v63
    v_cvt_pk_bf16_f32 v11, v188, v189
    v_cvt_pk_bf16_f32 v13, v192, v193
    v_cvt_pk_bf16_f32 v15, v196, v197
    v_cvt_pk_bf16_f32 v17, v200, v201
    s_add_u32 s70, s71, 525312
    buffer_store_dwordx4 v[10:13], v19, s[40:43], s70 offen sc1
    s_add_u32 s70, s71, 656384
    buffer_store_dwordx4 v[14:17], v19, s[40:43], s70 offen sc1
    s_xor_b32 s71, s25, 2
    s_lshl_b32 s71, s71, 11
    s_add_u32 s71, s71, s67
    s_nop 0
    v_pk_fma_f32 v[202:203], v[28:29], v[60:61], v[202:203] op_sel:[0,0,0] op_sel_hi:[1,0,1]
    v_pk_fma_f32 v[206:207], v[32:33], v[60:61], v[206:207] op_sel:[0,0,0] op_sel_hi:[1,0,1]
    v_pk_fma_f32 v[210:211], v[36:37], v[60:61], v[210:211] op_sel:[0,0,0] op_sel_hi:[1,0,1]
    v_pk_fma_f32 v[214:215], v[40:41], v[60:61], v[214:215] op_sel:[0,0,0] op_sel_hi:[1,0,1]
    v_pk_fma_f32 v[204:205], v[30:31], v[60:61], v[204:205] op_sel:[0,0,0] op_sel_hi:[1,0,1]
    v_pk_fma_f32 v[208:209], v[34:35], v[60:61], v[208:209] op_sel:[0,0,0] op_sel_hi:[1,0,1]
    v_pk_fma_f32 v[212:213], v[38:39], v[60:61], v[212:213] op_sel:[0,0,0] op_sel_hi:[1,0,1]
    v_pk_fma_f32 v[216:217], v[42:43], v[60:61], v[216:217] op_sel:[0,0,0] op_sel_hi:[1,0,1]
    v_pk_mul_f32 v[202:203], v[202:203], v[62:63] op_sel:[0,0] op_sel_hi:[1,0]
    v_pk_mul_f32 v[206:207], v[206:207], v[62:63] op_sel:[0,0] op_sel_hi:[1,0]
    v_pk_mul_f32 v[210:211], v[210:211], v[62:63] op_sel:[0,0] op_sel_hi:[1,0]
    v_pk_mul_f32 v[214:215], v[214:215], v[62:63] op_sel:[0,0] op_sel_hi:[1,0]
    v_pk_mul_f32 v[204:205], v[204:205], v[62:63] op_sel:[0,0] op_sel_hi:[1,0]
    v_pk_mul_f32 v[208:209], v[208:209], v[62:63] op_sel:[0,0] op_sel_hi:[1,0]
    v_pk_mul_f32 v[212:213], v[212:213], v[62:63] op_sel:[0,0] op_sel_hi:[1,0]
    v_pk_mul_f32 v[216:217], v[216:217], v[62:63] op_sel:[0,0] op_sel_hi:[1,0]
    v_cvt_pk_bf16_f32 v2, v202, v203
    v_cvt_pk_bf16_f32 v4, v206, v207
    v_cvt_pk_bf16_f32 v6, v210, v211
    v_cvt_pk_bf16_f32 v8, v214, v215
    v_cvt_pk_bf16_f32 v3, v204, v205
    v_cvt_pk_bf16_f32 v5, v208, v209
    v_cvt_pk_bf16_f32 v7, v212, v213
    v_cvt_pk_bf16_f32 v9, v216, v217
    s_add_u32 s70, s71, 0
    s_nop 0
    buffer_store_dwordx4 v[2:5], v19, s[40:43], s70 offen sc1
    s_add_u32 s70, s71, 131072
    buffer_store_dwordx4 v[6:9], v19, s[40:43], s70 offen sc1
    v_pk_fma_f32 v[218:219], v[44:45], v[60:61], v[218:219] op_sel:[0,0,0] op_sel_hi:[1,0,1]
    v_pk_fma_f32 v[222:223], v[48:49], v[60:61], v[222:223] op_sel:[0,0,0] op_sel_hi:[1,0,1]
    v_pk_fma_f32 v[226:227], v[52:53], v[60:61], v[226:227] op_sel:[0,0,0] op_sel_hi:[1,0,1]
    v_pk_fma_f32 v[230:231], v[56:57], v[60:61], v[230:231] op_sel:[0,0,0] op_sel_hi:[1,0,1]
    v_accvgpr_read_b32 v64, a122
    v_pk_fma_f32 v[220:221], v[46:47], v[60:61], v[220:221] op_sel:[0,0,0] op_sel_hi:[1,0,1]
    v_pk_fma_f32 v[224:225], v[50:51], v[60:61], v[224:225] op_sel:[0,0,0] op_sel_hi:[1,0,1]
    v_pk_fma_f32 v[228:229], v[54:55], v[60:61], v[228:229] op_sel:[0,0,0] op_sel_hi:[1,0,1]
    v_pk_fma_f32 v[232:233], v[58:59], v[60:61], v[232:233] op_sel:[0,0,0] op_sel_hi:[1,0,1]
    v_accvgpr_read_b32 v65, a123
    v_pk_mul_f32 v[218:219], v[218:219], v[62:63] op_sel:[0,0] op_sel_hi:[1,0]
    v_pk_mul_f32 v[222:223], v[222:223], v[62:63] op_sel:[0,0] op_sel_hi:[1,0]
    v_pk_mul_f32 v[226:227], v[226:227], v[62:63] op_sel:[0,0] op_sel_hi:[1,0]
    v_pk_mul_f32 v[230:231], v[230:231], v[62:63] op_sel:[0,0] op_sel_hi:[1,0]
    v_rsq_f32_e64 v67, v65
    v_pk_mul_f32 v[220:221], v[220:221], v[62:63] op_sel:[0,0] op_sel_hi:[1,0]
    v_pk_mul_f32 v[224:225], v[224:225], v[62:63] op_sel:[0,0] op_sel_hi:[1,0]
    v_pk_mul_f32 v[228:229], v[228:229], v[62:63] op_sel:[0,0] op_sel_hi:[1,0]
    v_pk_mul_f32 v[232:233], v[232:233], v[62:63] op_sel:[0,0] op_sel_hi:[1,0]
    s_nop 0
    s_nop 0
    v_cvt_pk_bf16_f32 v10, v218, v219
    v_cvt_pk_bf16_f32 v12, v222, v223
    v_cvt_pk_bf16_f32 v14, v226, v227
    v_cvt_pk_bf16_f32 v16, v230, v231
    v_mul_f32_e64 v66, s69, v67
    v_cvt_pk_bf16_f32 v11, v220, v221
    v_cvt_pk_bf16_f32 v13, v224, v225
    v_cvt_pk_bf16_f32 v15, v228, v229
    v_cvt_pk_bf16_f32 v17, v232, v233
    s_add_u32 s70, s71, 524288
    buffer_store_dwordx4 v[10:13], v19, s[40:43], s70 offen sc1
    s_add_u32 s70, s71, 655360
    buffer_store_dwordx4 v[14:17], v19, s[40:43], s70 offen sc1
    s_xor_b32 s71, s25, 2
    s_lshl_b32 s71, s71, 11
    s_add_u32 s71, s71, s67
    s_nop 0
    v_pk_fma_f32 v[234:235], v[28:29], v[64:65], v[234:235] op_sel:[0,0,0] op_sel_hi:[1,0,1]
    v_pk_fma_f32 v[238:239], v[32:33], v[64:65], v[238:239] op_sel:[0,0,0] op_sel_hi:[1,0,1]
    v_pk_fma_f32 v[242:243], v[36:37], v[64:65], v[242:243] op_sel:[0,0,0] op_sel_hi:[1,0,1]
    v_pk_fma_f32 v[246:247], v[40:41], v[64:65], v[246:247] op_sel:[0,0,0] op_sel_hi:[1,0,1]
    v_pk_fma_f32 v[236:237], v[30:31], v[64:65], v[236:237] op_sel:[0,0,0] op_sel_hi:[1,0,1]
    v_pk_fma_f32 v[240:241], v[34:35], v[64:65], v[240:241] op_sel:[0,0,0] op_sel_hi:[1,0,1]
    v_pk_fma_f32 v[244:245], v[38:39], v[64:65], v[244:245] op_sel:[0,0,0] op_sel_hi:[1,0,1]
    v_pk_fma_f32 v[248:249], v[42:43], v[64:65], v[248:249] op_sel:[0,0,0] op_sel_hi:[1,0,1]
    v_pk_mul_f32 v[234:235], v[234:235], v[66:67] op_sel:[0,0] op_sel_hi:[1,0]
    v_pk_mul_f32 v[238:239], v[238:239], v[66:67] op_sel:[0,0] op_sel_hi:[1,0]
    v_pk_mul_f32 v[242:243], v[242:243], v[66:67] op_sel:[0,0] op_sel_hi:[1,0]
    v_pk_mul_f32 v[246:247], v[246:247], v[66:67] op_sel:[0,0] op_sel_hi:[1,0]
    v_pk_mul_f32 v[236:237], v[236:237], v[66:67] op_sel:[0,0] op_sel_hi:[1,0]
    v_pk_mul_f32 v[240:241], v[240:241], v[66:67] op_sel:[0,0] op_sel_hi:[1,0]
    v_pk_mul_f32 v[244:245], v[244:245], v[66:67] op_sel:[0,0] op_sel_hi:[1,0]
    v_pk_mul_f32 v[248:249], v[248:249], v[66:67] op_sel:[0,0] op_sel_hi:[1,0]
    v_cvt_pk_bf16_f32 v2, v234, v235
    v_cvt_pk_bf16_f32 v4, v238, v239
    v_cvt_pk_bf16_f32 v6, v242, v243
    v_cvt_pk_bf16_f32 v8, v246, v247
    v_cvt_pk_bf16_f32 v3, v236, v237
    v_cvt_pk_bf16_f32 v5, v240, v241
    v_cvt_pk_bf16_f32 v7, v244, v245
    v_cvt_pk_bf16_f32 v9, v248, v249
    s_add_u32 s70, s71, 1024
    buffer_store_dwordx4 v[2:5], v19, s[40:43], s70 offen sc1
    s_add_u32 s70, s71, 132096
    buffer_store_dwordx4 v[6:9], v19, s[40:43], s70 offen sc1
    v_accvgpr_read_b32 v74, a152
    v_accvgpr_read_b32 v78, a156
    v_accvgpr_read_b32 v82, a160
    v_accvgpr_read_b32 v86, a164
    v_accvgpr_read_b32 v60, a124
    v_accvgpr_read_b32 v75, a153
    v_accvgpr_read_b32 v79, a157
    v_accvgpr_read_b32 v83, a161
    v_accvgpr_read_b32 v87, a165
    v_accvgpr_read_b32 v61, a125
    v_accvgpr_read_b32 v76, a154
    v_accvgpr_read_b32 v80, a158
    v_accvgpr_read_b32 v84, a162
    v_accvgpr_read_b32 v88, a166
    v_rsq_f32_e64 v63, v61
    v_accvgpr_read_b32 v77, a155
    v_accvgpr_read_b32 v81, a159
    v_accvgpr_read_b32 v85, a163
    v_accvgpr_read_b32 v89, a167
    s_nop 0
    s_nop 0
    v_pk_fma_f32 v[74:75], v[44:45], v[64:65], v[74:75] op_sel:[0,0,0] op_sel_hi:[1,0,1]
    v_pk_fma_f32 v[78:79], v[48:49], v[64:65], v[78:79] op_sel:[0,0,0] op_sel_hi:[1,0,1]
    v_pk_fma_f32 v[82:83], v[52:53], v[64:65], v[82:83] op_sel:[0,0,0] op_sel_hi:[1,0,1]
    v_pk_fma_f32 v[86:87], v[56:57], v[64:65], v[86:87] op_sel:[0,0,0] op_sel_hi:[1,0,1]
    v_mul_f32_e64 v62, s69, v63
    v_pk_fma_f32 v[76:77], v[46:47], v[64:65], v[76:77] op_sel:[0,0,0] op_sel_hi:[1,0,1]
    v_pk_fma_f32 v[80:81], v[50:51], v[64:65], v[80:81] op_sel:[0,0,0] op_sel_hi:[1,0,1]
    v_pk_fma_f32 v[84:85], v[54:55], v[64:65], v[84:85] op_sel:[0,0,0] op_sel_hi:[1,0,1]
    v_pk_fma_f32 v[88:89], v[58:59], v[64:65], v[88:89] op_sel:[0,0,0] op_sel_hi:[1,0,1]
    v_pk_mul_f32 v[74:75], v[74:75], v[66:67] op_sel:[0,0] op_sel_hi:[1,0]
    v_pk_mul_f32 v[78:79], v[78:79], v[66:67] op_sel:[0,0] op_sel_hi:[1,0]
    v_pk_mul_f32 v[82:83], v[82:83], v[66:67] op_sel:[0,0] op_sel_hi:[1,0]
    v_pk_mul_f32 v[86:87], v[86:87], v[66:67] op_sel:[0,0] op_sel_hi:[1,0]
    v_pk_mul_f32 v[76:77], v[76:77], v[66:67] op_sel:[0,0] op_sel_hi:[1,0]
    v_pk_mul_f32 v[80:81], v[80:81], v[66:67] op_sel:[0,0] op_sel_hi:[1,0]
    v_pk_mul_f32 v[84:85], v[84:85], v[66:67] op_sel:[0,0] op_sel_hi:[1,0]
    v_pk_mul_f32 v[88:89], v[88:89], v[66:67] op_sel:[0,0] op_sel_hi:[1,0]
    v_cvt_pk_bf16_f32 v10, v74, v75
    v_cvt_pk_bf16_f32 v12, v78, v79
    v_cvt_pk_bf16_f32 v14, v82, v83
    v_cvt_pk_bf16_f32 v16, v86, v87
    v_cvt_pk_bf16_f32 v11, v76, v77
    v_cvt_pk_bf16_f32 v13, v80, v81
    v_cvt_pk_bf16_f32 v15, v84, v85
    v_cvt_pk_bf16_f32 v17, v88, v89
    s_add_u32 s70, s71, 525312
    buffer_store_dwordx4 v[10:13], v19, s[40:43], s70 offen sc1
    s_add_u32 s70, s71, 656384
    buffer_store_dwordx4 v[14:17], v19, s[40:43], s70 offen sc1
    s_xor_b32 s71, s25, 3
    s_lshl_b32 s71, s71, 11
    s_add_u32 s71, s71, s67
    s_nop 0
    v_accvgpr_read_b32 v90, a168
    v_accvgpr_read_b32 v94, a172
    v_accvgpr_read_b32 v98, a176
    v_accvgpr_read_b32 v102, a180
    v_accvgpr_read_b32 v91, a169
    v_accvgpr_read_b32 v95, a173
    v_accvgpr_read_b32 v99, a177
    v_accvgpr_read_b32 v103, a181
    v_accvgpr_read_b32 v92, a170
    v_accvgpr_read_b32 v96, a174
    v_accvgpr_read_b32 v100, a178
    v_accvgpr_read_b32 v104, a182
    v_accvgpr_read_b32 v93, a171
    v_accvgpr_read_b32 v97, a175
    v_accvgpr_read_b32 v101, a179
    v_accvgpr_read_b32 v105, a183
    v_pk_fma_f32 v[90:91], v[28:29], v[60:61], v[90:91] op_sel:[0,0,0] op_sel_hi:[1,0,1]
    v_pk_fma_f32 v[94:95], v[32:33], v[60:61], v[94:95] op_sel:[0,0,0] op_sel_hi:[1,0,1]
    v_pk_fma_f32 v[98:99], v[36:37], v[60:61], v[98:99] op_sel:[0,0,0] op_sel_hi:[1,0,1]
    v_pk_fma_f32 v[102:103], v[40:41], v[60:61], v[102:103] op_sel:[0,0,0] op_sel_hi:[1,0,1]
    v_pk_fma_f32 v[92:93], v[30:31], v[60:61], v[92:93] op_sel:[0,0,0] op_sel_hi:[1,0,1]
    v_pk_fma_f32 v[96:97], v[34:35], v[60:61], v[96:97] op_sel:[0,0,0] op_sel_hi:[1,0,1]
    v_pk_fma_f32 v[100:101], v[38:39], v[60:61], v[100:101] op_sel:[0,0,0] op_sel_hi:[1,0,1]
    v_pk_fma_f32 v[104:105], v[42:43], v[60:61], v[104:105] op_sel:[0,0,0] op_sel_hi:[1,0,1]
    v_pk_mul_f32 v[90:91], v[90:91], v[62:63] op_sel:[0,0] op_sel_hi:[1,0]
    v_pk_mul_f32 v[94:95], v[94:95], v[62:63] op_sel:[0,0] op_sel_hi:[1,0]
    v_pk_mul_f32 v[98:99], v[98:99], v[62:63] op_sel:[0,0] op_sel_hi:[1,0]
    v_pk_mul_f32 v[102:103], v[102:103], v[62:63] op_sel:[0,0] op_sel_hi:[1,0]
    v_pk_mul_f32 v[92:93], v[92:93], v[62:63] op_sel:[0,0] op_sel_hi:[1,0]
    v_pk_mul_f32 v[96:97], v[96:97], v[62:63] op_sel:[0,0] op_sel_hi:[1,0]
    v_pk_mul_f32 v[100:101], v[100:101], v[62:63] op_sel:[0,0] op_sel_hi:[1,0]
    v_pk_mul_f32 v[104:105], v[104:105], v[62:63] op_sel:[0,0] op_sel_hi:[1,0]
    v_cvt_pk_bf16_f32 v2, v90, v91
    v_cvt_pk_bf16_f32 v4, v94, v95
    v_cvt_pk_bf16_f32 v6, v98, v99
    v_cvt_pk_bf16_f32 v8, v102, v103
    v_cvt_pk_bf16_f32 v3, v92, v93
    v_cvt_pk_bf16_f32 v5, v96, v97
    v_cvt_pk_bf16_f32 v7, v100, v101
    v_cvt_pk_bf16_f32 v9, v104, v105
    s_add_u32 s70, s71, 0
    s_nop 0
    buffer_store_dwordx4 v[2:5], v19, s[40:43], s70 offen sc1
    s_add_u32 s70, s71, 131072
    buffer_store_dwordx4 v[6:9], v19, s[40:43], s70 offen sc1
    v_accvgpr_read_b32 v74, a184
    v_accvgpr_read_b32 v78, a188
    v_accvgpr_read_b32 v82, a192
    v_accvgpr_read_b32 v86, a196
    v_accvgpr_read_b32 v64, a126
    v_accvgpr_read_b32 v75, a185
    v_accvgpr_read_b32 v79, a189
    v_accvgpr_read_b32 v83, a193
    v_accvgpr_read_b32 v87, a197
    v_accvgpr_read_b32 v65, a127
    v_accvgpr_read_b32 v76, a186
    v_accvgpr_read_b32 v80, a190
    v_accvgpr_read_b32 v84, a194
    v_accvgpr_read_b32 v88, a198
    v_rsq_f32_e64 v67, v65
    v_accvgpr_read_b32 v77, a187
    v_accvgpr_read_b32 v81, a191
    v_accvgpr_read_b32 v85, a195
    v_accvgpr_read_b32 v89, a199
    s_nop 0
    s_nop 0
    v_pk_fma_f32 v[74:75], v[44:45], v[60:61], v[74:75] op_sel:[0,0,0] op_sel_hi:[1,0,1]
    v_pk_fma_f32 v[78:79], v[48:49], v[60:61], v[78:79] op_sel:[0,0,0] op_sel_hi:[1,0,1]
    v_pk_fma_f32 v[82:83], v[52:53], v[60:61], v[82:83] op_sel:[0,0,0] op_sel_hi:[1,0,1]
    v_pk_fma_f32 v[86:87], v[56:57], v[60:61], v[86:87] op_sel:[0,0,0] op_sel_hi:[1,0,1]
    v_mul_f32_e64 v66, s69, v67
    v_pk_fma_f32 v[76:77], v[46:47], v[60:61], v[76:77] op_sel:[0,0,0] op_sel_hi:[1,0,1]
    v_pk_fma_f32 v[80:81], v[50:51], v[60:61], v[80:81] op_sel:[0,0,0] op_sel_hi:[1,0,1]
    v_pk_fma_f32 v[84:85], v[54:55], v[60:61], v[84:85] op_sel:[0,0,0] op_sel_hi:[1,0,1]
    v_pk_fma_f32 v[88:89], v[58:59], v[60:61], v[88:89] op_sel:[0,0,0] op_sel_hi:[1,0,1]
    v_pk_mul_f32 v[74:75], v[74:75], v[62:63] op_sel:[0,0] op_sel_hi:[1,0]
    v_pk_mul_f32 v[78:79], v[78:79], v[62:63] op_sel:[0,0] op_sel_hi:[1,0]
    v_pk_mul_f32 v[82:83], v[82:83], v[62:63] op_sel:[0,0] op_sel_hi:[1,0]
    v_pk_mul_f32 v[86:87], v[86:87], v[62:63] op_sel:[0,0] op_sel_hi:[1,0]
    v_pk_mul_f32 v[76:77], v[76:77], v[62:63] op_sel:[0,0] op_sel_hi:[1,0]
    v_pk_mul_f32 v[80:81], v[80:81], v[62:63] op_sel:[0,0] op_sel_hi:[1,0]
    v_pk_mul_f32 v[84:85], v[84:85], v[62:63] op_sel:[0,0] op_sel_hi:[1,0]
    v_pk_mul_f32 v[88:89], v[88:89], v[62:63] op_sel:[0,0] op_sel_hi:[1,0]
    v_cvt_pk_bf16_f32 v10, v74, v75
    v_cvt_pk_bf16_f32 v12, v78, v79
    v_cvt_pk_bf16_f32 v14, v82, v83
    v_cvt_pk_bf16_f32 v16, v86, v87
    v_cvt_pk_bf16_f32 v11, v76, v77
    v_cvt_pk_bf16_f32 v13, v80, v81
    v_cvt_pk_bf16_f32 v15, v84, v85
    v_cvt_pk_bf16_f32 v17, v88, v89
    s_add_u32 s70, s71, 524288
    buffer_store_dwordx4 v[10:13], v19, s[40:43], s70 offen sc1
    s_add_u32 s70, s71, 655360
    buffer_store_dwordx4 v[14:17], v19, s[40:43], s70 offen sc1
    s_xor_b32 s71, s25, 3
    s_lshl_b32 s71, s71, 11
    s_add_u32 s71, s71, s67
    s_nop 0
    v_accvgpr_read_b32 v90, a200
    v_accvgpr_read_b32 v94, a204
    v_accvgpr_read_b32 v98, a208
    v_accvgpr_read_b32 v102, a212
    v_accvgpr_read_b32 v91, a201
    v_accvgpr_read_b32 v95, a205
    v_accvgpr_read_b32 v99, a209
    v_accvgpr_read_b32 v103, a213
    v_accvgpr_read_b32 v92, a202
    v_accvgpr_read_b32 v96, a206
    v_accvgpr_read_b32 v100, a210
    v_accvgpr_read_b32 v104, a214
    v_accvgpr_read_b32 v93, a203
    v_accvgpr_read_b32 v97, a207
    v_accvgpr_read_b32 v101, a211
    v_accvgpr_read_b32 v105, a215
    v_pk_fma_f32 v[90:91], v[28:29], v[64:65], v[90:91] op_sel:[0,0,0] op_sel_hi:[1,0,1]
    v_pk_fma_f32 v[94:95], v[32:33], v[64:65], v[94:95] op_sel:[0,0,0] op_sel_hi:[1,0,1]
    v_pk_fma_f32 v[98:99], v[36:37], v[64:65], v[98:99] op_sel:[0,0,0] op_sel_hi:[1,0,1]
    v_pk_fma_f32 v[102:103], v[40:41], v[64:65], v[102:103] op_sel:[0,0,0] op_sel_hi:[1,0,1]
    v_pk_fma_f32 v[92:93], v[30:31], v[64:65], v[92:93] op_sel:[0,0,0] op_sel_hi:[1,0,1]
    v_pk_fma_f32 v[96:97], v[34:35], v[64:65], v[96:97] op_sel:[0,0,0] op_sel_hi:[1,0,1]
    v_pk_fma_f32 v[100:101], v[38:39], v[64:65], v[100:101] op_sel:[0,0,0] op_sel_hi:[1,0,1]
    v_pk_fma_f32 v[104:105], v[42:43], v[64:65], v[104:105] op_sel:[0,0,0] op_sel_hi:[1,0,1]
    v_pk_mul_f32 v[90:91], v[90:91], v[66:67] op_sel:[0,0] op_sel_hi:[1,0]
    v_pk_mul_f32 v[94:95], v[94:95], v[66:67] op_sel:[0,0] op_sel_hi:[1,0]
    v_pk_mul_f32 v[98:99], v[98:99], v[66:67] op_sel:[0,0] op_sel_hi:[1,0]
    v_pk_mul_f32 v[102:103], v[102:103], v[66:67] op_sel:[0,0] op_sel_hi:[1,0]
    v_pk_mul_f32 v[92:93], v[92:93], v[66:67] op_sel:[0,0] op_sel_hi:[1,0]
    v_pk_mul_f32 v[96:97], v[96:97], v[66:67] op_sel:[0,0] op_sel_hi:[1,0]
    v_pk_mul_f32 v[100:101], v[100:101], v[66:67] op_sel:[0,0] op_sel_hi:[1,0]
    v_pk_mul_f32 v[104:105], v[104:105], v[66:67] op_sel:[0,0] op_sel_hi:[1,0]
    v_cvt_pk_bf16_f32 v2, v90, v91
    v_cvt_pk_bf16_f32 v4, v94, v95
    v_cvt_pk_bf16_f32 v6, v98, v99
    v_cvt_pk_bf16_f32 v8, v102, v103
    v_cvt_pk_bf16_f32 v3, v92, v93
    v_cvt_pk_bf16_f32 v5, v96, v97
    v_cvt_pk_bf16_f32 v7, v100, v101
    v_cvt_pk_bf16_f32 v9, v104, v105
    s_add_u32 s70, s71, 1024
    buffer_store_dwordx4 v[2:5], v19, s[40:43], s70 offen sc1
    s_add_u32 s70, s71, 132096
    buffer_store_dwordx4 v[6:9], v19, s[40:43], s70 offen sc1
    v_accvgpr_read_b32 v74, a216
    v_accvgpr_read_b32 v78, a220
    v_accvgpr_read_b32 v82, a224
    v_accvgpr_read_b32 v86, a228
    v_accvgpr_read_b32 v75, a217
    v_accvgpr_read_b32 v79, a221
    v_accvgpr_read_b32 v83, a225
    v_accvgpr_read_b32 v87, a229
    v_accvgpr_read_b32 v76, a218
    v_accvgpr_read_b32 v80, a222
    v_accvgpr_read_b32 v84, a226
    v_accvgpr_read_b32 v88, a230
    v_accvgpr_read_b32 v77, a219
    v_accvgpr_read_b32 v81, a223
    v_accvgpr_read_b32 v85, a227
    v_accvgpr_read_b32 v89, a231
    v_pk_fma_f32 v[74:75], v[44:45], v[64:65], v[74:75] op_sel:[0,0,0] op_sel_hi:[1,0,1]
    v_pk_fma_f32 v[78:79], v[48:49], v[64:65], v[78:79] op_sel:[0,0,0] op_sel_hi:[1,0,1]
    v_pk_fma_f32 v[82:83], v[52:53], v[64:65], v[82:83] op_sel:[0,0,0] op_sel_hi:[1,0,1]
    v_pk_fma_f32 v[86:87], v[56:57], v[64:65], v[86:87] op_sel:[0,0,0] op_sel_hi:[1,0,1]
    v_pk_fma_f32 v[76:77], v[46:47], v[64:65], v[76:77] op_sel:[0,0,0] op_sel_hi:[1,0,1]
    v_pk_fma_f32 v[80:81], v[50:51], v[64:65], v[80:81] op_sel:[0,0,0] op_sel_hi:[1,0,1]
    v_pk_fma_f32 v[84:85], v[54:55], v[64:65], v[84:85] op_sel:[0,0,0] op_sel_hi:[1,0,1]
    v_pk_fma_f32 v[88:89], v[58:59], v[64:65], v[88:89] op_sel:[0,0,0] op_sel_hi:[1,0,1]
    v_pk_mul_f32 v[74:75], v[74:75], v[66:67] op_sel:[0,0] op_sel_hi:[1,0]
    v_pk_mul_f32 v[78:79], v[78:79], v[66:67] op_sel:[0,0] op_sel_hi:[1,0]
    v_pk_mul_f32 v[82:83], v[82:83], v[66:67] op_sel:[0,0] op_sel_hi:[1,0]
    v_pk_mul_f32 v[86:87], v[86:87], v[66:67] op_sel:[0,0] op_sel_hi:[1,0]
    v_pk_mul_f32 v[76:77], v[76:77], v[66:67] op_sel:[0,0] op_sel_hi:[1,0]
    v_pk_mul_f32 v[80:81], v[80:81], v[66:67] op_sel:[0,0] op_sel_hi:[1,0]
    v_pk_mul_f32 v[84:85], v[84:85], v[66:67] op_sel:[0,0] op_sel_hi:[1,0]
    v_pk_mul_f32 v[88:89], v[88:89], v[66:67] op_sel:[0,0] op_sel_hi:[1,0]
    v_cvt_pk_bf16_f32 v10, v74, v75
    v_cvt_pk_bf16_f32 v12, v78, v79
    v_cvt_pk_bf16_f32 v14, v82, v83
    v_cvt_pk_bf16_f32 v16, v86, v87
    v_cvt_pk_bf16_f32 v11, v76, v77
    v_cvt_pk_bf16_f32 v13, v80, v81
    v_cvt_pk_bf16_f32 v15, v84, v85
    v_cvt_pk_bf16_f32 v17, v88, v89
    s_add_u32 s70, s71, 525312
    buffer_store_dwordx4 v[10:13], v19, s[40:43], s70 offen sc1
    s_add_u32 s70, s71, 656384
    buffer_store_dwordx4 v[14:17], v19, s[40:43], s70 offen sc1
    s_lshl_b32 s67, s20, 3
    s_lshl_b32 s68, s23, 2
    s_add_u32 s67, s67, s68
    s_add_u32 s67, s67, s25
    s_lshl_b32 s67, s67, 11
    s_add_u32 s40, s18, 29360128
    s_addc_u32 s41, s19, 0
    s_mov_b32 s42, 294912
    s_mov_b32 s43, 0x20000
    v_accvgpr_read_b32 v44, a32
    v_accvgpr_read_b32 v45, a33
    v_accvgpr_read_b32 v46, a34
    v_accvgpr_read_b32 v47, a35
    v_accvgpr_read_b32 v48, a36
    v_accvgpr_read_b32 v49, a37
    v_accvgpr_read_b32 v50, a38
    v_accvgpr_read_b32 v51, a39
    v_accvgpr_read_b32 v60, a112
    v_accvgpr_read_b32 v61, a113
    v_rsq_f32 v63, v61
    s_nop 0
    v_mul_f32_e64 v62, s69, v63
    v_accvgpr_read_b32 v28, a232
    v_accvgpr_read_b32 v29, a233
    v_accvgpr_read_b32 v30, a234
    v_accvgpr_read_b32 v31, a235
    v_pk_fma_f32 v[28:29], v[44:45], v[60:61], v[28:29] op_sel:[0,0,0] op_sel_hi:[1,0,1]
    v_pk_fma_f32 v[30:31], v[46:47], v[60:61], v[30:31] op_sel:[0,0,0] op_sel_hi:[1,0,1]
    v_pk_mul_f32 v[28:29], v[28:29], v[62:63] op_sel:[0,1] op_sel_hi:[1,1]
    v_pk_mul_f32 v[30:31], v[30:31], v[62:63] op_sel:[0,1] op_sel_hi:[1,1]
    v_accvgpr_read_b32 v32, a240
    v_accvgpr_read_b32 v33, a241
    v_accvgpr_read_b32 v34, a242
    v_accvgpr_read_b32 v35, a243
    v_pk_fma_f32 v[32:33], v[48:49], v[60:61], v[32:33] op_sel:[0,0,0] op_sel_hi:[1,0,1]
    v_pk_fma_f32 v[34:35], v[50:51], v[60:61], v[34:35] op_sel:[0,0,0] op_sel_hi:[1,0,1]
    v_pk_mul_f32 v[32:33], v[32:33], v[62:63] op_sel:[0,1] op_sel_hi:[1,1]
    v_pk_mul_f32 v[34:35], v[34:35], v[62:63] op_sel:[0,1] op_sel_hi:[1,1]
    v_accvgpr_read_b32 v60, a114
    v_accvgpr_read_b32 v61, a115
    v_rsq_f32 v63, v61
    s_nop 0
    v_mul_f32_e64 v62, s69, v63
    v_accvgpr_read_b32 v36, a236
    v_accvgpr_read_b32 v37, a237
    v_accvgpr_read_b32 v38, a238
    v_accvgpr_read_b32 v39, a239
    v_pk_fma_f32 v[36:37], v[44:45], v[60:61], v[36:37] op_sel:[0,0,0] op_sel_hi:[1,0,1]
    v_pk_fma_f32 v[38:39], v[46:47], v[60:61], v[38:39] op_sel:[0,0,0] op_sel_hi:[1,0,1]
    v_pk_mul_f32 v[36:37], v[36:37], v[62:63] op_sel:[0,1] op_sel_hi:[1,1]
    v_pk_mul_f32 v[38:39], v[38:39], v[62:63] op_sel:[0,1] op_sel_hi:[1,1]
    v_accvgpr_read_b32 v40, a244
    v_accvgpr_read_b32 v41, a245
    v_accvgpr_read_b32 v42, a246
    v_accvgpr_read_b32 v43, a247
    v_pk_fma_f32 v[40:41], v[48:49], v[60:61], v[40:41] op_sel:[0,0,0] op_sel_hi:[1,0,1]
    v_pk_fma_f32 v[42:43], v[50:51], v[60:61], v[42:43] op_sel:[0,0,0] op_sel_hi:[1,0,1]
    v_pk_mul_f32 v[40:41], v[40:41], v[62:63] op_sel:[0,1] op_sel_hi:[1,1]
    v_pk_mul_f32 v[42:43], v[42:43], v[62:63] op_sel:[0,1] op_sel_hi:[1,1]
    s_cmp_lg_u32 s24, 0
    s_cbranch_scc1 proj_kernel_qkv_vstore
    v_cvt_pk_bf16_f32 v2, v28, v29
    v_cvt_pk_bf16_f32 v3, v30, v31
    v_cvt_pk_bf16_f32 v4, v32, v33
    v_cvt_pk_bf16_f32 v5, v34, v35
    s_add_u32 s70, s67, 0
    s_nop 0
    buffer_store_dwordx4 v[2:5], v20, s[40:43], s70 offen sc1
    v_cvt_pk_bf16_f32 v6, v36, v37
    v_cvt_pk_bf16_f32 v7, v38, v39
    v_cvt_pk_bf16_f32 v8, v40, v41
    v_cvt_pk_bf16_f32 v9, v42, v43
    s_add_u32 s70, s67, 256
    buffer_store_dwordx4 v[6:9], v20, s[40:43], s70 offen sc1
    v_mul_f32 v10, v28, v28
    v_mul_f32 v11, v36, v36
    v_fmac_f32 v10, v29, v29
    v_fmac_f32 v11, v37, v37
    v_fmac_f32 v10, v30, v30
    v_fmac_f32 v11, v38, v38
    v_fmac_f32 v10, v31, v31
    v_fmac_f32 v11, v39, v39
    v_fmac_f32 v10, v32, v32
    v_fmac_f32 v11, v40, v40
    v_fmac_f32 v10, v33, v33
    v_fmac_f32 v11, v41, v41
    v_fmac_f32 v10, v34, v34
    v_fmac_f32 v11, v42, v42
    v_fmac_f32 v10, v35, v35
    v_fmac_f32 v11, v43, v43
    v_mov_b32 v14, v10
    v_mov_b32 v15, v11
    s_nop 0
    v_permlane16_swap_b32 v10, v14
    v_permlane16_swap_b32 v11, v15
    s_nop 0
    v_add_f32 v10, v10, v14
    v_add_f32 v11, v11, v15
    v_mov_b32 v14, v10
    v_mov_b32 v15, v11
    s_nop 0
    v_permlane32_swap_b32 v10, v14
    v_permlane32_swap_b32 v11, v15
    s_nop 0
    v_add_f32 v10, v10, v14
    v_add_f32 v11, v11, v15
    v_and_b32_e64 v22, 15, v0
    v_and_b32 v10, 0x7ffffff0, v10
    v_and_b32 v11, 0x7ffffff0, v11
    v_or_b32 v10, v10, v22
    v_or_b32 v11, v11, v22
    v_mov_b32 v12, v10
    v_mov_b32_e64 v13, v11
    s_nop 0
    v_max_u32_dpp v12, v12, v12 quad_perm:[1,0,3,2] row_mask:0xf bank_mask:0xf
    v_max_u32_dpp v13, v13, v13 quad_perm:[1,0,3,2] row_mask:0xf bank_mask:0xf
    s_nop 0
    v_max_u32_dpp v12, v12, v12 quad_perm:[2,3,0,1] row_mask:0xf bank_mask:0xf
    v_max_u32_dpp v13, v13, v13 quad_perm:[2,3,0,1] row_mask:0xf bank_mask:0xf
    s_nop 0
    v_max_u32_dpp v12, v12, v12 row_half_mirror row_mask:0xf bank_mask:0xf
    v_max_u32_dpp v13, v13, v13 row_half_mirror row_mask:0xf bank_mask:0xf
    s_nop 0
    v_max_u32_dpp v12, v12, v12 row_mirror row_mask:0xf bank_mask:0xf
    v_max_u32_dpp v13, v13, v13 row_mirror row_mask:0xf bank_mask:0xf
    s_lshl_b32 s68, s20, 3
    s_lshl_b32 s71, s25, 1
    s_add_u32 s68, s68, s71
    s_add_u32 s68, s68, s23
    s_lshr_b32 s71, s68, 4
    s_lshl_b32 s71, s71, 11
    s_and_b32 s68, s68, 15
    s_lshl_b32 s68, s68, 5
    s_add_u32 s68, s68, s71
    s_add_u32 s68, s68, 286720
    v_lshrrev_b32 v21, 5, v0
    v_lshlrev_b32 v21, 10, v21
    v_bfe_u32 v22, v0, 4, 1
    v_lshl_add_u32 v21, v22, 9, v21
    v_cmp_eq_u32 vcc, v10, v12
    s_and_saveexec_b64 s[4:5], vcc
    buffer_store_dwordx4 v[2:5], v21, s[40:43], s68 offen offset:0 sc1
    s_mov_b64 exec, s[4:5]
    v_cmp_eq_u32 vcc, v11, v13
    s_and_saveexec_b64 s[4:5], vcc
    buffer_store_dwordx4 v[6:9], v21, s[40:43], s68 offen offset:16 sc1
    s_mov_b64 exec, s[4:5]
    s_branch proj_kernel_qkv_end
proj_kernel_qkv_vstore:
    s_lshl_b32 s68, s22, 11
    s_add_u32 s68, s68, 4096
    v_and_b32 v20, 15, v0
    v_lshlrev_b32 v20, 6, v20
    v_lshrrev_b32_e64 v21, 4, v0
    v_lshl_add_u32 v20, v21, 3, v20
    v_add_u32_e64 v20, s68, v20
    v_mul_f32 v28, 0x5f800000, v28
    v_mul_f32 v29, 0x5f800000, v29
    v_mul_f32 v30, 0x5f800000, v30
    v_mul_f32 v31, 0x5f800000, v31
    v_mul_f32 v32, 0x5f800000, v32
    v_mul_f32 v33, 0x5f800000, v33
    v_mul_f32 v34, 0x5f800000, v34
    v_mul_f32 v35, 0x5f800000, v35
    v_mul_f32 v36, 0x5f800000, v36
    v_mul_f32 v37, 0x5f800000, v37
    v_mul_f32 v38, 0x5f800000, v38
    v_mul_f32 v39, 0x5f800000, v39
    v_mul_f32 v40, 0x5f800000, v40
    v_mul_f32 v41, 0x5f800000, v41
    v_mul_f32 v42, 0x5f800000, v42
    v_mul_f32 v43, 0x5f800000, v43
    v_cvt_pk_bf16_f32 v2, v28, v29
    v_cvt_pk_bf16_f32 v3, v30, v31
    v_cvt_pk_bf16_f32 v4, v32, v33
    v_cvt_pk_bf16_f32 v5, v34, v35
    v_cvt_pk_bf16_f32 v6, v36, v37
    v_cvt_pk_bf16_f32 v7, v38, v39
    v_cvt_pk_bf16_f32 v8, v40, v41
    v_cvt_pk_bf16_f32 v9, v42, v43
    ds_write_b64 v20, v[2:3] offset:0
    ds_write_b64 v20, v[4:5] offset:32
    ds_write_b64 v20, v[6:7] offset:1024
    ds_write_b64 v20, v[8:9] offset:1056
    v_lshrrev_b32_e64 v21, 5, v0
    v_bfe_u32 v22, v0, 2, 2
    v_lshl_add_u32 v21, v21, 2, v22
    v_lshlrev_b32_e64 v21, 6, v21
    v_bfe_u32 v22, v0, 4, 1
    v_lshl_add_u32 v21, v22, 5, v21
    v_and_b32_e64 v22, 3, v0
    v_lshl_add_u32 v21, v22, 3, v21
    v_add_u32 v21, s68, v21
    s_waitcnt lgkmcnt(0)
    ds_read_b64_tr_b16 v[10:11], v21 offset:0
    ds_read_b64_tr_b16 v[12:13], v21 offset:512
    ds_read_b64_tr_b16 v[14:15], v21 offset:1024
    ds_read_b64_tr_b16 v[16:17], v21 offset:1536
    v_lshlrev_b32_e64 v20, 4, v0
    s_add_u32 s67, s67, 131072
    s_waitcnt lgkmcnt(0)
    buffer_store_dwordx4 v[10:13], v20, s[40:43], s67 offen offset:0 sc1
    buffer_store_dwordx4 v[14:17], v20, s[40:43], s67 offen offset:1024 sc1
proj_kernel_qkv_end:
    s_endpgm
proj_kernel_qkv_pfend:
proj_kernel_done:
    s_endpgm
.text
.globl attn_out_kernel
.p2align 8
.type attn_out_kernel,@function
attn_out_kernel:
    s_cmp_ge_u32 s2, 512
    s_cbranch_scc1 attn_out_kernel_done
    s_nop 0
    s_load_dwordx2 s[4:5], s[0:1], 0
    s_load_dwordx2 s[6:7], s[0:1], 32
    s_load_dwordx4 s[8:11], s[0:1], 64
    s_load_dwordx4 s[16:19], s[0:1], 80
    s_cmp_ge_u32 s2, 256
    s_waitcnt lgkmcnt(0)
    s_cbranch_scc1 attn_out_kernel_gemm
    v_lshrrev_b32 v1, 6, v0
    v_and_b32_e64 v0, 63, v0
    v_readfirstlane_b32 s24, v1
    s_add_u32 s40, s18, 29360128
    s_addc_u32 s41, s19, 0
    s_nop 0
    s_mov_b32 s42, 294912
    s_mov_b32 s43, 0x20000
    s_add_u32 s44, s18, 25165824
    s_addc_u32 s45, s19, 0
    s_nop 0
    s_mov_b32 s46, 4194304
    s_mov_b32 s47, 0x20000
    s_add_u32 s48, s18, 4194304
    s_addc_u32 s49, s19, 0
    s_mov_b32 s50, 18874368
    s_mov_b32 s51, 0x20000
    s_and_b32 s34, s2, 15
    s_lshl_b32 s34, s34, 1
    s_lshr_b32 s35, s24, 1
    s_add_u32 s25, s34, s35
    s_lshr_b32 s34, s2, 4
    s_lshl_b32 s34, s34, 2
    s_and_b32 s35, s24, 1
    s_lshl_b32 s35, s35, 1
    s_add_u32 s26, s34, s35
    v_lshlrev_b32 v6, 4, v0
    s_lshl_b32 s30, s24, 11
    v_add_u32 v5, s30, v6
    s_lshl_b32 s34, s25, 6
    s_add_u32 s34, s34, s26
    s_lshl_b32 s34, s34, 11
    v_bfe_u32 v2, v0, 4, 1
    v_lshlrev_b32 v2, 10, v2
    v_lshrrev_b32 v3, 5, v0
    v_lshl_add_u32 v2, v3, 8, v2
    v_and_b32_e64 v3, 15, v0
    v_lshl_add_u32 v2, v3, 4, v2
    buffer_load_dwordx4 v[10:13], v2, s[44:47], s34 offen offset:0
    buffer_load_dwordx4 v[14:17], v2, s[44:47], s34 offen offset:512
    buffer_load_dwordx4 v[18:21], v2, s[44:47], s34 offen offset:2048
    buffer_load_dwordx4 v[22:25], v2, s[44:47], s34 offen offset:2560
    s_mov_b32 s35, 286720
    s_mov_b32 s36, 290816
    buffer_load_dwordx4 v[108:111], v6, s[40:43], s35 offen offset:0
    buffer_load_dwordx4 v[112:115], v6, s[40:43], s35 offen offset:1024
    buffer_load_dwordx4 v[116:119], v6, s[40:43], s35 offen offset:2048
    buffer_load_dwordx4 v[120:123], v6, s[40:43], s35 offen offset:3072
    buffer_load_dwordx4 v[124:127], v6, s[40:43], s36 offen offset:0
    buffer_load_dwordx4 v[128:131], v6, s[40:43], s36 offen offset:1024
    buffer_load_dwordx4 v[132:135], v6, s[40:43], s36 offen offset:2048
    buffer_load_dwordx4 v[136:139], v6, s[40:43], s36 offen offset:3072
    s_mov_b32 s28, 0
    s_mov_b32 s32, 32768
    s_mov_b32 s29, 0
    s_add_u32 m0, s28, s30
    s_nop 0
    buffer_load_dwordx4 v5, s[40:43], s29 offen lds
    buffer_load_dwordx4 v5, s[40:43], s29 offen offset:1024 lds
    s_add_u32 m0, m0, 8192
    s_add_u32 s39, s29, 131072
    buffer_load_dwordx4 v5, s[40:43], s39 offen lds
    buffer_load_dwordx4 v5, s[40:43], s39 offen offset:1024 lds
    s_mov_b32 s28, 16384
    s_mov_b32 s32, 49152
    s_mov_b32 s29, 8192
    s_add_u32 m0, s28, s30
    s_nop 0
    buffer_load_dwordx4 v5, s[40:43], s29 offen lds
    buffer_load_dwordx4 v5, s[40:43], s29 offen offset:1024 lds
    s_add_u32 m0, m0, 8192
    s_add_u32 s39, s29, 131072
    buffer_load_dwordx4 v5, s[40:43], s39 offen lds
    buffer_load_dwordx4 v5, s[40:43], s39 offen offset:1024 lds
    v_and_b32_e64 v1, 15, v0
    v_bfe_u32 v2, v0, 4, 1
    v_lshlrev_b32 v2, 2, v2
    v_and_b32_e64 v4, 7, v1
    v_cmp_eq_u32 vcc, v4, v2
    v_mov_b32 v4, 0x3f803f80
    s_nop 0
    v_cndmask_b32 v180, 0, v4, vcc
    v_mov_b32 v181, v180
    v_mov_b32 v182, v180
    v_mov_b32_e64 v183, v180
    v_mov_b32 v186, 0xff800000
    v_mov_b32 v187, 0xff800000
    s_waitcnt vmcnt(8)
    s_nop 0
    v_mfma_f32_32x32x16_bf16 v[60:75], v[108:111], v[10:13], 0
    v_mfma_f32_32x32x16_bf16 v[60:75], v[112:115], v[14:17], v[60:75]
    v_mfma_f32_32x32x16_bf16 v[76:91], v[108:111], v[18:21], 0
    v_mfma_f32_32x32x16_bf16 v[76:91], v[112:115], v[22:25], v[76:91]
    s_nop 7
    s_nop 3
    v_mfma_f32_32x32x16_bf16 v[28:43], v[116:119], v[10:13], 0
    v_max3_f32 v186, v60, v61, v186
    v_max3_f32 v186, v62, v63, v186
    v_max3_f32 v186, v64, v65, v186
    v_max3_f32 v186, v66, v67, v186
    v_mfma_f32_32x32x16_bf16 v[28:43], v[120:123], v[14:17], v[28:43]
    v_max3_f32 v186, v68, v69, v186
    v_max3_f32 v186, v70, v71, v186
    v_max3_f32 v186, v72, v73, v186
    v_max3_f32 v186, v74, v75, v186
    v_mfma_f32_32x32x16_bf16 v[44:59], v[116:119], v[18:21], 0
    v_max3_f32 v187, v76, v77, v187
    v_max3_f32 v187, v78, v79, v187
    v_max3_f32 v187, v80, v81, v187
    v_max3_f32 v187, v82, v83, v187
    v_mfma_f32_32x32x16_bf16 v[44:59], v[120:123], v[22:25], v[44:59]
    v_max3_f32 v187, v84, v85, v187
    v_max3_f32 v187, v86, v87, v187
    v_max3_f32 v187, v88, v89, v187
    v_max3_f32 v187, v90, v91, v187
    v_mfma_f32_32x32x16_bf16 v[60:75], v[124:127], v[10:13], 0
    v_max3_f32 v186, v28, v29, v186
    v_max3_f32 v186, v30, v31, v186
    v_max3_f32 v186, v32, v33, v186
    v_max3_f32 v186, v34, v35, v186
    v_mfma_f32_32x32x16_bf16 v[60:75], v[128:131], v[14:17], v[60:75]
    v_max3_f32 v186, v36, v37, v186
    v_max3_f32 v186, v38, v39, v186
    v_max3_f32 v186, v40, v41, v186
    v_max3_f32 v186, v42, v43, v186
    v_mfma_f32_32x32x16_bf16 v[76:91], v[124:127], v[18:21], 0
    v_max3_f32 v187, v44, v45, v187
    v_max3_f32 v187, v46, v47, v187
    v_max3_f32 v187, v48, v49, v187
    v_max3_f32 v187, v50, v51, v187
    v_mfma_f32_32x32x16_bf16 v[76:91], v[128:131], v[22:25], v[76:91]
    v_max3_f32 v187, v52, v53, v187
    v_max3_f32 v187, v54, v55, v187
    v_max3_f32 v187, v56, v57, v187
    v_max3_f32 v187, v58, v59, v187
    v_mfma_f32_32x32x16_bf16 v[28:43], v[132:135], v[10:13], 0
    v_max3_f32 v186, v60, v61, v186
    v_max3_f32 v186, v62, v63, v186
    v_max3_f32 v186, v64, v65, v186
    v_max3_f32 v186, v66, v67, v186
    v_mfma_f32_32x32x16_bf16 v[28:43], v[136:139], v[14:17], v[28:43]
    v_max3_f32 v186, v68, v69, v186
    v_max3_f32 v186, v70, v71, v186
    v_max3_f32 v186, v72, v73, v186
    v_max3_f32 v186, v74, v75, v186
    v_mfma_f32_32x32x16_bf16 v[44:59], v[132:135], v[18:21], 0
    v_max3_f32 v187, v76, v77, v187
    v_max3_f32 v187, v78, v79, v187
    v_max3_f32 v187, v80, v81, v187
    v_max3_f32 v187, v82, v83, v187
    v_mfma_f32_32x32x16_bf16 v[44:59], v[136:139], v[22:25], v[44:59]
    v_max3_f32 v187, v84, v85, v187
    v_max3_f32 v187, v86, v87, v187
    v_max3_f32 v187, v88, v89, v187
    v_max3_f32 v187, v90, v91, v187
    v_mov_b32 v108, 0
    v_mov_b32 v109, 0
    v_mov_b32 v110, 0
    v_mov_b32 v111, 0
    v_mov_b32 v112, 0
    v_mov_b32 v113, 0
    v_mov_b32 v114, 0
    v_mov_b32 v115, 0
    v_mov_b32 v116, 0
    v_mov_b32 v117, 0
    v_mov_b32 v118, 0
    v_mov_b32 v119, 0
    v_mov_b32 v120, 0
    v_mov_b32 v121, 0
    v_mov_b32 v122, 0
    v_mov_b32 v123, 0
    v_mov_b32 v140, 0
    v_mov_b32 v141, 0
    v_mov_b32 v142, 0
    v_mov_b32 v143, 0
    v_mov_b32 v124, 0
    v_mov_b32 v125, 0
    v_mov_b32 v126, 0
    v_mov_b32 v127, 0
    v_mov_b32 v128, 0
    v_mov_b32 v129, 0
    v_mov_b32 v130, 0
    v_mov_b32 v131, 0
    v_mov_b32 v132, 0
    v_mov_b32 v133, 0
    v_mov_b32 v134, 0
    v_mov_b32 v135, 0
    v_mov_b32 v136, 0
    v_mov_b32 v137, 0
    v_mov_b32 v138, 0
    v_mov_b32 v139, 0
    v_mov_b32 v144, 0
    v_mov_b32 v145, 0
    v_mov_b32 v146, 0
    v_mov_b32 v147, 0
    v_max3_f32 v186, v28, v29, v186
    v_max3_f32 v187, v44, v45, v187
    v_max3_f32 v186, v30, v31, v186
    v_max3_f32 v187, v46, v47, v187
    v_max3_f32 v186, v32, v33, v186
    v_max3_f32 v187, v48, v49, v187
    v_max3_f32 v186, v34, v35, v186
    v_max3_f32 v187, v50, v51, v187
    v_max3_f32 v186, v36, v37, v186
    v_max3_f32 v187, v52, v53, v187
    v_max3_f32 v186, v38, v39, v186
    v_max3_f32 v187, v54, v55, v187
    v_max3_f32 v186, v40, v41, v186
    v_max3_f32 v187, v56, v57, v187
    v_max3_f32 v186, v42, v43, v186
    v_max3_f32 v187, v58, v59, v187
    v_mov_b32 v4, v186
    s_nop 1
    v_permlane32_swap_b32 v186, v4
    s_nop 1
    v_max_f32_e64 v186, v186, v4
    v_sub_f32 v2, 0xc2cc0000, v186
    v_mov_b32 v28, v2
    v_mov_b32 v29, v2
    v_mov_b32 v30, v2
    v_mov_b32 v31, v2
    v_mov_b32 v32, v2
    v_mov_b32 v33, v2
    v_mov_b32 v34, v2
    v_mov_b32 v35, v2
    v_mov_b32 v36, v2
    v_mov_b32 v37, v2
    v_mov_b32 v38, v2
    v_mov_b32 v39, v2
    v_mov_b32 v40, v2
    v_mov_b32 v41, v2
    v_mov_b32 v42, v2
    v_mov_b32 v43, v2
    v_mov_b32 v4, v187
    s_nop 1
    v_permlane32_swap_b32 v187, v4
    s_nop 1
    v_max_f32_e64 v187, v187, v4
    v_sub_f32 v2, 0xc2cc0000, v187
    v_mov_b32 v44, v2
    v_mov_b32 v45, v2
    v_mov_b32 v46, v2
    v_mov_b32 v47, v2
    v_mov_b32 v48, v2
    v_mov_b32 v49, v2
    v_mov_b32 v50, v2
    v_mov_b32 v51, v2
    v_mov_b32 v52, v2
    v_mov_b32 v53, v2
    v_mov_b32 v54, v2
    v_mov_b32 v55, v2
    v_mov_b32 v56, v2
    v_mov_b32 v57, v2
    v_mov_b32 v58, v2
    v_mov_b32 v59, v2
    s_waitcnt vmcnt(4)
    s_barrier
    v_mov_b32_e64 v7, v6
    ds_read_b128 v[148:151], v7 offset:0
    ds_read_b128 v[152:155], v7 offset:1024
    s_waitcnt lgkmcnt(0)
    v_mfma_f32_32x32x16_bf16 v[60:75], v[148:151], v[10:13], v[28:43]
    v_mfma_f32_32x32x16_bf16 v[60:75], v[152:155], v[14:17], v[60:75]
    v_mov_b32 v100, 0
    v_mov_b32 v172, 0
    v_mov_b32 v101, 0
    v_mov_b32 v173, 0
    v_mov_b32 v102, 0
    v_mov_b32 v174, 0
    v_mov_b32 v103, 0
    v_mov_b32 v175, 0
    v_mov_b32 v104, 0
    v_mov_b32 v176, 0
    v_mov_b32 v105, 0
    v_mov_b32 v177, 0
    v_mov_b32 v106, 0
    v_mov_b32 v178, 0
    v_mov_b32 v107, 0
    v_mov_b32 v179, 0
    s_mov_b32 s31, 0
    s_mov_b32 s28, 32768
    s_mov_b32 s29, 16384
    s_mov_b32 s27, 16
attn_out_kernel_att_loop:
    v_mfma_f32_32x32x16_bf16 v[76:91], v[148:151], v[18:21], v[44:59]
    v_exp_f32 v60, v60
    v_exp_f32 v61, v61
    v_exp_f32 v62, v62
    v_cvt_pk_bf16_f32 v92, v60, v61
    v_mfma_f32_32x32x16_bf16 v[76:91], v[152:155], v[22:25], v[76:91]
    v_exp_f32 v63, v63
    v_exp_f32 v64, v64
    ds_read_b128 v[156:159], v7 offset:2048
    ds_read_b128 v[160:163], v7 offset:3072
    ds_read_b128 v[164:167], v7 offset:8192
    ds_read_b128 v[168:171], v7 offset:9216
    v_cvt_pk_bf16_f32 v93, v62, v63
    v_exp_f32 v65, v65
    v_exp_f32 v66, v66
    v_mfma_f32_32x32x16_bf16 v[124:139], v[172:175], v[100:103], v[124:139]
    v_cvt_pk_bf16_f32 v94, v64, v65
    v_exp_f32 v67, v67
    v_exp_f32 v68, v68
    v_cvt_pk_bf16_f32 v95, v66, v67
    v_mfma_f32_16x16x32_bf16 v[144:147], v[180:183], v[100:103], v[144:147]
    v_exp_f32 v69, v69
    v_exp_f32 v70, v70
    v_cvt_pk_bf16_f32 v96, v68, v69
    v_exp_f32 v71, v71
    v_exp_f32 v72, v72
    v_mfma_f32_32x32x16_bf16 v[124:139], v[176:179], v[104:107], v[124:139]
    v_cvt_pk_bf16_f32 v97, v70, v71
    v_exp_f32 v73, v73
    v_exp_f32 v74, v74
    v_cvt_pk_bf16_f32 v98, v72, v73
    v_exp_f32_e64 v75, v75
    v_mfma_f32_16x16x32_bf16 v[144:147], v[180:183], v[104:107], v[144:147]
    v_cvt_pk_bf16_f32 v99, v74, v75
    s_waitcnt lgkmcnt(0)
    v_mfma_f32_32x32x16_bf16 v[60:75], v[156:159], v[10:13], v[28:43]
    v_exp_f32 v76, v76
    v_exp_f32 v77, v77
    v_exp_f32 v78, v78
    v_cvt_pk_bf16_f32 v100, v76, v77
    v_mfma_f32_32x32x16_bf16 v[60:75], v[160:163], v[14:17], v[60:75]
    v_exp_f32 v79, v79
    v_exp_f32 v80, v80
    v_cvt_pk_bf16_f32 v101, v78, v79
    v_exp_f32 v81, v81
    v_exp_f32 v82, v82
    v_mfma_f32_32x32x16_bf16 v[108:123], v[164:167], v[92:95], v[108:123]
    v_cvt_pk_bf16_f32 v102, v80, v81
    v_exp_f32 v83, v83
    v_exp_f32 v84, v84
    v_cvt_pk_bf16_f32 v103, v82, v83
    v_mfma_f32_16x16x32_bf16 v[140:143], v[180:183], v[92:95], v[140:143]
    v_exp_f32 v85, v85
    v_exp_f32 v86, v86
    v_cvt_pk_bf16_f32 v104, v84, v85
    v_exp_f32 v87, v87
    v_exp_f32 v88, v88
    v_mfma_f32_32x32x16_bf16 v[108:123], v[168:171], v[96:99], v[108:123]
    v_cvt_pk_bf16_f32 v105, v86, v87
    v_exp_f32 v89, v89
    v_exp_f32 v90, v90
    v_cvt_pk_bf16_f32 v106, v88, v89
    v_exp_f32_e64 v91, v91
    v_mfma_f32_16x16x32_bf16 v[140:143], v[180:183], v[96:99], v[140:143]
    v_cvt_pk_bf16_f32 v107, v90, v91
    v_mfma_f32_32x32x16_bf16 v[76:91], v[156:159], v[18:21], v[44:59]
    v_exp_f32 v60, v60
    v_exp_f32 v61, v61
    v_exp_f32_e64 v62, v62
    v_cvt_pk_bf16_f32 v92, v60, v61
    v_mfma_f32_32x32x16_bf16 v[76:91], v[160:163], v[22:25], v[76:91]
    v_exp_f32 v63, v63
    v_exp_f32 v64, v64
    ds_read_b128 v[148:151], v7 offset:4096
    ds_read_b128 v[152:155], v7 offset:5120
    ds_read_b128 v[172:175], v7 offset:10240
    ds_read_b128 v[176:179], v7 offset:11264
    v_cvt_pk_bf16_f32 v93, v62, v63
    v_exp_f32 v65, v65
    v_exp_f32 v66, v66
    v_mfma_f32_32x32x16_bf16 v[124:139], v[164:167], v[100:103], v[124:139]
    v_cvt_pk_bf16_f32 v94, v64, v65
    v_exp_f32 v67, v67
    v_exp_f32 v68, v68
    v_cvt_pk_bf16_f32 v95, v66, v67
    v_mfma_f32_16x16x32_bf16 v[144:147], v[180:183], v[100:103], v[144:147]
    v_exp_f32 v69, v69
    v_exp_f32 v70, v70
    v_cvt_pk_bf16_f32 v96, v68, v69
    v_exp_f32 v71, v71
    v_exp_f32 v72, v72
    v_mfma_f32_32x32x16_bf16 v[124:139], v[168:171], v[104:107], v[124:139]
    v_cvt_pk_bf16_f32 v97, v70, v71
    v_exp_f32 v73, v73
    v_exp_f32 v74, v74
    v_cvt_pk_bf16_f32 v98, v72, v73
    v_exp_f32_e64 v75, v75
    v_mfma_f32_16x16x32_bf16 v[144:147], v[180:183], v[104:107], v[144:147]
    v_cvt_pk_bf16_f32 v99, v74, v75
    s_waitcnt lgkmcnt(0)
    v_mfma_f32_32x32x16_bf16 v[60:75], v[148:151], v[10:13], v[28:43]
    v_exp_f32 v76, v76
    v_exp_f32 v77, v77
    v_exp_f32 v78, v78
    v_cvt_pk_bf16_f32 v100, v76, v77
    v_mfma_f32_32x32x16_bf16 v[60:75], v[152:155], v[14:17], v[60:75]
    v_exp_f32 v79, v79
    v_exp_f32 v80, v80
    v_cvt_pk_bf16_f32 v101, v78, v79
    v_exp_f32 v81, v81
    v_exp_f32 v82, v82
    v_mfma_f32_32x32x16_bf16 v[108:123], v[172:175], v[92:95], v[108:123]
    v_cvt_pk_bf16_f32 v102, v80, v81
    v_exp_f32 v83, v83
    v_exp_f32 v84, v84
    v_cvt_pk_bf16_f32 v103, v82, v83
    v_mfma_f32_16x16x32_bf16 v[140:143], v[180:183], v[92:95], v[140:143]
    v_exp_f32 v85, v85
    v_exp_f32 v86, v86
    v_cvt_pk_bf16_f32 v104, v84, v85
    v_exp_f32 v87, v87
    v_exp_f32 v88, v88
    v_mfma_f32_32x32x16_bf16 v[108:123], v[176:179], v[96:99], v[108:123]
    v_cvt_pk_bf16_f32 v105, v86, v87
    v_exp_f32 v89, v89
    v_exp_f32 v90, v90
    v_cvt_pk_bf16_f32 v106, v88, v89
    v_exp_f32_e64 v91, v91
    v_mfma_f32_16x16x32_bf16 v[140:143], v[180:183], v[96:99], v[140:143]
    v_cvt_pk_bf16_f32 v107, v90, v91
    v_mfma_f32_32x32x16_bf16 v[76:91], v[148:151], v[18:21], v[44:59]
    v_exp_f32 v60, v60
    v_exp_f32 v61, v61
    v_exp_f32_e64 v62, v62
    v_cvt_pk_bf16_f32 v92, v60, v61
    v_mfma_f32_32x32x16_bf16 v[76:91], v[152:155], v[22:25], v[76:91]
    v_exp_f32 v63, v63
    v_exp_f32 v64, v64
    ds_read_b128 v[156:159], v7 offset:6144
    ds_read_b128 v[160:163], v7 offset:7168
    ds_read_b128 v[164:167], v7 offset:12288
    ds_read_b128 v[168:171], v7 offset:13312
    v_cvt_pk_bf16_f32 v93, v62, v63
    v_exp_f32 v65, v65
    v_exp_f32 v66, v66
    v_mfma_f32_32x32x16_bf16 v[124:139], v[172:175], v[100:103], v[124:139]
    v_cvt_pk_bf16_f32 v94, v64, v65
    v_exp_f32 v67, v67
    v_exp_f32 v68, v68
    v_cvt_pk_bf16_f32 v95, v66, v67
    v_mfma_f32_16x16x32_bf16 v[144:147], v[180:183], v[100:103], v[144:147]
    v_exp_f32 v69, v69
    v_exp_f32 v70, v70
    v_cvt_pk_bf16_f32 v96, v68, v69
    v_exp_f32 v71, v71
    v_exp_f32 v72, v72
    v_mfma_f32_32x32x16_bf16 v[124:139], v[176:179], v[104:107], v[124:139]
    v_cvt_pk_bf16_f32 v97, v70, v71
    v_exp_f32 v73, v73
    v_exp_f32 v74, v74
    v_cvt_pk_bf16_f32 v98, v72, v73
    v_exp_f32_e64 v75, v75
    v_mfma_f32_16x16x32_bf16 v[144:147], v[180:183], v[104:107], v[144:147]
    v_cvt_pk_bf16_f32 v99, v74, v75
    s_waitcnt lgkmcnt(0)
    v_mfma_f32_32x32x16_bf16 v[60:75], v[156:159], v[10:13], v[28:43]
    v_exp_f32 v76, v76
    v_exp_f32 v77, v77
    v_exp_f32 v78, v78
    v_cvt_pk_bf16_f32 v100, v76, v77
    v_mfma_f32_32x32x16_bf16 v[60:75], v[160:163], v[14:17], v[60:75]
    v_exp_f32 v79, v79
    v_exp_f32 v80, v80
    v_cvt_pk_bf16_f32 v101, v78, v79
    v_exp_f32 v81, v81
    v_exp_f32 v82, v82
    v_mfma_f32_32x32x16_bf16 v[108:123], v[164:167], v[92:95], v[108:123]
    v_cvt_pk_bf16_f32 v102, v80, v81
    v_exp_f32 v83, v83
    v_exp_f32 v84, v84
    v_cvt_pk_bf16_f32 v103, v82, v83
    v_mfma_f32_16x16x32_bf16 v[140:143], v[180:183], v[92:95], v[140:143]
    v_exp_f32 v85, v85
    v_exp_f32 v86, v86
    v_cvt_pk_bf16_f32 v104, v84, v85
    v_exp_f32 v87, v87
    v_exp_f32 v88, v88
    v_mfma_f32_32x32x16_bf16 v[108:123], v[168:171], v[96:99], v[108:123]
    v_cvt_pk_bf16_f32 v105, v86, v87
    v_exp_f32 v89, v89
    v_exp_f32 v90, v90
    v_cvt_pk_bf16_f32 v106, v88, v89
    v_exp_f32_e64 v91, v91
    v_mfma_f32_16x16x32_bf16 v[140:143], v[180:183], v[96:99], v[140:143]
    v_cvt_pk_bf16_f32 v107, v90, v91
    s_waitcnt vmcnt(0)
    s_barrier
    s_add_u32 s38, s31, 16384
    s_cmp_eq_u32 s38, 49152
    s_cselect_b32 s38, 0, s38
    v_add_u32 v1, s38, v6
    v_mfma_f32_32x32x16_bf16 v[76:91], v[156:159], v[18:21], v[44:59]
    v_exp_f32 v60, v60
    v_exp_f32 v61, v61
    v_exp_f32_e64 v62, v62
    v_cvt_pk_bf16_f32 v92, v60, v61
    v_mfma_f32_32x32x16_bf16 v[76:91], v[160:163], v[22:25], v[76:91]
    v_exp_f32 v63, v63
    v_exp_f32 v64, v64
    ds_read_b128 v[148:151], v1 offset:0
    ds_read_b128 v[152:155], v1 offset:1024
    ds_read_b128 v[172:175], v7 offset:14336
    ds_read_b128 v[176:179], v7 offset:15360
    v_cvt_pk_bf16_f32 v93, v62, v63
    v_exp_f32 v65, v65
    v_exp_f32 v66, v66
    v_mfma_f32_32x32x16_bf16 v[124:139], v[164:167], v[100:103], v[124:139]
    v_cvt_pk_bf16_f32 v94, v64, v65
    s_add_u32 m0, s28, s30
    s_nop 0
    buffer_load_dwordx4 v5, s[40:43], s29 offen lds
    buffer_load_dwordx4 v5, s[40:43], s29 offen offset:1024 lds
    v_exp_f32 v67, v67
    v_exp_f32 v68, v68
    v_cvt_pk_bf16_f32 v95, v66, v67
    v_mfma_f32_16x16x32_bf16 v[144:147], v[180:183], v[100:103], v[144:147]
    v_exp_f32_e64 v69, v69
    s_add_u32 m0, m0, 8192
    s_add_u32 s39, s29, 131072
    buffer_load_dwordx4 v5, s[40:43], s39 offen lds
    buffer_load_dwordx4 v5, s[40:43], s39 offen offset:1024 lds
    v_exp_f32_e64 v70, v70
    v_cvt_pk_bf16_f32 v96, v68, v69
    v_exp_f32 v71, v71
    v_exp_f32 v72, v72
    s_add_u32 s29, s29, 8192
    s_add_u32 s28, s28, 16384
    s_cmp_eq_u32 s28, 49152
    s_cselect_b32 s28, 0, s28
    v_mfma_f32_32x32x16_bf16 v[124:139], v[168:171], v[104:107], v[124:139]
    v_cvt_pk_bf16_f32 v97, v70, v71
    v_exp_f32 v73, v73
    v_exp_f32_e64 v74, v74
    v_cvt_pk_bf16_f32 v98, v72, v73
    v_exp_f32_e64 v75, v75
    v_mfma_f32_16x16x32_bf16 v[144:147], v[180:183], v[104:107], v[144:147]
    v_cvt_pk_bf16_f32 v99, v74, v75
    s_waitcnt lgkmcnt(0)
    v_mfma_f32_32x32x16_bf16 v[60:75], v[148:151], v[10:13], v[28:43]
    v_exp_f32 v76, v76
    v_exp_f32 v77, v77
    v_exp_f32 v78, v78
    v_cvt_pk_bf16_f32 v100, v76, v77
    v_mfma_f32_32x32x16_bf16 v[60:75], v[152:155], v[14:17], v[60:75]
    v_exp_f32 v79, v79
    v_exp_f32 v80, v80
    s_mov_b32 s31, s38
    v_mov_b32 v7, v1
    v_cvt_pk_bf16_f32 v101, v78, v79
    v_exp_f32 v81, v81
    v_exp_f32 v82, v82
    v_mfma_f32_32x32x16_bf16 v[108:123], v[172:175], v[92:95], v[108:123]
    v_cvt_pk_bf16_f32 v102, v80, v81
    v_exp_f32 v83, v83
    v_exp_f32 v84, v84
    v_cvt_pk_bf16_f32 v103, v82, v83
    v_mfma_f32_16x16x32_bf16 v[140:143], v[180:183], v[92:95], v[140:143]
    v_exp_f32 v85, v85
    v_exp_f32 v86, v86
    v_cvt_pk_bf16_f32 v104, v84, v85
    v_exp_f32 v87, v87
    v_exp_f32 v88, v88
    v_mfma_f32_32x32x16_bf16 v[108:123], v[176:179], v[96:99], v[108:123]
    v_cvt_pk_bf16_f32 v105, v86, v87
    v_exp_f32 v89, v89
    v_exp_f32 v90, v90
    v_cvt_pk_bf16_f32 v106, v88, v89
    v_exp_f32_e64 v91, v91
    v_mfma_f32_16x16x32_bf16 v[140:143], v[180:183], v[96:99], v[140:143]
    v_cvt_pk_bf16_f32 v107, v90, v91
    s_sub_u32 s27, s27, 1
    s_cmp_lg_u32 s27, 0
    s_cbranch_scc1 attn_out_kernel_att_loop
    s_nop 1
    v_mfma_f32_32x32x16_bf16 v[124:139], v[172:175], v[100:103], v[124:139]
    v_mfma_f32_16x16x32_bf16 v[144:147], v[180:183], v[100:103], v[144:147]
    v_mfma_f32_32x32x16_bf16 v[124:139], v[176:179], v[104:107], v[124:139]
    v_mfma_f32_16x16x32_bf16 v[144:147], v[180:183], v[104:107], v[144:147]
    s_setprio 0
    s_waitcnt vmcnt(0)
    s_nop 7
    s_nop 7
    s_mov_b32 s34, 0x0c000000
    s_mov_b32 s35, 0x7f800000
    v_add_f32 v1, abs(v108), abs(v109)
    v_add_f32 v1, abs(v110), v1
    v_add_f32 v1, abs(v111), v1
    v_add_f32 v1, abs(v112), v1
    v_add_f32 v1, abs(v113), v1
    v_add_f32 v1, abs(v114), v1
    v_add_f32 v1, abs(v115), v1
    v_add_f32 v1, abs(v116), v1
    v_add_f32 v1, abs(v117), v1
    v_add_f32 v1, abs(v118), v1
    v_add_f32 v1, abs(v119), v1
    v_add_f32 v1, abs(v120), v1
    v_add_f32 v1, abs(v121), v1
    v_add_f32 v1, abs(v122), v1
    v_add_f32 v1, abs(v123), v1
    v_add_f32 v1, v140, v1
    v_cmp_gt_f32 vcc, s35, v1
    v_cmp_le_f32 s[4:5], s34, v140
    s_nop 1
    s_and_b64 s[4:5], s[4:5], vcc
    s_cmp_eq_u64 s[4:5], exec
    s_cbranch_scc1 attn_out_kernel_att_ok0
    v_mov_b32 v3, 0xff800000
    v_mov_b32 v108, 0
    v_mov_b32 v109, 0
    v_mov_b32 v110, 0
    v_mov_b32 v111, 0
    v_mov_b32 v112, 0
    v_mov_b32 v113, 0
    v_mov_b32 v114, 0
    v_mov_b32 v115, 0
    v_mov_b32 v116, 0
    v_mov_b32 v117, 0
    v_mov_b32 v118, 0
    v_mov_b32 v119, 0
    v_mov_b32 v120, 0
    v_mov_b32 v121, 0
    v_mov_b32 v122, 0
    v_mov_b32 v123, 0
    v_mov_b32 v140, 0
    v_mov_b32 v141, 0
    v_mov_b32 v142, 0
    v_mov_b32 v143, 0
    s_mov_b32 s36, 0
attn_out_kernel_att_slow0_loop:
    s_nop 0
    s_add_u32 s37, s36, 131072
    buffer_load_dwordx4 v[148:151], v6, s[40:43], s36 offen offset:0
    buffer_load_dwordx4 v[164:167], v6, s[40:43], s37 offen offset:0
    buffer_load_dwordx4 v[152:155], v6, s[40:43], s36 offen offset:1024
    buffer_load_dwordx4 v[168:171], v6, s[40:43], s37 offen offset:1024
    s_waitcnt vmcnt(0)
    v_mfma_f32_32x32x16_bf16 v[60:75], v[148:151], v[10:13], 0
    v_mfma_f32_32x32x16_bf16 v[60:75], v[152:155], v[14:17], v[60:75]
    s_nop 7
    s_nop 7
    s_nop 0
    v_max3_f32 v4, v60, v61, v3
    v_max3_f32 v4, v62, v63, v4
    v_max3_f32 v4, v64, v65, v4
    v_max3_f32 v4, v66, v67, v4
    v_max3_f32 v4, v68, v69, v4
    v_max3_f32 v4, v70, v71, v4
    v_max3_f32 v4, v72, v73, v4
    v_max3_f32 v4, v74, v75, v4
    v_mov_b32 v1, v4
    s_nop 1
    v_permlane32_swap_b32 v4, v1
    s_nop 1
    v_max_f32 v4, v4, v1
    v_sub_f32 v1, v3, v4
    v_exp_f32 v1, v1
    v_mov_b32 v3, v4
    v_sub_f32 v60, v60, v4
    v_sub_f32 v61, v61, v4
    v_sub_f32 v62, v62, v4
    v_sub_f32 v63, v63, v4
    v_sub_f32 v64, v64, v4
    v_sub_f32 v65, v65, v4
    v_sub_f32 v66, v66, v4
    v_sub_f32 v67, v67, v4
    v_sub_f32 v68, v68, v4
    v_sub_f32 v69, v69, v4
    v_sub_f32 v70, v70, v4
    v_sub_f32 v71, v71, v4
    v_sub_f32 v72, v72, v4
    v_sub_f32 v73, v73, v4
    v_sub_f32 v74, v74, v4
    v_sub_f32 v75, v75, v4
    v_exp_f32 v60, v60
    v_exp_f32 v61, v61
    v_exp_f32 v62, v62
    v_exp_f32 v63, v63
    v_exp_f32 v64, v64
    v_exp_f32 v65, v65
    v_exp_f32 v66, v66
    v_exp_f32 v67, v67
    v_exp_f32 v68, v68
    v_exp_f32 v69, v69
    v_exp_f32 v70, v70
    v_exp_f32 v71, v71
    v_exp_f32 v72, v72
    v_exp_f32 v73, v73
    v_exp_f32 v74, v74
    v_exp_f32 v75, v75
    v_mul_f32 v108, v108, v1
    v_mul_f32 v109, v109, v1
    v_mul_f32 v110, v110, v1
    v_mul_f32 v111, v111, v1
    v_mul_f32 v112, v112, v1
    v_mul_f32 v113, v113, v1
    v_mul_f32 v114, v114, v1
    v_mul_f32 v115, v115, v1
    v_mul_f32 v116, v116, v1
    v_mul_f32 v117, v117, v1
    v_mul_f32 v118, v118, v1
    v_mul_f32 v119, v119, v1
    v_mul_f32 v120, v120, v1
    v_mul_f32 v121, v121, v1
    v_mul_f32 v122, v122, v1
    v_mul_f32 v123, v123, v1
    v_mul_f32_e64 v140, v140, v1
    v_cvt_pk_bf16_f32 v92, v60, v61
    v_cvt_pk_bf16_f32 v93, v62, v63
    v_cvt_pk_bf16_f32 v94, v64, v65
    v_cvt_pk_bf16_f32 v95, v66, v67
    v_cvt_pk_bf16_f32 v96, v68, v69
    v_cvt_pk_bf16_f32 v97, v70, v71
    v_cvt_pk_bf16_f32 v98, v72, v73
    v_cvt_pk_bf16_f32 v99, v74, v75
    s_nop 1
    s_nop 0
    v_mfma_f32_32x32x16_bf16 v[108:123], v[164:167], v[92:95], v[108:123]
    v_mfma_f32_16x16x32_bf16 v[140:143], v[180:183], v[92:95], v[140:143]
    v_mfma_f32_32x32x16_bf16 v[108:123], v[168:171], v[96:99], v[108:123]
    v_mfma_f32_16x16x32_bf16 v[140:143], v[180:183], v[96:99], v[140:143]
    s_nop 7
    s_nop 7
    s_nop 7
    s_add_u32 s36, s36, 2048
    s_cmp_lt_u32 s36, 131072
    s_cbranch_scc1 attn_out_kernel_att_slow0_loop
attn_out_kernel_att_ok0:
    v_rcp_f32 v2, v140
    s_nop 0
    v_mul_f32 v2, 0x1f800000, v2
    v_mul_f32 v108, v108, v2
    v_mul_f32 v109, v109, v2
    v_mul_f32 v110, v110, v2
    v_mul_f32 v111, v111, v2
    v_mul_f32 v112, v112, v2
    v_mul_f32 v113, v113, v2
    v_mul_f32 v114, v114, v2
    v_mul_f32 v115, v115, v2
    v_mul_f32 v116, v116, v2
    v_mul_f32 v117, v117, v2
    v_mul_f32 v118, v118, v2
    v_mul_f32 v119, v119, v2
    v_mul_f32 v120, v120, v2
    v_mul_f32 v121, v121, v2
    v_mul_f32 v122, v122, v2
    v_mul_f32 v123, v123, v2
    v_bfe_u32 v1, v0, 4, 1
    v_mul_u32_u24 v1, 147456, v1
    v_lshrrev_b32_e64 v3, 5, v0
    v_lshl_add_u32 v1, v3, 8, v1
    v_and_b32_e64 v3, 15, v0
    v_lshl_add_u32 v1, v3, 4, v1
    s_add_u32 s36, s26, 0
    s_mul_i32 s36, s36, 288
    s_add_u32 s36, s36, s25
    s_add_u32 s36, s36, 112
    s_lshl_b32 s36, s36, 10
    s_nop 0
    v_cvt_pk_bf16_f32 v92, v108, v109
    v_cvt_pk_bf16_f32 v93, v110, v111
    v_cvt_pk_bf16_f32 v94, v116, v117
    v_cvt_pk_bf16_f32 v95, v118, v119
    buffer_store_dwordx4 v[92:95], v1, s[48:51], s36 offen offset:0 sc1
    v_cvt_pk_bf16_f32 v96, v112, v113
    v_cvt_pk_bf16_f32 v97, v114, v115
    v_cvt_pk_bf16_f32 v98, v120, v121
    v_cvt_pk_bf16_f32 v99, v122, v123
    buffer_store_dwordx4 v[96:99], v1, s[48:51], s36 offen offset:512 sc1
    v_add_f32 v1, abs(v124), abs(v125)
    v_add_f32 v1, abs(v126), v1
    v_add_f32 v1, abs(v127), v1
    v_add_f32 v1, abs(v128), v1
    v_add_f32 v1, abs(v129), v1
    v_add_f32 v1, abs(v130), v1
    v_add_f32 v1, abs(v131), v1
    v_add_f32 v1, abs(v132), v1
    v_add_f32 v1, abs(v133), v1
    v_add_f32 v1, abs(v134), v1
    v_add_f32 v1, abs(v135), v1
    v_add_f32 v1, abs(v136), v1
    v_add_f32 v1, abs(v137), v1
    v_add_f32 v1, abs(v138), v1
    v_add_f32 v1, abs(v139), v1
    v_add_f32 v1, v144, v1
    v_cmp_gt_f32 vcc, s35, v1
    v_cmp_le_f32 s[4:5], s34, v144
    s_nop 1
    s_and_b64 s[4:5], s[4:5], vcc
    s_cmp_eq_u64 s[4:5], exec
    s_cbranch_scc1 attn_out_kernel_att_ok1
    v_mov_b32 v3, 0xff800000
    v_mov_b32 v124, 0
    v_mov_b32 v125, 0
    v_mov_b32 v126, 0
    v_mov_b32 v127, 0
    v_mov_b32 v128, 0
    v_mov_b32 v129, 0
    v_mov_b32 v130, 0
    v_mov_b32 v131, 0
    v_mov_b32 v132, 0
    v_mov_b32 v133, 0
    v_mov_b32 v134, 0
    v_mov_b32 v135, 0
    v_mov_b32 v136, 0
    v_mov_b32 v137, 0
    v_mov_b32 v138, 0
    v_mov_b32 v139, 0
    v_mov_b32 v144, 0
    v_mov_b32 v145, 0
    v_mov_b32 v146, 0
    v_mov_b32 v147, 0
    s_mov_b32 s36, 0
attn_out_kernel_att_slow1_loop:
    s_nop 0
    s_add_u32 s37, s36, 131072
    buffer_load_dwordx4 v[148:151], v6, s[40:43], s36 offen offset:0
    buffer_load_dwordx4 v[164:167], v6, s[40:43], s37 offen offset:0
    buffer_load_dwordx4 v[152:155], v6, s[40:43], s36 offen offset:1024
    buffer_load_dwordx4 v[168:171], v6, s[40:43], s37 offen offset:1024
    s_waitcnt vmcnt(0)
    v_mfma_f32_32x32x16_bf16 v[76:91], v[148:151], v[18:21], 0
    v_mfma_f32_32x32x16_bf16 v[76:91], v[152:155], v[22:25], v[76:91]
    s_nop 7
    s_nop 7
    s_nop 0
    v_max3_f32 v4, v76, v77, v3
    v_max3_f32 v4, v78, v79, v4
    v_max3_f32 v4, v80, v81, v4
    v_max3_f32 v4, v82, v83, v4
    v_max3_f32 v4, v84, v85, v4
    v_max3_f32 v4, v86, v87, v4
    v_max3_f32 v4, v88, v89, v4
    v_max3_f32 v4, v90, v91, v4
    v_mov_b32 v1, v4
    s_nop 1
    v_permlane32_swap_b32 v4, v1
    s_nop 1
    v_max_f32 v4, v4, v1
    v_sub_f32 v1, v3, v4
    v_exp_f32 v1, v1
    v_mov_b32 v3, v4
    v_sub_f32 v76, v76, v4
    v_sub_f32 v77, v77, v4
    v_sub_f32 v78, v78, v4
    v_sub_f32 v79, v79, v4
    v_sub_f32 v80, v80, v4
    v_sub_f32 v81, v81, v4
    v_sub_f32 v82, v82, v4
    v_sub_f32 v83, v83, v4
    v_sub_f32 v84, v84, v4
    v_sub_f32 v85, v85, v4
    v_sub_f32 v86, v86, v4
    v_sub_f32 v87, v87, v4
    v_sub_f32 v88, v88, v4
    v_sub_f32 v89, v89, v4
    v_sub_f32 v90, v90, v4
    v_sub_f32 v91, v91, v4
    v_exp_f32 v76, v76
    v_exp_f32 v77, v77
    v_exp_f32 v78, v78
    v_exp_f32 v79, v79
    v_exp_f32 v80, v80
    v_exp_f32 v81, v81
    v_exp_f32 v82, v82
    v_exp_f32 v83, v83
    v_exp_f32 v84, v84
    v_exp_f32 v85, v85
    v_exp_f32 v86, v86
    v_exp_f32 v87, v87
    v_exp_f32 v88, v88
    v_exp_f32 v89, v89
    v_exp_f32 v90, v90
    v_exp_f32 v91, v91
    v_mul_f32 v124, v124, v1
    v_mul_f32 v125, v125, v1
    v_mul_f32 v126, v126, v1
    v_mul_f32 v127, v127, v1
    v_mul_f32 v128, v128, v1
    v_mul_f32 v129, v129, v1
    v_mul_f32 v130, v130, v1
    v_mul_f32 v131, v131, v1
    v_mul_f32 v132, v132, v1
    v_mul_f32 v133, v133, v1
    v_mul_f32 v134, v134, v1
    v_mul_f32 v135, v135, v1
    v_mul_f32 v136, v136, v1
    v_mul_f32 v137, v137, v1
    v_mul_f32 v138, v138, v1
    v_mul_f32 v139, v139, v1
    v_mul_f32_e64 v144, v144, v1
    v_cvt_pk_bf16_f32 v100, v76, v77
    v_cvt_pk_bf16_f32 v101, v78, v79
    v_cvt_pk_bf16_f32 v102, v80, v81
    v_cvt_pk_bf16_f32 v103, v82, v83
    v_cvt_pk_bf16_f32 v104, v84, v85
    v_cvt_pk_bf16_f32 v105, v86, v87
    v_cvt_pk_bf16_f32 v106, v88, v89
    v_cvt_pk_bf16_f32 v107, v90, v91
    s_nop 1
    s_nop 0
    v_mfma_f32_32x32x16_bf16 v[124:139], v[164:167], v[100:103], v[124:139]
    v_mfma_f32_16x16x32_bf16 v[144:147], v[180:183], v[100:103], v[144:147]
    v_mfma_f32_32x32x16_bf16 v[124:139], v[168:171], v[104:107], v[124:139]
    v_mfma_f32_16x16x32_bf16 v[144:147], v[180:183], v[104:107], v[144:147]
    s_nop 7
    s_nop 7
    s_nop 7
    s_add_u32 s36, s36, 2048
    s_cmp_lt_u32 s36, 131072
    s_cbranch_scc1 attn_out_kernel_att_slow1_loop
attn_out_kernel_att_ok1:
    v_rcp_f32 v2, v144
    s_nop 0
    v_mul_f32 v2, 0x1f800000, v2
    v_mul_f32 v124, v124, v2
    v_mul_f32 v125, v125, v2
    v_mul_f32 v126, v126, v2
    v_mul_f32 v127, v127, v2
    v_mul_f32 v128, v128, v2
    v_mul_f32 v129, v129, v2
    v_mul_f32 v130, v130, v2
    v_mul_f32 v131, v131, v2
    v_mul_f32 v132, v132, v2
    v_mul_f32 v133, v133, v2
    v_mul_f32 v134, v134, v2
    v_mul_f32 v135, v135, v2
    v_mul_f32 v136, v136, v2
    v_mul_f32 v137, v137, v2
    v_mul_f32 v138, v138, v2
    v_mul_f32 v139, v139, v2
    v_bfe_u32 v1, v0, 4, 1
    v_mul_u32_u24 v1, 147456, v1
    v_lshrrev_b32_e64 v3, 5, v0
    v_lshl_add_u32 v1, v3, 8, v1
    v_and_b32_e64 v3, 15, v0
    v_lshl_add_u32 v1, v3, 4, v1
    s_add_u32 s36, s26, 1
    s_mul_i32 s36, s36, 288
    s_add_u32 s36, s36, s25
    s_add_u32 s36, s36, 112
    s_lshl_b32 s36, s36, 10
    s_nop 0
    v_cvt_pk_bf16_f32 v100, v124, v125
    v_cvt_pk_bf16_f32 v101, v126, v127
    v_cvt_pk_bf16_f32 v102, v132, v133
    v_cvt_pk_bf16_f32 v103, v134, v135
    buffer_store_dwordx4 v[100:103], v1, s[48:51], s36 offen offset:0 sc1
    v_cvt_pk_bf16_f32 v104, v128, v129
    v_cvt_pk_bf16_f32 v105, v130, v131
    v_cvt_pk_bf16_f32 v106, v136, v137
    v_cvt_pk_bf16_f32 v107, v138, v139
    buffer_store_dwordx4 v[104:107], v1, s[48:51], s36 offen offset:512 sc1
    s_waitcnt vmcnt(0)
    s_barrier
    s_lshr_b32 s34, s2, 4
    s_lshl_b32 s34, s34, 8
    s_and_b32 s35, s2, 15
    s_lshl_b32 s35, s35, 2
    s_add_u32 s34, s34, s35
    s_add_u32 s34, s34, 29642752
    v_mov_b32 v1, s34
    v_mov_b32_e64 v2, 1
    s_cmp_eq_u32 s24, 0
    s_cbranch_scc0 attn_out_kernel_att_nosig
    v_cmp_eq_u32 vcc, 0, v0
    s_and_saveexec_b64 s[4:5], vcc
    global_store_dword v1, v2, s[18:19] sc1
    s_mov_b64 exec, s[4:5]
attn_out_kernel_att_nosig:
    s_endpgm
attn_out_kernel_gemm:
    s_sub_u32 s20, s2, 256
    v_lshrrev_b32 v1, 6, v0
    v_and_b32_e64 v0, 63, v0
    v_readfirstlane_b32 s24, v1
    s_and_b32 s33, s20, 7
    s_lshr_b32 s34, s20, 3
    s_lshr_b32 s35, s33, 1
    s_lshl_b32 s35, s35, 2
    s_lshr_b32 s36, s34, 3
    s_add_u32 s25, s35, s36
    s_and_b32 s35, s33, 1
    s_lshl_b32 s35, s35, 3
    s_and_b32 s36, s34, 7
    s_add_u32 s26, s35, s36
    s_add_u32 s40, s18, 4194304
    s_addc_u32 s41, s19, 0
    s_mov_b32 s42, 18874368
    s_mov_b32 s43, 0x20000
    s_mov_b32 s44, s8
    s_mov_b32 s45, s9
    s_mov_b32 s46, 7340032
    s_mov_b32 s47, 0x20000
    v_lshlrev_b32_e64 v1, 4, v0
    s_lshl_b32 s33, s25, 3
    s_xor_b32 s34, s24, 0
    s_add_u32 s34, s34, s33
    s_mul_i32 s34, s34, 147456
    v_add_u32_e64 v5, s34, v1
    s_xor_b32 s34, s24, 1
    s_add_u32 s34, s34, s33
    s_mul_i32 s34, s34, 147456
    v_add_u32_e64 v6, s34, v1
    s_xor_b32 s34, s24, 2
    s_add_u32 s34, s34, s33
    s_mul_i32 s34, s34, 147456
    v_add_u32_e64 v7, s34, v1
    s_xor_b32 s34, s24, 3
    s_add_u32 s34, s34, s33
    s_mul_i32 s34, s34, 147456
    v_add_u32 v8, s34, v1
    s_xor_b32 s34, s24, 0
    s_add_u32 s34, s34, s33
    s_add_u32 s34, s34, 4
    s_mul_i32 s34, s34, 147456
    v_add_u32 v9, s34, v1
    s_xor_b32 s34, s24, 1
    s_add_u32 s34, s34, s33
    s_add_u32 s34, s34, 4
    s_mul_i32 s34, s34, 147456
    v_add_u32 v10, s34, v1
    s_xor_b32 s34, s24, 2
    s_add_u32 s34, s34, s33
    s_add_u32 s34, s34, 4
    s_mul_i32 s34, s34, 147456
    v_add_u32 v11, s34, v1
    s_xor_b32 s34, s24, 3
    s_add_u32 s34, s34, s33
    s_add_u32 s34, s34, 4
    s_mul_i32 s34, s34, 147456
    v_add_u32 v12, s34, v1
    v_lshrrev_b32 v1, 3, v0
    v_bfe_u32 v2, v0, 1, 2
    v_bfe_u32 v3, v0, 4, 2
    v_xor_b32 v2, v2, v3
    v_and_b32 v3, 1, v0
    v_lshlrev_b32_e64 v2, 5, v2
    v_lshl_add_u32 v2, v3, 4, v2
    v_lshl_add_u32 v2, v1, 11, v2
    s_lshl_b32 s33, s26, 7
    v_add_u32 v13, s33, v2
    v_add_u32 v14, 15360, v13
    v_add_u32 v15, 30720, v13
    v_add_u32 v16, 46080, v13
    s_lshl_b32 s32, s24, 14
    v_lshrrev_b32 v1, 2, v0
    v_bfe_u32 v2, v1, 1, 2
    v_lshlrev_b32 v1, 7, v1
    v_and_b32 v3, 3, v0
    v_lshl_add_u32 v1, v3, 3, v1
    v_add_u32 v1, s32, v1
    v_xor_b32 v3, 0, v2
    v_lshl_add_u32 v17, v3, 5, v1
    v_xor_b32_e64 v3, 1, v2
    v_lshl_add_u32 v18, v3, 5, v1
    v_xor_b32_e64 v3, 2, v2
    v_lshl_add_u32 v19, v3, 5, v1
    v_xor_b32_e64 v3, 3, v2
    v_lshl_add_u32 v20, v3, 5, v1
    s_lshl_b32 s31, s24, 16
    s_lshl_b32 s28, s24, 10
    s_mov_b32 s48, s6
    s_mov_b32 s49, s7
    s_mov_b32 s50, 2097152
    s_mov_b32 s51, 0x20000
    s_add_u32 m0, s32, 0
    s_nop 0
    buffer_load_dwordx4 v13, s[44:47], s31 offen offset:0 lds
    buffer_load_dwordx4 v14, s[44:47], s31 offen offset:1024 lds
    buffer_load_dwordx4 v15, s[44:47], s31 offen offset:2048 lds
    buffer_load_dwordx4 v16, s[44:47], s31 offen offset:3072 lds
    s_add_u32 s31, s31, 262144
    s_add_u32 m0, s32, 4096
    s_nop 0
    s_nop 0
    buffer_load_dwordx4 v13, s[44:47], s31 offen offset:0 lds
    buffer_load_dwordx4 v14, s[44:47], s31 offen offset:1024 lds
    buffer_load_dwordx4 v15, s[44:47], s31 offen offset:2048 lds
    buffer_load_dwordx4 v16, s[44:47], s31 offen offset:3072 lds
    s_add_u32 s31, s31, 262144
    s_add_u32 m0, s32, 8192
    s_nop 0
    s_nop 0
    buffer_load_dwordx4 v13, s[44:47], s31 offen offset:0 lds
    buffer_load_dwordx4 v14, s[44:47], s31 offen offset:1024 lds
    buffer_load_dwordx4 v15, s[44:47], s31 offen offset:2048 lds
    buffer_load_dwordx4 v16, s[44:47], s31 offen offset:3072 lds
    s_add_u32 s31, s31, 262144
    buffer_load_dwordx4 v[24:27], v5, s[40:43], s28 offen
    buffer_load_dwordx4 v[28:31], v6, s[40:43], s28 offen
    buffer_load_dwordx4 v[32:35], v7, s[40:43], s28 offen
    buffer_load_dwordx4 v[36:39], v8, s[40:43], s28 offen
    buffer_load_dwordx4 v[40:43], v9, s[40:43], s28 offen
    buffer_load_dwordx4 v[44:47], v10, s[40:43], s28 offen
    buffer_load_dwordx4 v[48:51], v11, s[40:43], s28 offen
    buffer_load_dwordx4 v[52:55], v12, s[40:43], s28 offen
    s_add_u32 m0, s32, 12288
    s_nop 0
    s_nop 0
    buffer_load_dwordx4 v13, s[44:47], s31 offen offset:0 lds
    buffer_load_dwordx4 v14, s[44:47], s31 offen offset:1024 lds
    buffer_load_dwordx4 v15, s[44:47], s31 offen offset:2048 lds
    buffer_load_dwordx4 v16, s[44:47], s31 offen offset:3072 lds
    s_add_u32 s31, s31, 262144
    s_add_u32 s28, s28, 4096
    buffer_load_dwordx4 v[56:59], v5, s[40:43], s28 offen
    buffer_load_dwordx4 v[60:63], v6, s[40:43], s28 offen
    buffer_load_dwordx4 v[64:67], v7, s[40:43], s28 offen
    buffer_load_dwordx4 v[68:71], v8, s[40:43], s28 offen
    buffer_load_dwordx4 v[72:75], v9, s[40:43], s28 offen
    buffer_load_dwordx4 v[76:79], v10, s[40:43], s28 offen
    buffer_load_dwordx4 v[80:83], v11, s[40:43], s28 offen
    buffer_load_dwordx4 v[84:87], v12, s[40:43], s28 offen
    s_add_u32 s28, s28, 4096
    s_lshl_b32 s33, s24, 12
    s_lshl_b32 s34, s24, 16
    s_add_u32 m0, s33, 65536
    s_nop 0
    s_nop 0
    buffer_load_dwordx4 v13, s[48:51], s34 offen offset:0 lds
    buffer_load_dwordx4 v14, s[48:51], s34 offen offset:1024 lds
    buffer_load_dwordx4 v15, s[48:51], s34 offen offset:2048 lds
    buffer_load_dwordx4 v16, s[48:51], s34 offen offset:3072 lds
    s_lshl_b32 s29, s24, 10
    s_add_u32 s29, s29, 114688
    s_waitcnt vmcnt(32)
    ds_read_b64_tr_b16 v[88:89], v17 offset:0
    ds_read_b64_tr_b16 v[90:91], v17 offset:2048
    ds_read_b64_tr_b16 v[92:93], v18 offset:0
    ds_read_b64_tr_b16 v[94:95], v18 offset:2048
    ds_read_b64_tr_b16 v[96:97], v19 offset:0
    ds_read_b64_tr_b16 v[98:99], v19 offset:2048
    ds_read_b64_tr_b16 v[100:101], v20 offset:0
    ds_read_b64_tr_b16 v[102:103], v20 offset:2048
    s_waitcnt lgkmcnt(0)
    s_mov_b32 s27, 7
    s_cmp_lt_u32 s28, s29
    s_cselect_b32 s30, s28, 0x40000000
    s_add_u32 s28, s28, 4096
    s_waitcnt vmcnt(18)
    v_mfma_f32_16x16x32_bf16 v[120:123], v[88:91], v[24:27], 0
    s_add_u32 m0, s32, 0
    s_nop 0
    v_mfma_f32_16x16x32_bf16 v[124:127], v[92:95], v[24:27], 0
    buffer_load_dwordx4 v13, s[44:47], s31 offen offset:0 lds
    buffer_load_dwordx4 v14, s[44:47], s31 offen offset:1024 lds
    v_mfma_f32_16x16x32_bf16 v[128:131], v[96:99], v[24:27], 0
    buffer_load_dwordx4 v15, s[44:47], s31 offen offset:2048 lds
    buffer_load_dwordx4 v16, s[44:47], s31 offen offset:3072 lds
    v_mfma_f32_16x16x32_bf16 v[132:135], v[100:103], v[24:27], 0
    s_add_u32 s31, s31, 262144
    buffer_load_dwordx4 v[24:27], v5, s[40:43], s30 offen
    v_mfma_f32_16x16x32_bf16 v[136:139], v[88:91], v[28:31], 0
    ds_read_b64_tr_b16 v[104:105], v17 offset:4096
    v_mfma_f32_16x16x32_bf16 v[140:143], v[92:95], v[28:31], 0
    ds_read_b64_tr_b16 v[106:107], v17 offset:6144
    v_mfma_f32_16x16x32_bf16 v[144:147], v[96:99], v[28:31], 0
    v_mfma_f32_16x16x32_bf16 v[148:151], v[100:103], v[28:31], 0
    buffer_load_dwordx4 v[28:31], v6, s[40:43], s30 offen
    s_waitcnt vmcnt(22)
    v_mfma_f32_16x16x32_bf16 v[152:155], v[88:91], v[32:35], 0
    ds_read_b64_tr_b16 v[108:109], v18 offset:4096
    v_mfma_f32_16x16x32_bf16 v[156:159], v[92:95], v[32:35], 0
    ds_read_b64_tr_b16 v[110:111], v18 offset:6144
    v_mfma_f32_16x16x32_bf16 v[160:163], v[96:99], v[32:35], 0
    v_mfma_f32_16x16x32_bf16 v[164:167], v[100:103], v[32:35], 0
    buffer_load_dwordx4 v[32:35], v7, s[40:43], s30 offen
    v_mfma_f32_16x16x32_bf16 v[168:171], v[88:91], v[36:39], 0
    ds_read_b64_tr_b16 v[112:113], v19 offset:4096
    v_mfma_f32_16x16x32_bf16 v[172:175], v[92:95], v[36:39], 0
    ds_read_b64_tr_b16 v[114:115], v19 offset:6144
    v_mfma_f32_16x16x32_bf16 v[176:179], v[96:99], v[36:39], 0
    v_mfma_f32_16x16x32_bf16 v[180:183], v[100:103], v[36:39], 0
    buffer_load_dwordx4 v[36:39], v8, s[40:43], s30 offen
    s_waitcnt vmcnt(22)
    v_mfma_f32_16x16x32_bf16 v[184:187], v[88:91], v[40:43], 0
    ds_read_b64_tr_b16 v[116:117], v20 offset:4096
    v_mfma_f32_16x16x32_bf16 v[188:191], v[92:95], v[40:43], 0
    ds_read_b64_tr_b16 v[118:119], v20 offset:6144
    v_mfma_f32_16x16x32_bf16 v[192:195], v[96:99], v[40:43], 0
    v_mfma_f32_16x16x32_bf16 v[196:199], v[100:103], v[40:43], 0
    buffer_load_dwordx4 v[40:43], v9, s[40:43], s30 offen
    v_mfma_f32_16x16x32_bf16 v[200:203], v[88:91], v[44:47], 0
    v_mfma_f32_16x16x32_bf16 v[204:207], v[92:95], v[44:47], 0
    v_mfma_f32_16x16x32_bf16 v[208:211], v[96:99], v[44:47], 0
    v_mfma_f32_16x16x32_bf16 v[212:215], v[100:103], v[44:47], 0
    buffer_load_dwordx4 v[44:47], v10, s[40:43], s30 offen
    s_waitcnt vmcnt(22)
    v_mfma_f32_16x16x32_bf16 v[216:219], v[88:91], v[48:51], 0
    v_mfma_f32_16x16x32_bf16 v[220:223], v[92:95], v[48:51], 0
    v_mfma_f32_16x16x32_bf16 v[224:227], v[96:99], v[48:51], 0
    v_mfma_f32_16x16x32_bf16 v[228:231], v[100:103], v[48:51], 0
    buffer_load_dwordx4 v[48:51], v11, s[40:43], s30 offen
    v_mfma_f32_16x16x32_bf16 v[232:235], v[88:91], v[52:55], 0
    v_mfma_f32_16x16x32_bf16 v[236:239], v[92:95], v[52:55], 0
    v_mfma_f32_16x16x32_bf16 v[240:243], v[96:99], v[52:55], 0
    v_mfma_f32_16x16x32_bf16 v[244:247], v[100:103], v[52:55], 0
    buffer_load_dwordx4 v[52:55], v12, s[40:43], s30 offen
    s_waitcnt lgkmcnt(0)
    s_branch attn_out_kernel_g_loop1
attn_out_kernel_g_loop:
    s_cmp_lt_u32 s28, s29
    s_cselect_b32 s30, s28, 0x40000000
    s_add_u32 s28, s28, 4096
    s_waitcnt vmcnt(18)
    v_mfma_f32_16x16x32_bf16 v[120:123], v[88:91], v[24:27], v[120:123]
    s_add_u32 m0, s32, 0
    s_nop 0
    v_mfma_f32_16x16x32_bf16 v[124:127], v[92:95], v[24:27], v[124:127]
    buffer_load_dwordx4 v13, s[44:47], s31 offen offset:0 lds
    buffer_load_dwordx4 v14, s[44:47], s31 offen offset:1024 lds
    v_mfma_f32_16x16x32_bf16 v[128:131], v[96:99], v[24:27], v[128:131]
    buffer_load_dwordx4 v15, s[44:47], s31 offen offset:2048 lds
    buffer_load_dwordx4 v16, s[44:47], s31 offen offset:3072 lds
    v_mfma_f32_16x16x32_bf16 v[132:135], v[100:103], v[24:27], v[132:135]
    s_add_u32 s31, s31, 262144
    buffer_load_dwordx4 v[24:27], v5, s[40:43], s30 offen
    v_mfma_f32_16x16x32_bf16 v[136:139], v[88:91], v[28:31], v[136:139]
    ds_read_b64_tr_b16 v[104:105], v17 offset:4096
    v_mfma_f32_16x16x32_bf16 v[140:143], v[92:95], v[28:31], v[140:143]
    ds_read_b64_tr_b16 v[106:107], v17 offset:6144
    v_mfma_f32_16x16x32_bf16 v[144:147], v[96:99], v[28:31], v[144:147]
    v_mfma_f32_16x16x32_bf16 v[148:151], v[100:103], v[28:31], v[148:151]
    buffer_load_dwordx4 v[28:31], v6, s[40:43], s30 offen
    s_waitcnt vmcnt(22)
    v_mfma_f32_16x16x32_bf16 v[152:155], v[88:91], v[32:35], v[152:155]
    ds_read_b64_tr_b16 v[108:109], v18 offset:4096
    v_mfma_f32_16x16x32_bf16 v[156:159], v[92:95], v[32:35], v[156:159]
    ds_read_b64_tr_b16 v[110:111], v18 offset:6144
    v_mfma_f32_16x16x32_bf16 v[160:163], v[96:99], v[32:35], v[160:163]
    v_mfma_f32_16x16x32_bf16 v[164:167], v[100:103], v[32:35], v[164:167]
    buffer_load_dwordx4 v[32:35], v7, s[40:43], s30 offen
    v_mfma_f32_16x16x32_bf16 v[168:171], v[88:91], v[36:39], v[168:171]
    ds_read_b64_tr_b16 v[112:113], v19 offset:4096
    v_mfma_f32_16x16x32_bf16 v[172:175], v[92:95], v[36:39], v[172:175]
    ds_read_b64_tr_b16 v[114:115], v19 offset:6144
    v_mfma_f32_16x16x32_bf16 v[176:179], v[96:99], v[36:39], v[176:179]
    v_mfma_f32_16x16x32_bf16 v[180:183], v[100:103], v[36:39], v[180:183]
    buffer_load_dwordx4 v[36:39], v8, s[40:43], s30 offen
    s_waitcnt vmcnt(22)
    v_mfma_f32_16x16x32_bf16 v[184:187], v[88:91], v[40:43], v[184:187]
    ds_read_b64_tr_b16 v[116:117], v20 offset:4096
    v_mfma_f32_16x16x32_bf16 v[188:191], v[92:95], v[40:43], v[188:191]
    ds_read_b64_tr_b16 v[118:119], v20 offset:6144
    v_mfma_f32_16x16x32_bf16 v[192:195], v[96:99], v[40:43], v[192:195]
    v_mfma_f32_16x16x32_bf16 v[196:199], v[100:103], v[40:43], v[196:199]
    buffer_load_dwordx4 v[40:43], v9, s[40:43], s30 offen
    v_mfma_f32_16x16x32_bf16 v[200:203], v[88:91], v[44:47], v[200:203]
    v_mfma_f32_16x16x32_bf16 v[204:207], v[92:95], v[44:47], v[204:207]
    v_mfma_f32_16x16x32_bf16 v[208:211], v[96:99], v[44:47], v[208:211]
    v_mfma_f32_16x16x32_bf16 v[212:215], v[100:103], v[44:47], v[212:215]
    buffer_load_dwordx4 v[44:47], v10, s[40:43], s30 offen
    s_waitcnt vmcnt(22)
    v_mfma_f32_16x16x32_bf16 v[216:219], v[88:91], v[48:51], v[216:219]
    v_mfma_f32_16x16x32_bf16 v[220:223], v[92:95], v[48:51], v[220:223]
    v_mfma_f32_16x16x32_bf16 v[224:227], v[96:99], v[48:51], v[224:227]
    v_mfma_f32_16x16x32_bf16 v[228:231], v[100:103], v[48:51], v[228:231]
    buffer_load_dwordx4 v[48:51], v11, s[40:43], s30 offen
    v_mfma_f32_16x16x32_bf16 v[232:235], v[88:91], v[52:55], v[232:235]
    v_mfma_f32_16x16x32_bf16 v[236:239], v[92:95], v[52:55], v[236:239]
    v_mfma_f32_16x16x32_bf16 v[240:243], v[96:99], v[52:55], v[240:243]
    v_mfma_f32_16x16x32_bf16 v[244:247], v[100:103], v[52:55], v[244:247]
    buffer_load_dwordx4 v[52:55], v12, s[40:43], s30 offen
    s_waitcnt lgkmcnt(0)
attn_out_kernel_g_loop1:
    s_cmp_lt_u32 s28, s29
    s_cselect_b32 s30, s28, 0x40000000
    s_add_u32 s28, s28, 4096
    s_waitcnt vmcnt(18)
    v_mfma_f32_16x16x32_bf16 v[120:123], v[104:107], v[56:59], v[120:123]
    s_add_u32 m0, s32, 4096
    s_nop 0
    v_mfma_f32_16x16x32_bf16 v[124:127], v[108:111], v[56:59], v[124:127]
    buffer_load_dwordx4 v13, s[44:47], s31 offen offset:0 lds
    buffer_load_dwordx4 v14, s[44:47], s31 offen offset:1024 lds
    v_mfma_f32_16x16x32_bf16 v[128:131], v[112:115], v[56:59], v[128:131]
    buffer_load_dwordx4 v15, s[44:47], s31 offen offset:2048 lds
    buffer_load_dwordx4 v16, s[44:47], s31 offen offset:3072 lds
    v_mfma_f32_16x16x32_bf16 v[132:135], v[116:119], v[56:59], v[132:135]
    s_add_u32 s31, s31, 262144
    buffer_load_dwordx4 v[56:59], v5, s[40:43], s30 offen
    v_mfma_f32_16x16x32_bf16 v[136:139], v[104:107], v[60:63], v[136:139]
    ds_read_b64_tr_b16 v[88:89], v17 offset:8192
    v_mfma_f32_16x16x32_bf16 v[140:143], v[108:111], v[60:63], v[140:143]
    ds_read_b64_tr_b16 v[90:91], v17 offset:10240
    v_mfma_f32_16x16x32_bf16 v[144:147], v[112:115], v[60:63], v[144:147]
    v_mfma_f32_16x16x32_bf16 v[148:151], v[116:119], v[60:63], v[148:151]
    buffer_load_dwordx4 v[60:63], v6, s[40:43], s30 offen
    s_waitcnt vmcnt(22)
    v_mfma_f32_16x16x32_bf16 v[152:155], v[104:107], v[64:67], v[152:155]
    ds_read_b64_tr_b16 v[92:93], v18 offset:8192
    v_mfma_f32_16x16x32_bf16 v[156:159], v[108:111], v[64:67], v[156:159]
    ds_read_b64_tr_b16 v[94:95], v18 offset:10240
    v_mfma_f32_16x16x32_bf16 v[160:163], v[112:115], v[64:67], v[160:163]
    v_mfma_f32_16x16x32_bf16 v[164:167], v[116:119], v[64:67], v[164:167]
    buffer_load_dwordx4 v[64:67], v7, s[40:43], s30 offen
    v_mfma_f32_16x16x32_bf16 v[168:171], v[104:107], v[68:71], v[168:171]
    ds_read_b64_tr_b16 v[96:97], v19 offset:8192
    v_mfma_f32_16x16x32_bf16 v[172:175], v[108:111], v[68:71], v[172:175]
    ds_read_b64_tr_b16 v[98:99], v19 offset:10240
    v_mfma_f32_16x16x32_bf16 v[176:179], v[112:115], v[68:71], v[176:179]
    v_mfma_f32_16x16x32_bf16 v[180:183], v[116:119], v[68:71], v[180:183]
    buffer_load_dwordx4 v[68:71], v8, s[40:43], s30 offen
    s_waitcnt vmcnt(22)
    v_mfma_f32_16x16x32_bf16 v[184:187], v[104:107], v[72:75], v[184:187]
    ds_read_b64_tr_b16 v[100:101], v20 offset:8192
    v_mfma_f32_16x16x32_bf16 v[188:191], v[108:111], v[72:75], v[188:191]
    ds_read_b64_tr_b16 v[102:103], v20 offset:10240
    v_mfma_f32_16x16x32_bf16 v[192:195], v[112:115], v[72:75], v[192:195]
    v_mfma_f32_16x16x32_bf16 v[196:199], v[116:119], v[72:75], v[196:199]
    buffer_load_dwordx4 v[72:75], v9, s[40:43], s30 offen
    v_mfma_f32_16x16x32_bf16 v[200:203], v[104:107], v[76:79], v[200:203]
    v_mfma_f32_16x16x32_bf16 v[204:207], v[108:111], v[76:79], v[204:207]
    v_mfma_f32_16x16x32_bf16 v[208:211], v[112:115], v[76:79], v[208:211]
    v_mfma_f32_16x16x32_bf16 v[212:215], v[116:119], v[76:79], v[212:215]
    buffer_load_dwordx4 v[76:79], v10, s[40:43], s30 offen
    s_waitcnt vmcnt(22)
    v_mfma_f32_16x16x32_bf16 v[216:219], v[104:107], v[80:83], v[216:219]
    v_mfma_f32_16x16x32_bf16 v[220:223], v[108:111], v[80:83], v[220:223]
    v_mfma_f32_16x16x32_bf16 v[224:227], v[112:115], v[80:83], v[224:227]
    v_mfma_f32_16x16x32_bf16 v[228:231], v[116:119], v[80:83], v[228:231]
    buffer_load_dwordx4 v[80:83], v11, s[40:43], s30 offen
    v_mfma_f32_16x16x32_bf16 v[232:235], v[104:107], v[84:87], v[232:235]
    v_mfma_f32_16x16x32_bf16 v[236:239], v[108:111], v[84:87], v[236:239]
    v_mfma_f32_16x16x32_bf16 v[240:243], v[112:115], v[84:87], v[240:243]
    v_mfma_f32_16x16x32_bf16 v[244:247], v[116:119], v[84:87], v[244:247]
    buffer_load_dwordx4 v[84:87], v12, s[40:43], s30 offen
    s_waitcnt lgkmcnt(0)
    s_cmp_lt_u32 s28, s29
    s_cselect_b32 s30, s28, 0x40000000
    s_add_u32 s28, s28, 4096
    s_waitcnt vmcnt(18)
    v_mfma_f32_16x16x32_bf16 v[120:123], v[88:91], v[24:27], v[120:123]
    s_add_u32 m0, s32, 8192
    s_nop 0
    v_mfma_f32_16x16x32_bf16 v[124:127], v[92:95], v[24:27], v[124:127]
    buffer_load_dwordx4 v13, s[44:47], s31 offen offset:0 lds
    buffer_load_dwordx4 v14, s[44:47], s31 offen offset:1024 lds
    v_mfma_f32_16x16x32_bf16 v[128:131], v[96:99], v[24:27], v[128:131]
    buffer_load_dwordx4 v15, s[44:47], s31 offen offset:2048 lds
    buffer_load_dwordx4 v16, s[44:47], s31 offen offset:3072 lds
    v_mfma_f32_16x16x32_bf16 v[132:135], v[100:103], v[24:27], v[132:135]
    s_add_u32 s31, s31, 262144
    buffer_load_dwordx4 v[24:27], v5, s[40:43], s30 offen
    v_mfma_f32_16x16x32_bf16 v[136:139], v[88:91], v[28:31], v[136:139]
    ds_read_b64_tr_b16 v[104:105], v17 offset:12288
    v_mfma_f32_16x16x32_bf16 v[140:143], v[92:95], v[28:31], v[140:143]
    ds_read_b64_tr_b16 v[106:107], v17 offset:14336
    v_mfma_f32_16x16x32_bf16 v[144:147], v[96:99], v[28:31], v[144:147]
    v_mfma_f32_16x16x32_bf16 v[148:151], v[100:103], v[28:31], v[148:151]
    buffer_load_dwordx4 v[28:31], v6, s[40:43], s30 offen
    s_waitcnt vmcnt(22)
    v_mfma_f32_16x16x32_bf16 v[152:155], v[88:91], v[32:35], v[152:155]
    ds_read_b64_tr_b16 v[108:109], v18 offset:12288
    v_mfma_f32_16x16x32_bf16 v[156:159], v[92:95], v[32:35], v[156:159]
    ds_read_b64_tr_b16 v[110:111], v18 offset:14336
    v_mfma_f32_16x16x32_bf16 v[160:163], v[96:99], v[32:35], v[160:163]
    v_mfma_f32_16x16x32_bf16 v[164:167], v[100:103], v[32:35], v[164:167]
    buffer_load_dwordx4 v[32:35], v7, s[40:43], s30 offen
    v_mfma_f32_16x16x32_bf16 v[168:171], v[88:91], v[36:39], v[168:171]
    ds_read_b64_tr_b16 v[112:113], v19 offset:12288
    v_mfma_f32_16x16x32_bf16 v[172:175], v[92:95], v[36:39], v[172:175]
    ds_read_b64_tr_b16 v[114:115], v19 offset:14336
    v_mfma_f32_16x16x32_bf16 v[176:179], v[96:99], v[36:39], v[176:179]
    v_mfma_f32_16x16x32_bf16 v[180:183], v[100:103], v[36:39], v[180:183]
    buffer_load_dwordx4 v[36:39], v8, s[40:43], s30 offen
    s_waitcnt vmcnt(22)
    v_mfma_f32_16x16x32_bf16 v[184:187], v[88:91], v[40:43], v[184:187]
    ds_read_b64_tr_b16 v[116:117], v20 offset:12288
    v_mfma_f32_16x16x32_bf16 v[188:191], v[92:95], v[40:43], v[188:191]
    ds_read_b64_tr_b16 v[118:119], v20 offset:14336
    v_mfma_f32_16x16x32_bf16 v[192:195], v[96:99], v[40:43], v[192:195]
    v_mfma_f32_16x16x32_bf16 v[196:199], v[100:103], v[40:43], v[196:199]
    buffer_load_dwordx4 v[40:43], v9, s[40:43], s30 offen
    v_mfma_f32_16x16x32_bf16 v[200:203], v[88:91], v[44:47], v[200:203]
    v_mfma_f32_16x16x32_bf16 v[204:207], v[92:95], v[44:47], v[204:207]
    v_mfma_f32_16x16x32_bf16 v[208:211], v[96:99], v[44:47], v[208:211]
    v_mfma_f32_16x16x32_bf16 v[212:215], v[100:103], v[44:47], v[212:215]
    buffer_load_dwordx4 v[44:47], v10, s[40:43], s30 offen
    s_waitcnt vmcnt(22)
    v_mfma_f32_16x16x32_bf16 v[216:219], v[88:91], v[48:51], v[216:219]
    v_mfma_f32_16x16x32_bf16 v[220:223], v[92:95], v[48:51], v[220:223]
    v_mfma_f32_16x16x32_bf16 v[224:227], v[96:99], v[48:51], v[224:227]
    v_mfma_f32_16x16x32_bf16 v[228:231], v[100:103], v[48:51], v[228:231]
    buffer_load_dwordx4 v[48:51], v11, s[40:43], s30 offen
    v_mfma_f32_16x16x32_bf16 v[232:235], v[88:91], v[52:55], v[232:235]
    v_mfma_f32_16x16x32_bf16 v[236:239], v[92:95], v[52:55], v[236:239]
    v_mfma_f32_16x16x32_bf16 v[240:243], v[96:99], v[52:55], v[240:243]
    v_mfma_f32_16x16x32_bf16 v[244:247], v[100:103], v[52:55], v[244:247]
    buffer_load_dwordx4 v[52:55], v12, s[40:43], s30 offen
    s_waitcnt lgkmcnt(0)
    s_cmp_lt_u32 s28, s29
    s_cselect_b32 s30, s28, 0x40000000
    s_add_u32 s28, s28, 4096
    s_waitcnt vmcnt(18)
    v_mfma_f32_16x16x32_bf16 v[120:123], v[104:107], v[56:59], v[120:123]
    s_add_u32 m0, s32, 12288
    s_nop 0
    v_mfma_f32_16x16x32_bf16 v[124:127], v[108:111], v[56:59], v[124:127]
    buffer_load_dwordx4 v13, s[44:47], s31 offen offset:0 lds
    buffer_load_dwordx4 v14, s[44:47], s31 offen offset:1024 lds
    v_mfma_f32_16x16x32_bf16 v[128:131], v[112:115], v[56:59], v[128:131]
    buffer_load_dwordx4 v15, s[44:47], s31 offen offset:2048 lds
    buffer_load_dwordx4 v16, s[44:47], s31 offen offset:3072 lds
    v_mfma_f32_16x16x32_bf16 v[132:135], v[116:119], v[56:59], v[132:135]
    s_add_u32 s31, s31, 262144
    buffer_load_dwordx4 v[56:59], v5, s[40:43], s30 offen
    v_mfma_f32_16x16x32_bf16 v[136:139], v[104:107], v[60:63], v[136:139]
    ds_read_b64_tr_b16 v[88:89], v17 offset:0
    v_mfma_f32_16x16x32_bf16 v[140:143], v[108:111], v[60:63], v[140:143]
    ds_read_b64_tr_b16 v[90:91], v17 offset:2048
    v_mfma_f32_16x16x32_bf16 v[144:147], v[112:115], v[60:63], v[144:147]
    v_mfma_f32_16x16x32_bf16 v[148:151], v[116:119], v[60:63], v[148:151]
    buffer_load_dwordx4 v[60:63], v6, s[40:43], s30 offen
    s_waitcnt vmcnt(22)
    v_mfma_f32_16x16x32_bf16 v[152:155], v[104:107], v[64:67], v[152:155]
    ds_read_b64_tr_b16 v[92:93], v18 offset:0
    v_mfma_f32_16x16x32_bf16 v[156:159], v[108:111], v[64:67], v[156:159]
    ds_read_b64_tr_b16 v[94:95], v18 offset:2048
    v_mfma_f32_16x16x32_bf16 v[160:163], v[112:115], v[64:67], v[160:163]
    v_mfma_f32_16x16x32_bf16 v[164:167], v[116:119], v[64:67], v[164:167]
    buffer_load_dwordx4 v[64:67], v7, s[40:43], s30 offen
    v_mfma_f32_16x16x32_bf16 v[168:171], v[104:107], v[68:71], v[168:171]
    ds_read_b64_tr_b16 v[96:97], v19 offset:0
    v_mfma_f32_16x16x32_bf16 v[172:175], v[108:111], v[68:71], v[172:175]
    ds_read_b64_tr_b16 v[98:99], v19 offset:2048
    v_mfma_f32_16x16x32_bf16 v[176:179], v[112:115], v[68:71], v[176:179]
    v_mfma_f32_16x16x32_bf16 v[180:183], v[116:119], v[68:71], v[180:183]
    buffer_load_dwordx4 v[68:71], v8, s[40:43], s30 offen
    s_waitcnt vmcnt(22)
    v_mfma_f32_16x16x32_bf16 v[184:187], v[104:107], v[72:75], v[184:187]
    ds_read_b64_tr_b16 v[100:101], v20 offset:0
    v_mfma_f32_16x16x32_bf16 v[188:191], v[108:111], v[72:75], v[188:191]
    ds_read_b64_tr_b16 v[102:103], v20 offset:2048
    v_mfma_f32_16x16x32_bf16 v[192:195], v[112:115], v[72:75], v[192:195]
    v_mfma_f32_16x16x32_bf16 v[196:199], v[116:119], v[72:75], v[196:199]
    buffer_load_dwordx4 v[72:75], v9, s[40:43], s30 offen
    v_mfma_f32_16x16x32_bf16 v[200:203], v[104:107], v[76:79], v[200:203]
    v_mfma_f32_16x16x32_bf16 v[204:207], v[108:111], v[76:79], v[204:207]
    v_mfma_f32_16x16x32_bf16 v[208:211], v[112:115], v[76:79], v[208:211]
    v_mfma_f32_16x16x32_bf16 v[212:215], v[116:119], v[76:79], v[212:215]
    buffer_load_dwordx4 v[76:79], v10, s[40:43], s30 offen
    s_waitcnt vmcnt(22)
    v_mfma_f32_16x16x32_bf16 v[216:219], v[104:107], v[80:83], v[216:219]
    v_mfma_f32_16x16x32_bf16 v[220:223], v[108:111], v[80:83], v[220:223]
    v_mfma_f32_16x16x32_bf16 v[224:227], v[112:115], v[80:83], v[224:227]
    v_mfma_f32_16x16x32_bf16 v[228:231], v[116:119], v[80:83], v[228:231]
    buffer_load_dwordx4 v[80:83], v11, s[40:43], s30 offen
    v_mfma_f32_16x16x32_bf16 v[232:235], v[104:107], v[84:87], v[232:235]
    v_mfma_f32_16x16x32_bf16 v[236:239], v[108:111], v[84:87], v[236:239]
    v_mfma_f32_16x16x32_bf16 v[240:243], v[112:115], v[84:87], v[240:243]
    v_mfma_f32_16x16x32_bf16 v[244:247], v[116:119], v[84:87], v[244:247]
    buffer_load_dwordx4 v[84:87], v12, s[40:43], s30 offen
    s_waitcnt lgkmcnt(0)
    s_sub_u32 s27, s27, 1
    s_cmp_lg_u32 s27, 0
    s_cbranch_scc1 attn_out_kernel_g_loop
attn_out_kernel_g_tail:
    s_setprio 0
    s_waitcnt vmcnt(0)
    s_mov_b32 s52, s4
    s_mov_b32 s53, s5
    s_mov_b32 s54, 4194304
    s_mov_b32 s55, 0x20000
    v_and_b32 v1, 15, v0
    s_lshl_b32 s33, s25, 7
    s_lshl_b32 s34, s24, 4
    s_add_u32 s33, s33, s34
    v_add_u32 v1, s33, v1
    v_lshlrev_b32 v1, 11, v1
    v_lshrrev_b32 v2, 4, v0
    s_lshl_b32 s33, s26, 7
    v_add_u32_e64 v22, s33, v1
    v_lshl_add_u32 v3, v2, 3, v22
    s_mov_b32 s37, 131072
    buffer_load_dwordx2 v[104:105], v3, s[52:55], 0 offen offset:0
    buffer_load_dwordx2 v[106:107], v3, s[52:55], 0 offen offset:32
    buffer_load_dwordx2 v[108:109], v3, s[52:55], 0 offen offset:64
    buffer_load_dwordx2 v[110:111], v3, s[52:55], 0 offen offset:96
    buffer_load_dwordx2 v[112:113], v3, s[52:55], s37 offen offset:0
    buffer_load_dwordx2 v[114:115], v3, s[52:55], s37 offen offset:32
    buffer_load_dwordx2 v[116:117], v3, s[52:55], s37 offen offset:64
    buffer_load_dwordx2 v[118:119], v3, s[52:55], s37 offen offset:96
    v_and_b32_e64 v3, 1, v2
    v_lshl_add_u32 v22, v3, 5, v22
    v_lshrrev_b32_e64 v3, 1, v2
    v_lshl_add_u32 v22, v3, 4, v22
    v_lshlrev_b32 v2, 4, v0
    s_xor_b32 s33, s24, 1
    s_mul_i32 s33, s33, 12288
    s_add_u32 s33, s33, 0
    v_add_u32_e64 v6, s33, v2
    s_xor_b32 s33, s24, 2
    s_mul_i32 s33, s33, 12288
    s_add_u32 s33, s33, 4096
    v_add_u32 v7, s33, v2
    s_xor_b32 s33, s24, 3
    s_mul_i32 s33, s33, 12288
    s_add_u32 s33, s33, 8192
    v_add_u32_e64 v8, s33, v2
    s_mul_i32 s33, s24, 12288
    v_add_u32 v4, s33, v2
    v_subrev_u32 v17, s32, v17
    v_subrev_u32 v18, s32, v18
    v_subrev_u32 v19, s32, v19
    v_subrev_u32_e64 v20, s32, v20
    s_lshl_b32 s32, s24, 12
    s_lshl_b32 s31, s24, 16
    s_add_u32 s31, s31, 262144
    s_barrier
    s_add_u32 m0, s32, 49152
    s_nop 0
    buffer_load_dwordx4 v13, s[48:51], s31 offen offset:0 lds
    buffer_load_dwordx4 v14, s[48:51], s31 offen offset:1024 lds
    buffer_load_dwordx4 v15, s[48:51], s31 offen offset:2048 lds
    buffer_load_dwordx4 v16, s[48:51], s31 offen offset:3072 lds
    s_add_u32 s31, s31, 262144
    ds_write_b128 v6, v[136:139] offset:0
    ds_write_b128 v6, v[140:143] offset:1024
    ds_write_b128 v6, v[144:147] offset:2048
    ds_write_b128 v6, v[148:151] offset:3072
    ds_write_b128 v7, v[152:155] offset:0
    ds_write_b128 v7, v[156:159] offset:1024
    ds_write_b128 v7, v[160:163] offset:2048
    ds_write_b128 v7, v[164:167] offset:3072
    ds_write_b128 v8, v[168:171] offset:0
    ds_write_b128 v8, v[172:175] offset:1024
    ds_write_b128 v8, v[176:179] offset:2048
    ds_write_b128 v8, v[180:183] offset:3072
    s_waitcnt lgkmcnt(0)
    s_barrier
    ds_read_b128 v[24:27], v4 offset:0
    ds_read_b128 v[28:31], v4 offset:1024
    ds_read_b128 v[32:35], v4 offset:2048
    ds_read_b128 v[36:39], v4 offset:3072
    ds_read_b128 v[40:43], v4 offset:4096
    ds_read_b128 v[44:47], v4 offset:5120
    ds_read_b128 v[48:51], v4 offset:6144
    ds_read_b128 v[52:55], v4 offset:7168
    ds_read_b128 v[56:59], v4 offset:8192
    ds_read_b128 v[60:63], v4 offset:9216
    ds_read_b128 v[64:67], v4 offset:10240
    ds_read_b128 v[68:71], v4 offset:11264
    s_waitcnt vmcnt(4) lgkmcnt(0)
    s_barrier
    s_lshl_b32 s33, s25, 8
    s_add_u32 s33, s33, 29642752
    v_and_b32 v1, 15, v0
    v_lshlrev_b32 v1, 2, v1
    v_add_u32 v1, s33, v1
    s_cmp_eq_u32 s24, 0
    s_cbranch_scc0 attn_out_kernel_g_noearly
    global_load_dword v2, v1, s[18:19] sc1
attn_out_kernel_g_noearly:
    ds_write_b128 v6, v[200:203] offset:0
    ds_write_b128 v6, v[204:207] offset:1024
    ds_write_b128 v6, v[208:211] offset:2048
    ds_write_b128 v6, v[212:215] offset:3072
    ds_write_b128 v7, v[216:219] offset:0
    ds_write_b128 v7, v[220:223] offset:1024
    ds_write_b128 v7, v[224:227] offset:2048
    ds_write_b128 v7, v[228:231] offset:3072
    ds_write_b128 v8, v[232:235] offset:0
    ds_write_b128 v8, v[236:239] offset:1024
    ds_write_b128 v8, v[240:243] offset:2048
    ds_write_b128 v8, v[244:247] offset:3072
    v_pk_add_f32 v[24:25], v[24:25], v[40:41] op_sel:[0,0] op_sel_hi:[1,1]
    v_pk_add_f32 v[28:29], v[28:29], v[44:45] op_sel:[0,0] op_sel_hi:[1,1]
    v_pk_add_f32 v[32:33], v[32:33], v[48:49] op_sel:[0,0] op_sel_hi:[1,1]
    v_pk_add_f32 v[36:37], v[36:37], v[52:53] op_sel:[0,0] op_sel_hi:[1,1]
    v_pk_add_f32 v[26:27], v[26:27], v[42:43] op_sel:[0,0] op_sel_hi:[1,1]
    v_pk_add_f32 v[30:31], v[30:31], v[46:47] op_sel:[0,0] op_sel_hi:[1,1]
    v_pk_add_f32 v[34:35], v[34:35], v[50:51] op_sel:[0,0] op_sel_hi:[1,1]
    v_pk_add_f32 v[38:39], v[38:39], v[54:55] op_sel:[0,0] op_sel_hi:[1,1]
    v_pk_add_f32 v[120:121], v[120:121], v[56:57] op_sel:[0,0] op_sel_hi:[1,1]
    v_pk_add_f32 v[124:125], v[124:125], v[60:61] op_sel:[0,0] op_sel_hi:[1,1]
    v_pk_add_f32 v[128:129], v[128:129], v[64:65] op_sel:[0,0] op_sel_hi:[1,1]
    v_pk_add_f32 v[132:133], v[132:133], v[68:69] op_sel:[0,0] op_sel_hi:[1,1]
    v_pk_add_f32 v[122:123], v[122:123], v[58:59] op_sel:[0,0] op_sel_hi:[1,1]
    v_pk_add_f32 v[126:127], v[126:127], v[62:63] op_sel:[0,0] op_sel_hi:[1,1]
    v_pk_add_f32 v[130:131], v[130:131], v[66:67] op_sel:[0,0] op_sel_hi:[1,1]
    v_pk_add_f32 v[134:135], v[134:135], v[70:71] op_sel:[0,0] op_sel_hi:[1,1]
    v_lshlrev_b32 v40, 16, v104
    v_lshlrev_b32 v44, 16, v106
    v_lshlrev_b32 v48, 16, v108
    v_lshlrev_b32 v52, 16, v110
    v_and_b32 v41, 0xffff0000, v104
    v_and_b32 v45, 0xffff0000, v106
    v_and_b32 v49, 0xffff0000, v108
    v_and_b32 v53, 0xffff0000, v110
    v_lshlrev_b32 v42, 16, v105
    v_lshlrev_b32 v46, 16, v107
    v_lshlrev_b32 v50, 16, v109
    v_lshlrev_b32 v54, 16, v111
    v_and_b32 v43, 0xffff0000, v105
    v_and_b32 v47, 0xffff0000, v107
    v_and_b32 v51, 0xffff0000, v109
    v_and_b32 v55, 0xffff0000, v111
    v_pk_add_f32 v[120:121], v[120:121], v[24:25] op_sel:[0,0] op_sel_hi:[1,1]
    v_pk_add_f32 v[124:125], v[124:125], v[28:29] op_sel:[0,0] op_sel_hi:[1,1]
    v_pk_add_f32 v[128:129], v[128:129], v[32:33] op_sel:[0,0] op_sel_hi:[1,1]
    v_pk_add_f32 v[132:133], v[132:133], v[36:37] op_sel:[0,0] op_sel_hi:[1,1]
    v_pk_add_f32 v[122:123], v[122:123], v[26:27] op_sel:[0,0] op_sel_hi:[1,1]
    v_pk_add_f32 v[126:127], v[126:127], v[30:31] op_sel:[0,0] op_sel_hi:[1,1]
    v_pk_add_f32 v[130:131], v[130:131], v[34:35] op_sel:[0,0] op_sel_hi:[1,1]
    v_pk_add_f32 v[134:135], v[134:135], v[38:39] op_sel:[0,0] op_sel_hi:[1,1]
    v_pk_add_f32 v[120:121], v[120:121], v[40:41] op_sel:[0,0] op_sel_hi:[1,1]
    v_pk_add_f32 v[124:125], v[124:125], v[44:45] op_sel:[0,0] op_sel_hi:[1,1]
    v_pk_add_f32 v[128:129], v[128:129], v[48:49] op_sel:[0,0] op_sel_hi:[1,1]
    v_pk_add_f32 v[132:133], v[132:133], v[52:53] op_sel:[0,0] op_sel_hi:[1,1]
    v_pk_add_f32 v[122:123], v[122:123], v[42:43] op_sel:[0,0] op_sel_hi:[1,1]
    v_pk_add_f32 v[126:127], v[126:127], v[46:47] op_sel:[0,0] op_sel_hi:[1,1]
    v_pk_add_f32 v[130:131], v[130:131], v[50:51] op_sel:[0,0] op_sel_hi:[1,1]
    v_pk_add_f32 v[134:135], v[134:135], v[54:55] op_sel:[0,0] op_sel_hi:[1,1]
    s_waitcnt lgkmcnt(0)
    s_barrier
    ds_read_b128 v[24:27], v4 offset:0
    ds_read_b128 v[28:31], v4 offset:1024
    ds_read_b128 v[32:35], v4 offset:2048
    ds_read_b128 v[36:39], v4 offset:3072
    ds_read_b128 v[40:43], v4 offset:4096
    ds_read_b128 v[44:47], v4 offset:5120
    ds_read_b128 v[48:51], v4 offset:6144
    ds_read_b128 v[52:55], v4 offset:7168
    ds_read_b128 v[56:59], v4 offset:8192
    ds_read_b128 v[60:63], v4 offset:9216
    ds_read_b128 v[64:67], v4 offset:10240
    ds_read_b128 v[68:71], v4 offset:11264
    v_add_u32 v6, 49152, v17
    v_add_u32 v7, 49152, v18
    v_add_u32 v8, 49152, v19
    v_add_u32 v10, 49152, v20
    s_waitcnt vmcnt(0) lgkmcnt(0)
    s_barrier
    s_add_u32 m0, s32, 0
    s_nop 0
    buffer_load_dwordx4 v13, s[48:51], s31 offen offset:0 lds
    buffer_load_dwordx4 v14, s[48:51], s31 offen offset:1024 lds
    buffer_load_dwordx4 v15, s[48:51], s31 offen offset:2048 lds
    buffer_load_dwordx4 v16, s[48:51], s31 offen offset:3072 lds
    s_add_u32 s31, s31, 262144
    s_add_u32 m0, s32, 16384
    s_nop 0
    s_nop 0
    buffer_load_dwordx4 v13, s[48:51], s31 offen offset:0 lds
    buffer_load_dwordx4 v14, s[48:51], s31 offen offset:1024 lds
    buffer_load_dwordx4 v15, s[48:51], s31 offen offset:2048 lds
    buffer_load_dwordx4 v16, s[48:51], s31 offen offset:3072 lds
    s_add_u32 s31, s31, 262144
    s_add_u32 m0, s32, 32768
    s_nop 0
    s_nop 0
    buffer_load_dwordx4 v13, s[48:51], s31 offen offset:0 lds
    buffer_load_dwordx4 v14, s[48:51], s31 offen offset:1024 lds
    buffer_load_dwordx4 v15, s[48:51], s31 offen offset:2048 lds
    buffer_load_dwordx4 v16, s[48:51], s31 offen offset:3072 lds
    s_add_u32 s31, s31, 262144
    ds_read_b64_tr_b16 v[88:89], v6 offset:16384
    ds_read_b64_tr_b16 v[90:91], v6 offset:18432
    ds_read_b64_tr_b16 v[92:93], v7 offset:16384
    ds_read_b64_tr_b16 v[94:95], v7 offset:18432
    ds_read_b64_tr_b16 v[96:97], v8 offset:16384
    ds_read_b64_tr_b16 v[98:99], v8 offset:18432
    ds_read_b64_tr_b16 v[100:101], v10 offset:16384
    ds_read_b64_tr_b16 v[102:103], v10 offset:18432
    v_pk_add_f32 v[24:25], v[24:25], v[40:41] op_sel:[0,0] op_sel_hi:[1,1]
    v_pk_add_f32 v[28:29], v[28:29], v[44:45] op_sel:[0,0] op_sel_hi:[1,1]
    v_pk_add_f32 v[32:33], v[32:33], v[48:49] op_sel:[0,0] op_sel_hi:[1,1]
    v_pk_add_f32 v[36:37], v[36:37], v[52:53] op_sel:[0,0] op_sel_hi:[1,1]
    v_pk_add_f32 v[26:27], v[26:27], v[42:43] op_sel:[0,0] op_sel_hi:[1,1]
    v_pk_add_f32 v[30:31], v[30:31], v[46:47] op_sel:[0,0] op_sel_hi:[1,1]
    v_pk_add_f32 v[34:35], v[34:35], v[50:51] op_sel:[0,0] op_sel_hi:[1,1]
    v_pk_add_f32 v[38:39], v[38:39], v[54:55] op_sel:[0,0] op_sel_hi:[1,1]
    v_pk_add_f32 v[184:185], v[184:185], v[56:57] op_sel:[0,0] op_sel_hi:[1,1]
    v_pk_add_f32 v[188:189], v[188:189], v[60:61] op_sel:[0,0] op_sel_hi:[1,1]
    v_pk_add_f32 v[192:193], v[192:193], v[64:65] op_sel:[0,0] op_sel_hi:[1,1]
    v_pk_add_f32 v[196:197], v[196:197], v[68:69] op_sel:[0,0] op_sel_hi:[1,1]
    v_pk_add_f32 v[186:187], v[186:187], v[58:59] op_sel:[0,0] op_sel_hi:[1,1]
    v_pk_add_f32 v[190:191], v[190:191], v[62:63] op_sel:[0,0] op_sel_hi:[1,1]
    v_pk_add_f32 v[194:195], v[194:195], v[66:67] op_sel:[0,0] op_sel_hi:[1,1]
    v_pk_add_f32 v[198:199], v[198:199], v[70:71] op_sel:[0,0] op_sel_hi:[1,1]
    v_lshlrev_b32 v40, 16, v112
    v_lshlrev_b32 v44, 16, v114
    v_lshlrev_b32 v48, 16, v116
    v_lshlrev_b32 v52, 16, v118
    v_and_b32 v41, 0xffff0000, v112
    v_and_b32 v45, 0xffff0000, v114
    v_and_b32 v49, 0xffff0000, v116
    v_and_b32 v53, 0xffff0000, v118
    v_lshlrev_b32 v42, 16, v113
    v_lshlrev_b32 v46, 16, v115
    v_lshlrev_b32 v50, 16, v117
    v_lshlrev_b32 v54, 16, v119
    v_and_b32 v43, 0xffff0000, v113
    v_and_b32 v47, 0xffff0000, v115
    v_and_b32 v51, 0xffff0000, v117
    v_and_b32 v55, 0xffff0000, v119
    v_pk_add_f32 v[184:185], v[184:185], v[24:25] op_sel:[0,0] op_sel_hi:[1,1]
    v_pk_add_f32 v[188:189], v[188:189], v[28:29] op_sel:[0,0] op_sel_hi:[1,1]
    v_pk_add_f32 v[192:193], v[192:193], v[32:33] op_sel:[0,0] op_sel_hi:[1,1]
    v_pk_add_f32 v[196:197], v[196:197], v[36:37] op_sel:[0,0] op_sel_hi:[1,1]
    v_pk_add_f32 v[186:187], v[186:187], v[26:27] op_sel:[0,0] op_sel_hi:[1,1]
    v_pk_add_f32 v[190:191], v[190:191], v[30:31] op_sel:[0,0] op_sel_hi:[1,1]
    v_pk_add_f32 v[194:195], v[194:195], v[34:35] op_sel:[0,0] op_sel_hi:[1,1]
    v_pk_add_f32 v[198:199], v[198:199], v[38:39] op_sel:[0,0] op_sel_hi:[1,1]
    v_pk_add_f32 v[184:185], v[184:185], v[40:41] op_sel:[0,0] op_sel_hi:[1,1]
    v_pk_add_f32 v[188:189], v[188:189], v[44:45] op_sel:[0,0] op_sel_hi:[1,1]
    v_pk_add_f32 v[192:193], v[192:193], v[48:49] op_sel:[0,0] op_sel_hi:[1,1]
    v_pk_add_f32 v[196:197], v[196:197], v[52:53] op_sel:[0,0] op_sel_hi:[1,1]
    v_pk_add_f32 v[186:187], v[186:187], v[42:43] op_sel:[0,0] op_sel_hi:[1,1]
    v_pk_add_f32 v[190:191], v[190:191], v[46:47] op_sel:[0,0] op_sel_hi:[1,1]
    v_pk_add_f32 v[194:195], v[194:195], v[50:51] op_sel:[0,0] op_sel_hi:[1,1]
    v_pk_add_f32 v[198:199], v[198:199], v[54:55] op_sel:[0,0] op_sel_hi:[1,1]
    ds_read_b64_tr_b16 v[104:105], v6 offset:20480
    ds_read_b64_tr_b16 v[106:107], v6 offset:22528
    ds_read_b64_tr_b16 v[108:109], v7 offset:20480
    ds_read_b64_tr_b16 v[110:111], v7 offset:22528
    ds_read_b64_tr_b16 v[112:113], v8 offset:20480
    ds_read_b64_tr_b16 v[114:115], v8 offset:22528
    ds_read_b64_tr_b16 v[116:117], v10 offset:20480
    ds_read_b64_tr_b16 v[118:119], v10 offset:22528
    s_cmp_eq_u32 s24, 0
    s_cbranch_scc0 attn_out_kernel_g_ready
    s_mov_b32 s35, 0x40000
attn_out_kernel_g_check:
    v_cmp_eq_u32 vcc, 1, v2
    s_nop 3
    s_cmp_eq_u64 vcc, exec
    s_cbranch_scc1 attn_out_kernel_g_ready
    s_sub_u32 s35, s35, 1
    s_cbranch_scc1 attn_out_kernel_g_ready
    s_sleep 4
    global_load_dword v2, v1, s[18:19] sc1
    s_waitcnt vmcnt(0)
    s_branch attn_out_kernel_g_check
attn_out_kernel_g_ready:
    s_barrier
    s_mov_b32 s28, 114688
    buffer_load_dwordx4 v[24:27], v5, s[40:43], s28 offen sc1
    buffer_load_dwordx4 v[28:31], v9, s[40:43], s28 offen sc1
    s_mov_b32 s28, 115712
    buffer_load_dwordx4 v[32:35], v5, s[40:43], s28 offen sc1
    buffer_load_dwordx4 v[36:39], v9, s[40:43], s28 offen sc1
    s_mov_b32 s28, 116736
    buffer_load_dwordx4 v[40:43], v5, s[40:43], s28 offen sc1
    buffer_load_dwordx4 v[44:47], v9, s[40:43], s28 offen sc1
    s_mov_b32 s28, 117760
    buffer_load_dwordx4 v[48:51], v5, s[40:43], s28 offen sc1
    buffer_load_dwordx4 v[52:55], v9, s[40:43], s28 offen sc1
    s_mov_b32 s28, 118784
    buffer_load_dwordx4 v[56:59], v5, s[40:43], s28 offen sc1
    buffer_load_dwordx4 v[60:63], v9, s[40:43], s28 offen sc1
    s_mov_b32 s28, 119808
    buffer_load_dwordx4 v[64:67], v5, s[40:43], s28 offen sc1
    buffer_load_dwordx4 v[68:71], v9, s[40:43], s28 offen sc1
    s_mov_b32 s28, 120832
    buffer_load_dwordx4 v[72:75], v5, s[40:43], s28 offen sc1
    buffer_load_dwordx4 v[76:79], v9, s[40:43], s28 offen sc1
    s_mov_b32 s28, 121856
    buffer_load_dwordx4 v[80:83], v5, s[40:43], s28 offen sc1
    buffer_load_dwordx4 v[84:87], v9, s[40:43], s28 offen sc1
    s_waitcnt vmcnt(14)
    s_waitcnt lgkmcnt(12)
    v_mfma_f32_16x16x32_bf16 v[120:123], v[88:91], v[24:27], v[120:123]
    ds_read_b64_tr_b16 v[216:217], v6 offset:24576
    v_mfma_f32_16x16x32_bf16 v[184:187], v[88:91], v[28:31], v[184:187]
    ds_read_b64_tr_b16 v[218:219], v6 offset:26624
    v_mfma_f32_16x16x32_bf16 v[124:127], v[92:95], v[24:27], v[124:127]
    ds_read_b64_tr_b16 v[220:221], v7 offset:24576
    v_mfma_f32_16x16x32_bf16 v[188:191], v[92:95], v[28:31], v[188:191]
    ds_read_b64_tr_b16 v[222:223], v7 offset:26624
    s_waitcnt lgkmcnt(12)
    v_mfma_f32_16x16x32_bf16 v[128:131], v[96:99], v[24:27], v[128:131]
    ds_read_b64_tr_b16 v[224:225], v8 offset:24576
    v_mfma_f32_16x16x32_bf16 v[192:195], v[96:99], v[28:31], v[192:195]
    ds_read_b64_tr_b16 v[226:227], v8 offset:26624
    v_mfma_f32_16x16x32_bf16 v[132:135], v[100:103], v[24:27], v[132:135]
    ds_read_b64_tr_b16 v[228:229], v10 offset:24576
    v_mfma_f32_16x16x32_bf16 v[196:199], v[100:103], v[28:31], v[196:199]
    ds_read_b64_tr_b16 v[230:231], v10 offset:26624
    s_mov_b32 s28, 122880
    buffer_load_dwordx4 v[136:139], v5, s[40:43], s28 offen sc1
    buffer_load_dwordx4 v[140:143], v9, s[40:43], s28 offen sc1
    s_mov_b32 s28, 123904
    buffer_load_dwordx4 v[144:147], v5, s[40:43], s28 offen sc1
    buffer_load_dwordx4 v[148:151], v9, s[40:43], s28 offen sc1
    s_waitcnt vmcnt(16)
    s_waitcnt lgkmcnt(12)
    v_mfma_f32_16x16x32_bf16 v[120:123], v[104:107], v[32:35], v[120:123]
    ds_read_b64_tr_b16 v[232:233], v6 offset:28672
    v_mfma_f32_16x16x32_bf16 v[184:187], v[104:107], v[36:39], v[184:187]
    ds_read_b64_tr_b16 v[234:235], v6 offset:30720
    v_mfma_f32_16x16x32_bf16 v[124:127], v[108:111], v[32:35], v[124:127]
    ds_read_b64_tr_b16 v[236:237], v7 offset:28672
    v_mfma_f32_16x16x32_bf16 v[188:191], v[108:111], v[36:39], v[188:191]
    ds_read_b64_tr_b16 v[238:239], v7 offset:30720
    s_waitcnt lgkmcnt(12)
    v_mfma_f32_16x16x32_bf16 v[128:131], v[112:115], v[32:35], v[128:131]
    ds_read_b64_tr_b16 v[240:241], v8 offset:28672
    v_mfma_f32_16x16x32_bf16 v[192:195], v[112:115], v[36:39], v[192:195]
    ds_read_b64_tr_b16 v[242:243], v8 offset:30720
    v_mfma_f32_16x16x32_bf16 v[132:135], v[116:119], v[32:35], v[132:135]
    ds_read_b64_tr_b16 v[244:245], v10 offset:28672
    v_mfma_f32_16x16x32_bf16 v[196:199], v[116:119], v[36:39], v[196:199]
    ds_read_b64_tr_b16 v[246:247], v10 offset:30720
    s_mov_b32 s28, 124928
    buffer_load_dwordx4 v[152:155], v5, s[40:43], s28 offen sc1
    buffer_load_dwordx4 v[156:159], v9, s[40:43], s28 offen sc1
    s_mov_b32 s28, 125952
    buffer_load_dwordx4 v[160:163], v5, s[40:43], s28 offen sc1
    buffer_load_dwordx4 v[164:167], v9, s[40:43], s28 offen sc1
    s_waitcnt vmcnt(18)
    s_waitcnt lgkmcnt(12)
    v_mfma_f32_16x16x32_bf16 v[120:123], v[216:219], v[40:43], v[120:123]
    ds_read_b64_tr_b16 v[88:89], v6 offset:0
    v_mfma_f32_16x16x32_bf16 v[184:187], v[216:219], v[44:47], v[184:187]
    ds_read_b64_tr_b16 v[90:91], v6 offset:2048
    v_mfma_f32_16x16x32_bf16 v[124:127], v[220:223], v[40:43], v[124:127]
    ds_read_b64_tr_b16 v[92:93], v7 offset:0
    v_mfma_f32_16x16x32_bf16 v[188:191], v[220:223], v[44:47], v[188:191]
    ds_read_b64_tr_b16 v[94:95], v7 offset:2048
    s_waitcnt lgkmcnt(12)
    v_mfma_f32_16x16x32_bf16 v[128:131], v[224:227], v[40:43], v[128:131]
    ds_read_b64_tr_b16 v[96:97], v8 offset:0
    v_mfma_f32_16x16x32_bf16 v[192:195], v[224:227], v[44:47], v[192:195]
    ds_read_b64_tr_b16 v[98:99], v8 offset:2048
    v_mfma_f32_16x16x32_bf16 v[132:135], v[228:231], v[40:43], v[132:135]
    ds_read_b64_tr_b16 v[100:101], v10 offset:0
    v_mfma_f32_16x16x32_bf16 v[196:199], v[228:231], v[44:47], v[196:199]
    ds_read_b64_tr_b16 v[102:103], v10 offset:2048
    s_mov_b32 s28, 126976
    buffer_load_dwordx4 v[168:171], v5, s[40:43], s28 offen sc1
    buffer_load_dwordx4 v[172:175], v9, s[40:43], s28 offen sc1
    s_mov_b32 s28, 128000
    buffer_load_dwordx4 v[176:179], v5, s[40:43], s28 offen sc1
    buffer_load_dwordx4 v[180:183], v9, s[40:43], s28 offen sc1
    s_waitcnt vmcnt(20)
    s_waitcnt lgkmcnt(12)
    v_mfma_f32_16x16x32_bf16 v[120:123], v[232:235], v[48:51], v[120:123]
    ds_read_b64_tr_b16 v[104:105], v6 offset:4096
    v_mfma_f32_16x16x32_bf16 v[184:187], v[232:235], v[52:55], v[184:187]
    ds_read_b64_tr_b16 v[106:107], v6 offset:6144
    v_mfma_f32_16x16x32_bf16 v[124:127], v[236:239], v[48:51], v[124:127]
    ds_read_b64_tr_b16 v[108:109], v7 offset:4096
    v_mfma_f32_16x16x32_bf16 v[188:191], v[236:239], v[52:55], v[188:191]
    ds_read_b64_tr_b16 v[110:111], v7 offset:6144
    s_waitcnt lgkmcnt(12)
    v_mfma_f32_16x16x32_bf16 v[128:131], v[240:243], v[48:51], v[128:131]
    ds_read_b64_tr_b16 v[112:113], v8 offset:4096
    v_mfma_f32_16x16x32_bf16 v[192:195], v[240:243], v[52:55], v[192:195]
    ds_read_b64_tr_b16 v[114:115], v8 offset:6144
    v_mfma_f32_16x16x32_bf16 v[132:135], v[244:247], v[48:51], v[132:135]
    ds_read_b64_tr_b16 v[116:117], v10 offset:4096
    v_mfma_f32_16x16x32_bf16 v[196:199], v[244:247], v[52:55], v[196:199]
    ds_read_b64_tr_b16 v[118:119], v10 offset:6144
    s_mov_b32 s28, 129024
    buffer_load_dwordx4 v[200:203], v5, s[40:43], s28 offen sc1
    buffer_load_dwordx4 v[204:207], v9, s[40:43], s28 offen sc1
    s_mov_b32 s28, 130048
    buffer_load_dwordx4 v[208:211], v5, s[40:43], s28 offen sc1
    buffer_load_dwordx4 v[212:215], v9, s[40:43], s28 offen sc1
    s_waitcnt vmcnt(22)
    s_barrier
    s_waitcnt lgkmcnt(12)
    v_mfma_f32_16x16x32_bf16 v[120:123], v[88:91], v[56:59], v[120:123]
    ds_read_b64_tr_b16 v[216:217], v6 offset:8192
    v_mfma_f32_16x16x32_bf16 v[184:187], v[88:91], v[60:63], v[184:187]
    ds_read_b64_tr_b16 v[218:219], v6 offset:10240
    s_add_u32 m0, s32, 65536
    s_nop 0
    v_mfma_f32_16x16x32_bf16 v[124:127], v[92:95], v[56:59], v[124:127]
    ds_read_b64_tr_b16 v[220:221], v7 offset:8192
    v_mfma_f32_16x16x32_bf16 v[188:191], v[92:95], v[60:63], v[188:191]
    ds_read_b64_tr_b16 v[222:223], v7 offset:10240
    buffer_load_dwordx4 v13, s[48:51], s31 offen offset:0 lds
    buffer_load_dwordx4 v14, s[48:51], s31 offen offset:1024 lds
    s_waitcnt lgkmcnt(12)
    v_mfma_f32_16x16x32_bf16 v[128:131], v[96:99], v[56:59], v[128:131]
    ds_read_b64_tr_b16 v[224:225], v8 offset:8192
    v_mfma_f32_16x16x32_bf16 v[192:195], v[96:99], v[60:63], v[192:195]
    ds_read_b64_tr_b16 v[226:227], v8 offset:10240
    buffer_load_dwordx4 v15, s[48:51], s31 offen offset:2048 lds
    buffer_load_dwordx4 v16, s[48:51], s31 offen offset:3072 lds
    v_mfma_f32_16x16x32_bf16 v[132:135], v[100:103], v[56:59], v[132:135]
    ds_read_b64_tr_b16 v[228:229], v10 offset:8192
    v_mfma_f32_16x16x32_bf16 v[196:199], v[100:103], v[60:63], v[196:199]
    ds_read_b64_tr_b16 v[230:231], v10 offset:10240
    s_add_u32 s31, s31, 262144
    s_mov_b32 s28, 131072
    buffer_load_dwordx4 v[24:27], v5, s[40:43], s28 offen sc1
    buffer_load_dwordx4 v[28:31], v9, s[40:43], s28 offen sc1
    s_mov_b32 s28, 132096
    buffer_load_dwordx4 v[32:35], v5, s[40:43], s28 offen sc1
    buffer_load_dwordx4 v[36:39], v9, s[40:43], s28 offen sc1
    s_waitcnt vmcnt(28)
    s_waitcnt lgkmcnt(12)
    v_mfma_f32_16x16x32_bf16 v[120:123], v[104:107], v[64:67], v[120:123]
    ds_read_b64_tr_b16 v[232:233], v6 offset:12288
    v_mfma_f32_16x16x32_bf16 v[184:187], v[104:107], v[68:71], v[184:187]
    ds_read_b64_tr_b16 v[234:235], v6 offset:14336
    v_mfma_f32_16x16x32_bf16 v[124:127], v[108:111], v[64:67], v[124:127]
    ds_read_b64_tr_b16 v[236:237], v7 offset:12288
    v_mfma_f32_16x16x32_bf16 v[188:191], v[108:111], v[68:71], v[188:191]
    ds_read_b64_tr_b16 v[238:239], v7 offset:14336
    s_waitcnt lgkmcnt(12)
    v_mfma_f32_16x16x32_bf16 v[128:131], v[112:115], v[64:67], v[128:131]
    ds_read_b64_tr_b16 v[240:241], v8 offset:12288
    v_mfma_f32_16x16x32_bf16 v[192:195], v[112:115], v[68:71], v[192:195]
    ds_read_b64_tr_b16 v[242:243], v8 offset:14336
    v_mfma_f32_16x16x32_bf16 v[132:135], v[116:119], v[64:67], v[132:135]
    ds_read_b64_tr_b16 v[244:245], v10 offset:12288
    v_mfma_f32_16x16x32_bf16 v[196:199], v[116:119], v[68:71], v[196:199]
    ds_read_b64_tr_b16 v[246:247], v10 offset:14336
    s_mov_b32 s28, 133120
    buffer_load_dwordx4 v[40:43], v5, s[40:43], s28 offen sc1
    buffer_load_dwordx4 v[44:47], v9, s[40:43], s28 offen sc1
    s_mov_b32 s28, 134144
    buffer_load_dwordx4 v[48:51], v5, s[40:43], s28 offen sc1
    buffer_load_dwordx4 v[52:55], v9, s[40:43], s28 offen sc1
    s_waitcnt vmcnt(30)
    s_waitcnt lgkmcnt(12)
    v_mfma_f32_16x16x32_bf16 v[120:123], v[216:219], v[72:75], v[120:123]
    ds_read_b64_tr_b16 v[88:89], v17 offset:0
    v_mfma_f32_16x16x32_bf16 v[184:187], v[216:219], v[76:79], v[184:187]
    ds_read_b64_tr_b16 v[90:91], v17 offset:2048
    v_mfma_f32_16x16x32_bf16 v[124:127], v[220:223], v[72:75], v[124:127]
    ds_read_b64_tr_b16 v[92:93], v18 offset:0
    v_mfma_f32_16x16x32_bf16 v[188:191], v[220:223], v[76:79], v[188:191]
    ds_read_b64_tr_b16 v[94:95], v18 offset:2048
    s_waitcnt lgkmcnt(12)
    v_mfma_f32_16x16x32_bf16 v[128:131], v[224:227], v[72:75], v[128:131]
    ds_read_b64_tr_b16 v[96:97], v19 offset:0
    v_mfma_f32_16x16x32_bf16 v[192:195], v[224:227], v[76:79], v[192:195]
    ds_read_b64_tr_b16 v[98:99], v19 offset:2048
    v_mfma_f32_16x16x32_bf16 v[132:135], v[228:231], v[72:75], v[132:135]
    ds_read_b64_tr_b16 v[100:101], v20 offset:0
    v_mfma_f32_16x16x32_bf16 v[196:199], v[228:231], v[76:79], v[196:199]
    ds_read_b64_tr_b16 v[102:103], v20 offset:2048
    s_mov_b32 s28, 135168
    buffer_load_dwordx4 v[56:59], v5, s[40:43], s28 offen sc1
    buffer_load_dwordx4 v[60:63], v9, s[40:43], s28 offen sc1
    s_mov_b32 s28, 136192
    buffer_load_dwordx4 v[64:67], v5, s[40:43], s28 offen sc1
    buffer_load_dwordx4 v[68:71], v9, s[40:43], s28 offen sc1
    s_waitcnt vmcnt(32)
    s_waitcnt lgkmcnt(12)
    v_mfma_f32_16x16x32_bf16 v[120:123], v[232:235], v[80:83], v[120:123]
    ds_read_b64_tr_b16 v[104:105], v17 offset:4096
    v_mfma_f32_16x16x32_bf16 v[184:187], v[232:235], v[84:87], v[184:187]
    ds_read_b64_tr_b16 v[106:107], v17 offset:6144
    v_mfma_f32_16x16x32_bf16 v[124:127], v[236:239], v[80:83], v[124:127]
    ds_read_b64_tr_b16 v[108:109], v18 offset:4096
    v_mfma_f32_16x16x32_bf16 v[188:191], v[236:239], v[84:87], v[188:191]
    ds_read_b64_tr_b16 v[110:111], v18 offset:6144
    s_waitcnt lgkmcnt(12)
    v_mfma_f32_16x16x32_bf16 v[128:131], v[240:243], v[80:83], v[128:131]
    ds_read_b64_tr_b16 v[112:113], v19 offset:4096
    v_mfma_f32_16x16x32_bf16 v[192:195], v[240:243], v[84:87], v[192:195]
    ds_read_b64_tr_b16 v[114:115], v19 offset:6144
    v_mfma_f32_16x16x32_bf16 v[132:135], v[244:247], v[80:83], v[132:135]
    ds_read_b64_tr_b16 v[116:117], v20 offset:4096
    v_mfma_f32_16x16x32_bf16 v[196:199], v[244:247], v[84:87], v[196:199]
    ds_read_b64_tr_b16 v[118:119], v20 offset:6144
    s_mov_b32 s28, 137216
    buffer_load_dwordx4 v[72:75], v5, s[40:43], s28 offen sc1
    buffer_load_dwordx4 v[76:79], v9, s[40:43], s28 offen sc1
    s_mov_b32 s28, 138240
    buffer_load_dwordx4 v[80:83], v5, s[40:43], s28 offen sc1
    buffer_load_dwordx4 v[84:87], v9, s[40:43], s28 offen sc1
    s_waitcnt vmcnt(34)
    s_barrier
    s_waitcnt lgkmcnt(12)
    v_mfma_f32_16x16x32_bf16 v[120:123], v[88:91], v[136:139], v[120:123]
    ds_read_b64_tr_b16 v[216:217], v17 offset:8192
    v_mfma_f32_16x16x32_bf16 v[184:187], v[88:91], v[140:143], v[184:187]
    ds_read_b64_tr_b16 v[218:219], v17 offset:10240
    s_add_u32 m0, s32, 49152
    s_nop 0
    v_mfma_f32_16x16x32_bf16 v[124:127], v[92:95], v[136:139], v[124:127]
    ds_read_b64_tr_b16 v[220:221], v18 offset:8192
    v_mfma_f32_16x16x32_bf16 v[188:191], v[92:95], v[140:143], v[188:191]
    ds_read_b64_tr_b16 v[222:223], v18 offset:10240
    buffer_load_dwordx4 v13, s[48:51], s31 offen offset:0 lds
    buffer_load_dwordx4 v14, s[48:51], s31 offen offset:1024 lds
    s_waitcnt lgkmcnt(12)
    v_mfma_f32_16x16x32_bf16 v[128:131], v[96:99], v[136:139], v[128:131]
    ds_read_b64_tr_b16 v[224:225], v19 offset:8192
    v_mfma_f32_16x16x32_bf16 v[192:195], v[96:99], v[140:143], v[192:195]
    ds_read_b64_tr_b16 v[226:227], v19 offset:10240
    buffer_load_dwordx4 v15, s[48:51], s31 offen offset:2048 lds
    buffer_load_dwordx4 v16, s[48:51], s31 offen offset:3072 lds
    v_mfma_f32_16x16x32_bf16 v[132:135], v[100:103], v[136:139], v[132:135]
    ds_read_b64_tr_b16 v[228:229], v20 offset:8192
    v_mfma_f32_16x16x32_bf16 v[196:199], v[100:103], v[140:143], v[196:199]
    ds_read_b64_tr_b16 v[230:231], v20 offset:10240
    s_add_u32 s31, s31, 262144
    s_mov_b32 s28, 139264
    buffer_load_dwordx4 v[136:139], v5, s[40:43], s28 offen sc1
    buffer_load_dwordx4 v[140:143], v9, s[40:43], s28 offen sc1
    s_waitcnt vmcnt(38)
    s_waitcnt lgkmcnt(12)
    v_mfma_f32_16x16x32_bf16 v[120:123], v[104:107], v[144:147], v[120:123]
    ds_read_b64_tr_b16 v[232:233], v17 offset:12288
    v_mfma_f32_16x16x32_bf16 v[184:187], v[104:107], v[148:151], v[184:187]
    ds_read_b64_tr_b16 v[234:235], v17 offset:14336
    v_mfma_f32_16x16x32_bf16 v[124:127], v[108:111], v[144:147], v[124:127]
    ds_read_b64_tr_b16 v[236:237], v18 offset:12288
    v_mfma_f32_16x16x32_bf16 v[188:191], v[108:111], v[148:151], v[188:191]
    ds_read_b64_tr_b16 v[238:239], v18 offset:14336
    s_waitcnt lgkmcnt(12)
    v_mfma_f32_16x16x32_bf16 v[128:131], v[112:115], v[144:147], v[128:131]
    ds_read_b64_tr_b16 v[240:241], v19 offset:12288
    v_mfma_f32_16x16x32_bf16 v[192:195], v[112:115], v[148:151], v[192:195]
    ds_read_b64_tr_b16 v[242:243], v19 offset:14336
    v_mfma_f32_16x16x32_bf16 v[132:135], v[116:119], v[144:147], v[132:135]
    ds_read_b64_tr_b16 v[244:245], v20 offset:12288
    v_mfma_f32_16x16x32_bf16 v[196:199], v[116:119], v[148:151], v[196:199]
    ds_read_b64_tr_b16 v[246:247], v20 offset:14336
    s_mov_b32 s28, 140288
    buffer_load_dwordx4 v[144:147], v5, s[40:43], s28 offen sc1
    buffer_load_dwordx4 v[148:151], v9, s[40:43], s28 offen sc1
    s_waitcnt vmcnt(38)
    s_waitcnt lgkmcnt(12)
    v_mfma_f32_16x16x32_bf16 v[120:123], v[216:219], v[152:155], v[120:123]
    ds_read_b64_tr_b16 v[88:89], v17 offset:16384
    v_mfma_f32_16x16x32_bf16 v[184:187], v[216:219], v[156:159], v[184:187]
    ds_read_b64_tr_b16 v[90:91], v17 offset:18432
    v_mfma_f32_16x16x32_bf16 v[124:127], v[220:223], v[152:155], v[124:127]
    ds_read_b64_tr_b16 v[92:93], v18 offset:16384
    v_mfma_f32_16x16x32_bf16 v[188:191], v[220:223], v[156:159], v[188:191]
    ds_read_b64_tr_b16 v[94:95], v18 offset:18432
    s_waitcnt lgkmcnt(12)
    v_mfma_f32_16x16x32_bf16 v[128:131], v[224:227], v[152:155], v[128:131]
    ds_read_b64_tr_b16 v[96:97], v19 offset:16384
    v_mfma_f32_16x16x32_bf16 v[192:195], v[224:227], v[156:159], v[192:195]
    ds_read_b64_tr_b16 v[98:99], v19 offset:18432
    v_mfma_f32_16x16x32_bf16 v[132:135], v[228:231], v[152:155], v[132:135]
    ds_read_b64_tr_b16 v[100:101], v20 offset:16384
    v_mfma_f32_16x16x32_bf16 v[196:199], v[228:231], v[156:159], v[196:199]
    ds_read_b64_tr_b16 v[102:103], v20 offset:18432
    s_mov_b32 s28, 141312
    buffer_load_dwordx4 v[152:155], v5, s[40:43], s28 offen sc1
    buffer_load_dwordx4 v[156:159], v9, s[40:43], s28 offen sc1
    s_waitcnt vmcnt(38)
    s_waitcnt lgkmcnt(12)
    v_mfma_f32_16x16x32_bf16 v[120:123], v[232:235], v[160:163], v[120:123]
    ds_read_b64_tr_b16 v[104:105], v17 offset:20480
    v_mfma_f32_16x16x32_bf16 v[184:187], v[232:235], v[164:167], v[184:187]
    ds_read_b64_tr_b16 v[106:107], v17 offset:22528
    v_mfma_f32_16x16x32_bf16 v[124:127], v[236:239], v[160:163], v[124:127]
    ds_read_b64_tr_b16 v[108:109], v18 offset:20480
    v_mfma_f32_16x16x32_bf16 v[188:191], v[236:239], v[164:167], v[188:191]
    ds_read_b64_tr_b16 v[110:111], v18 offset:22528
    s_waitcnt lgkmcnt(12)
    v_mfma_f32_16x16x32_bf16 v[128:131], v[240:243], v[160:163], v[128:131]
    ds_read_b64_tr_b16 v[112:113], v19 offset:20480
    v_mfma_f32_16x16x32_bf16 v[192:195], v[240:243], v[164:167], v[192:195]
    ds_read_b64_tr_b16 v[114:115], v19 offset:22528
    v_mfma_f32_16x16x32_bf16 v[132:135], v[244:247], v[160:163], v[132:135]
    ds_read_b64_tr_b16 v[116:117], v20 offset:20480
    v_mfma_f32_16x16x32_bf16 v[196:199], v[244:247], v[164:167], v[196:199]
    ds_read_b64_tr_b16 v[118:119], v20 offset:22528
    s_mov_b32 s28, 142336
    buffer_load_dwordx4 v[160:163], v5, s[40:43], s28 offen sc1
    buffer_load_dwordx4 v[164:167], v9, s[40:43], s28 offen sc1
    s_waitcnt vmcnt(38)
    s_barrier
    s_waitcnt lgkmcnt(12)
    v_mfma_f32_16x16x32_bf16 v[120:123], v[88:91], v[168:171], v[120:123]
    ds_read_b64_tr_b16 v[216:217], v17 offset:24576
    v_mfma_f32_16x16x32_bf16 v[184:187], v[88:91], v[172:175], v[184:187]
    ds_read_b64_tr_b16 v[218:219], v17 offset:26624
    s_add_u32 m0, s32, 0
    s_nop 0
    v_mfma_f32_16x16x32_bf16 v[124:127], v[92:95], v[168:171], v[124:127]
    ds_read_b64_tr_b16 v[220:221], v18 offset:24576
    v_mfma_f32_16x16x32_bf16 v[188:191], v[92:95], v[172:175], v[188:191]
    ds_read_b64_tr_b16 v[222:223], v18 offset:26624
    buffer_load_dwordx4 v13, s[48:51], s31 offen offset:0 lds
    buffer_load_dwordx4 v14, s[48:51], s31 offen offset:1024 lds
    s_waitcnt lgkmcnt(12)
    v_mfma_f32_16x16x32_bf16 v[128:131], v[96:99], v[168:171], v[128:131]
    ds_read_b64_tr_b16 v[224:225], v19 offset:24576
    v_mfma_f32_16x16x32_bf16 v[192:195], v[96:99], v[172:175], v[192:195]
    ds_read_b64_tr_b16 v[226:227], v19 offset:26624
    buffer_load_dwordx4 v15, s[48:51], s31 offen offset:2048 lds
    buffer_load_dwordx4 v16, s[48:51], s31 offen offset:3072 lds
    v_mfma_f32_16x16x32_bf16 v[132:135], v[100:103], v[168:171], v[132:135]
    ds_read_b64_tr_b16 v[228:229], v20 offset:24576
    v_mfma_f32_16x16x32_bf16 v[196:199], v[100:103], v[172:175], v[196:199]
    ds_read_b64_tr_b16 v[230:231], v20 offset:26624
    s_add_u32 s31, s31, 262144
    s_mov_b32 s28, 143360
    buffer_load_dwordx4 v[168:171], v5, s[40:43], s28 offen sc1
    buffer_load_dwordx4 v[172:175], v9, s[40:43], s28 offen sc1
    s_waitcnt vmcnt(42)
    s_waitcnt lgkmcnt(12)
    v_mfma_f32_16x16x32_bf16 v[120:123], v[104:107], v[176:179], v[120:123]
    ds_read_b64_tr_b16 v[232:233], v17 offset:28672
    v_mfma_f32_16x16x32_bf16 v[184:187], v[104:107], v[180:183], v[184:187]
    ds_read_b64_tr_b16 v[234:235], v17 offset:30720
    v_mfma_f32_16x16x32_bf16 v[124:127], v[108:111], v[176:179], v[124:127]
    ds_read_b64_tr_b16 v[236:237], v18 offset:28672
    v_mfma_f32_16x16x32_bf16 v[188:191], v[108:111], v[180:183], v[188:191]
    ds_read_b64_tr_b16 v[238:239], v18 offset:30720
    s_waitcnt lgkmcnt(12)
    v_mfma_f32_16x16x32_bf16 v[128:131], v[112:115], v[176:179], v[128:131]
    ds_read_b64_tr_b16 v[240:241], v19 offset:28672
    v_mfma_f32_16x16x32_bf16 v[192:195], v[112:115], v[180:183], v[192:195]
    ds_read_b64_tr_b16 v[242:243], v19 offset:30720
    v_mfma_f32_16x16x32_bf16 v[132:135], v[116:119], v[176:179], v[132:135]
    ds_read_b64_tr_b16 v[244:245], v20 offset:28672
    v_mfma_f32_16x16x32_bf16 v[196:199], v[116:119], v[180:183], v[196:199]
    ds_read_b64_tr_b16 v[246:247], v20 offset:30720
    s_mov_b32 s28, 144384
    buffer_load_dwordx4 v[176:179], v5, s[40:43], s28 offen sc1
    buffer_load_dwordx4 v[180:183], v9, s[40:43], s28 offen sc1
    s_waitcnt vmcnt(42)
    s_waitcnt lgkmcnt(12)
    v_mfma_f32_16x16x32_bf16 v[120:123], v[216:219], v[200:203], v[120:123]
    ds_read_b64_tr_b16 v[88:89], v17 offset:32768
    v_mfma_f32_16x16x32_bf16 v[184:187], v[216:219], v[204:207], v[184:187]
    ds_read_b64_tr_b16 v[90:91], v17 offset:34816
    v_mfma_f32_16x16x32_bf16 v[124:127], v[220:223], v[200:203], v[124:127]
    ds_read_b64_tr_b16 v[92:93], v18 offset:32768
    v_mfma_f32_16x16x32_bf16 v[188:191], v[220:223], v[204:207], v[188:191]
    ds_read_b64_tr_b16 v[94:95], v18 offset:34816
    s_waitcnt lgkmcnt(12)
    v_mfma_f32_16x16x32_bf16 v[128:131], v[224:227], v[200:203], v[128:131]
    ds_read_b64_tr_b16 v[96:97], v19 offset:32768
    v_mfma_f32_16x16x32_bf16 v[192:195], v[224:227], v[204:207], v[192:195]
    ds_read_b64_tr_b16 v[98:99], v19 offset:34816
    v_mfma_f32_16x16x32_bf16 v[132:135], v[228:231], v[200:203], v[132:135]
    ds_read_b64_tr_b16 v[100:101], v20 offset:32768
    v_mfma_f32_16x16x32_bf16 v[196:199], v[228:231], v[204:207], v[196:199]
    ds_read_b64_tr_b16 v[102:103], v20 offset:34816
    s_mov_b32 s28, 145408
    buffer_load_dwordx4 v[200:203], v5, s[40:43], s28 offen sc1
    buffer_load_dwordx4 v[204:207], v9, s[40:43], s28 offen sc1
    s_waitcnt vmcnt(42)
    s_waitcnt lgkmcnt(12)
    v_mfma_f32_16x16x32_bf16 v[120:123], v[232:235], v[208:211], v[120:123]
    ds_read_b64_tr_b16 v[104:105], v17 offset:36864
    v_mfma_f32_16x16x32_bf16 v[184:187], v[232:235], v[212:215], v[184:187]
    ds_read_b64_tr_b16 v[106:107], v17 offset:38912
    v_mfma_f32_16x16x32_bf16 v[124:127], v[236:239], v[208:211], v[124:127]
    ds_read_b64_tr_b16 v[108:109], v18 offset:36864
    v_mfma_f32_16x16x32_bf16 v[188:191], v[236:239], v[212:215], v[188:191]
    ds_read_b64_tr_b16 v[110:111], v18 offset:38912
    s_waitcnt lgkmcnt(12)
    v_mfma_f32_16x16x32_bf16 v[128:131], v[240:243], v[208:211], v[128:131]
    ds_read_b64_tr_b16 v[112:113], v19 offset:36864
    v_mfma_f32_16x16x32_bf16 v[192:195], v[240:243], v[212:215], v[192:195]
    ds_read_b64_tr_b16 v[114:115], v19 offset:38912
    v_mfma_f32_16x16x32_bf16 v[132:135], v[244:247], v[208:211], v[132:135]
    ds_read_b64_tr_b16 v[116:117], v20 offset:36864
    v_mfma_f32_16x16x32_bf16 v[196:199], v[244:247], v[212:215], v[196:199]
    ds_read_b64_tr_b16 v[118:119], v20 offset:38912
    s_mov_b32 s28, 146432
    buffer_load_dwordx4 v[208:211], v5, s[40:43], s28 offen sc1
    buffer_load_dwordx4 v[212:215], v9, s[40:43], s28 offen sc1
    s_waitcnt vmcnt(38)
    s_waitcnt lgkmcnt(12)
    v_mfma_f32_16x16x32_bf16 v[120:123], v[88:91], v[24:27], v[120:123]
    ds_read_b64_tr_b16 v[216:217], v17 offset:40960
    v_mfma_f32_16x16x32_bf16 v[184:187], v[88:91], v[28:31], v[184:187]
    ds_read_b64_tr_b16 v[218:219], v17 offset:43008
    v_mfma_f32_16x16x32_bf16 v[124:127], v[92:95], v[24:27], v[124:127]
    ds_read_b64_tr_b16 v[220:221], v18 offset:40960
    v_mfma_f32_16x16x32_bf16 v[188:191], v[92:95], v[28:31], v[188:191]
    ds_read_b64_tr_b16 v[222:223], v18 offset:43008
    s_waitcnt lgkmcnt(12)
    v_mfma_f32_16x16x32_bf16 v[128:131], v[96:99], v[24:27], v[128:131]
    ds_read_b64_tr_b16 v[224:225], v19 offset:40960
    v_mfma_f32_16x16x32_bf16 v[192:195], v[96:99], v[28:31], v[192:195]
    ds_read_b64_tr_b16 v[226:227], v19 offset:43008
    v_mfma_f32_16x16x32_bf16 v[132:135], v[100:103], v[24:27], v[132:135]
    ds_read_b64_tr_b16 v[228:229], v20 offset:40960
    v_mfma_f32_16x16x32_bf16 v[196:199], v[100:103], v[28:31], v[196:199]
    ds_read_b64_tr_b16 v[230:231], v20 offset:43008
    s_waitcnt vmcnt(36)
    s_waitcnt lgkmcnt(12)
    v_mfma_f32_16x16x32_bf16 v[120:123], v[104:107], v[32:35], v[120:123]
    ds_read_b64_tr_b16 v[232:233], v17 offset:45056
    v_mfma_f32_16x16x32_bf16 v[184:187], v[104:107], v[36:39], v[184:187]
    ds_read_b64_tr_b16 v[234:235], v17 offset:47104
    v_mfma_f32_16x16x32_bf16 v[124:127], v[108:111], v[32:35], v[124:127]
    ds_read_b64_tr_b16 v[236:237], v18 offset:45056
    v_mfma_f32_16x16x32_bf16 v[188:191], v[108:111], v[36:39], v[188:191]
    ds_read_b64_tr_b16 v[238:239], v18 offset:47104
    s_waitcnt lgkmcnt(12)
    v_mfma_f32_16x16x32_bf16 v[128:131], v[112:115], v[32:35], v[128:131]
    ds_read_b64_tr_b16 v[240:241], v19 offset:45056
    v_mfma_f32_16x16x32_bf16 v[192:195], v[112:115], v[36:39], v[192:195]
    ds_read_b64_tr_b16 v[242:243], v19 offset:47104
    v_mfma_f32_16x16x32_bf16 v[132:135], v[116:119], v[32:35], v[132:135]
    ds_read_b64_tr_b16 v[244:245], v20 offset:45056
    v_mfma_f32_16x16x32_bf16 v[196:199], v[116:119], v[36:39], v[196:199]
    ds_read_b64_tr_b16 v[246:247], v20 offset:47104
    s_waitcnt vmcnt(34)
    s_barrier
    s_waitcnt lgkmcnt(12)
    v_mfma_f32_16x16x32_bf16 v[120:123], v[216:219], v[40:43], v[120:123]
    ds_read_b64_tr_b16 v[88:89], v6 offset:16384
    v_mfma_f32_16x16x32_bf16 v[184:187], v[216:219], v[44:47], v[184:187]
    ds_read_b64_tr_b16 v[90:91], v6 offset:18432
    v_mfma_f32_16x16x32_bf16 v[124:127], v[220:223], v[40:43], v[124:127]
    ds_read_b64_tr_b16 v[92:93], v7 offset:16384
    v_mfma_f32_16x16x32_bf16 v[188:191], v[220:223], v[44:47], v[188:191]
    ds_read_b64_tr_b16 v[94:95], v7 offset:18432
    s_waitcnt lgkmcnt(12)
    v_mfma_f32_16x16x32_bf16 v[128:131], v[224:227], v[40:43], v[128:131]
    ds_read_b64_tr_b16 v[96:97], v8 offset:16384
    v_mfma_f32_16x16x32_bf16 v[192:195], v[224:227], v[44:47], v[192:195]
    ds_read_b64_tr_b16 v[98:99], v8 offset:18432
    v_mfma_f32_16x16x32_bf16 v[132:135], v[228:231], v[40:43], v[132:135]
    ds_read_b64_tr_b16 v[100:101], v10 offset:16384
    v_mfma_f32_16x16x32_bf16 v[196:199], v[228:231], v[44:47], v[196:199]
    ds_read_b64_tr_b16 v[102:103], v10 offset:18432
    s_waitcnt vmcnt(32)
    s_waitcnt lgkmcnt(12)
    v_mfma_f32_16x16x32_bf16 v[120:123], v[232:235], v[48:51], v[120:123]
    ds_read_b64_tr_b16 v[104:105], v6 offset:20480
    v_mfma_f32_16x16x32_bf16 v[184:187], v[232:235], v[52:55], v[184:187]
    ds_read_b64_tr_b16 v[106:107], v6 offset:22528
    v_mfma_f32_16x16x32_bf16 v[124:127], v[236:239], v[48:51], v[124:127]
    ds_read_b64_tr_b16 v[108:109], v7 offset:20480
    v_mfma_f32_16x16x32_bf16 v[188:191], v[236:239], v[52:55], v[188:191]
    ds_read_b64_tr_b16 v[110:111], v7 offset:22528
    s_waitcnt lgkmcnt(12)
    v_mfma_f32_16x16x32_bf16 v[128:131], v[240:243], v[48:51], v[128:131]
    ds_read_b64_tr_b16 v[112:113], v8 offset:20480
    v_mfma_f32_16x16x32_bf16 v[192:195], v[240:243], v[52:55], v[192:195]
    ds_read_b64_tr_b16 v[114:115], v8 offset:22528
    v_mfma_f32_16x16x32_bf16 v[132:135], v[244:247], v[48:51], v[132:135]
    ds_read_b64_tr_b16 v[116:117], v10 offset:20480
    v_mfma_f32_16x16x32_bf16 v[196:199], v[244:247], v[52:55], v[196:199]
    ds_read_b64_tr_b16 v[118:119], v10 offset:22528
    s_waitcnt vmcnt(30)
    s_waitcnt lgkmcnt(12)
    v_mfma_f32_16x16x32_bf16 v[120:123], v[88:91], v[56:59], v[120:123]
    ds_read_b64_tr_b16 v[216:217], v6 offset:24576
    v_mfma_f32_16x16x32_bf16 v[184:187], v[88:91], v[60:63], v[184:187]
    ds_read_b64_tr_b16 v[218:219], v6 offset:26624
    v_mfma_f32_16x16x32_bf16 v[124:127], v[92:95], v[56:59], v[124:127]
    ds_read_b64_tr_b16 v[220:221], v7 offset:24576
    v_mfma_f32_16x16x32_bf16 v[188:191], v[92:95], v[60:63], v[188:191]
    ds_read_b64_tr_b16 v[222:223], v7 offset:26624
    s_waitcnt lgkmcnt(12)
    v_mfma_f32_16x16x32_bf16 v[128:131], v[96:99], v[56:59], v[128:131]
    ds_read_b64_tr_b16 v[224:225], v8 offset:24576
    v_mfma_f32_16x16x32_bf16 v[192:195], v[96:99], v[60:63], v[192:195]
    ds_read_b64_tr_b16 v[226:227], v8 offset:26624
    v_mfma_f32_16x16x32_bf16 v[132:135], v[100:103], v[56:59], v[132:135]
    ds_read_b64_tr_b16 v[228:229], v10 offset:24576
    v_mfma_f32_16x16x32_bf16 v[196:199], v[100:103], v[60:63], v[196:199]
    ds_read_b64_tr_b16 v[230:231], v10 offset:26624
    s_waitcnt vmcnt(28)
    s_waitcnt lgkmcnt(12)
    v_mfma_f32_16x16x32_bf16 v[120:123], v[104:107], v[64:67], v[120:123]
    ds_read_b64_tr_b16 v[232:233], v6 offset:28672
    v_mfma_f32_16x16x32_bf16 v[184:187], v[104:107], v[68:71], v[184:187]
    ds_read_b64_tr_b16 v[234:235], v6 offset:30720
    v_mfma_f32_16x16x32_bf16 v[124:127], v[108:111], v[64:67], v[124:127]
    ds_read_b64_tr_b16 v[236:237], v7 offset:28672
    v_mfma_f32_16x16x32_bf16 v[188:191], v[108:111], v[68:71], v[188:191]
    ds_read_b64_tr_b16 v[238:239], v7 offset:30720
    s_waitcnt lgkmcnt(12)
    v_mfma_f32_16x16x32_bf16 v[128:131], v[112:115], v[64:67], v[128:131]
    ds_read_b64_tr_b16 v[240:241], v8 offset:28672
    v_mfma_f32_16x16x32_bf16 v[192:195], v[112:115], v[68:71], v[192:195]
    ds_read_b64_tr_b16 v[242:243], v8 offset:30720
    v_mfma_f32_16x16x32_bf16 v[132:135], v[116:119], v[64:67], v[132:135]
    ds_read_b64_tr_b16 v[244:245], v10 offset:28672
    v_mfma_f32_16x16x32_bf16 v[196:199], v[116:119], v[68:71], v[196:199]
    ds_read_b64_tr_b16 v[246:247], v10 offset:30720
    s_waitcnt vmcnt(20)
    s_barrier
    s_waitcnt lgkmcnt(12)
    v_mfma_f32_16x16x32_bf16 v[120:123], v[216:219], v[72:75], v[120:123]
    ds_read_b64_tr_b16 v[88:89], v6 offset:0
    v_mfma_f32_16x16x32_bf16 v[184:187], v[216:219], v[76:79], v[184:187]
    ds_read_b64_tr_b16 v[90:91], v6 offset:2048
    v_mfma_f32_16x16x32_bf16 v[124:127], v[220:223], v[72:75], v[124:127]
    ds_read_b64_tr_b16 v[92:93], v7 offset:0
    v_mfma_f32_16x16x32_bf16 v[188:191], v[220:223], v[76:79], v[188:191]
    ds_read_b64_tr_b16 v[94:95], v7 offset:2048
    s_waitcnt lgkmcnt(12)
    v_mfma_f32_16x16x32_bf16 v[128:131], v[224:227], v[72:75], v[128:131]
    ds_read_b64_tr_b16 v[96:97], v8 offset:0
    v_mfma_f32_16x16x32_bf16 v[192:195], v[224:227], v[76:79], v[192:195]
    ds_read_b64_tr_b16 v[98:99], v8 offset:2048
    v_mfma_f32_16x16x32_bf16 v[132:135], v[228:231], v[72:75], v[132:135]
    ds_read_b64_tr_b16 v[100:101], v10 offset:0
    v_mfma_f32_16x16x32_bf16 v[196:199], v[228:231], v[76:79], v[196:199]
    ds_read_b64_tr_b16 v[102:103], v10 offset:2048
    s_waitcnt vmcnt(24)
    s_waitcnt lgkmcnt(12)
    v_mfma_f32_16x16x32_bf16 v[120:123], v[232:235], v[80:83], v[120:123]
    ds_read_b64_tr_b16 v[104:105], v6 offset:4096
    v_mfma_f32_16x16x32_bf16 v[184:187], v[232:235], v[84:87], v[184:187]
    ds_read_b64_tr_b16 v[106:107], v6 offset:6144
    v_mfma_f32_16x16x32_bf16 v[124:127], v[236:239], v[80:83], v[124:127]
    ds_read_b64_tr_b16 v[108:109], v7 offset:4096
    v_mfma_f32_16x16x32_bf16 v[188:191], v[236:239], v[84:87], v[188:191]
    ds_read_b64_tr_b16 v[110:111], v7 offset:6144
    s_waitcnt lgkmcnt(12)
    v_mfma_f32_16x16x32_bf16 v[128:131], v[240:243], v[80:83], v[128:131]
    ds_read_b64_tr_b16 v[112:113], v8 offset:4096
    v_mfma_f32_16x16x32_bf16 v[192:195], v[240:243], v[84:87], v[192:195]
    ds_read_b64_tr_b16 v[114:115], v8 offset:6144
    v_mfma_f32_16x16x32_bf16 v[132:135], v[244:247], v[80:83], v[132:135]
    ds_read_b64_tr_b16 v[116:117], v10 offset:4096
    v_mfma_f32_16x16x32_bf16 v[196:199], v[244:247], v[84:87], v[196:199]
    ds_read_b64_tr_b16 v[118:119], v10 offset:6144
    s_waitcnt vmcnt(18)
    s_waitcnt lgkmcnt(12)
    v_mfma_f32_16x16x32_bf16 v[120:123], v[88:91], v[136:139], v[120:123]
    ds_read_b64_tr_b16 v[216:217], v6 offset:8192
    v_mfma_f32_16x16x32_bf16 v[184:187], v[88:91], v[140:143], v[184:187]
    ds_read_b64_tr_b16 v[218:219], v6 offset:10240
    v_mfma_f32_16x16x32_bf16 v[124:127], v[92:95], v[136:139], v[124:127]
    ds_read_b64_tr_b16 v[220:221], v7 offset:8192
    v_mfma_f32_16x16x32_bf16 v[188:191], v[92:95], v[140:143], v[188:191]
    ds_read_b64_tr_b16 v[222:223], v7 offset:10240
    s_waitcnt lgkmcnt(12)
    v_mfma_f32_16x16x32_bf16 v[128:131], v[96:99], v[136:139], v[128:131]
    ds_read_b64_tr_b16 v[224:225], v8 offset:8192
    v_mfma_f32_16x16x32_bf16 v[192:195], v[96:99], v[140:143], v[192:195]
    ds_read_b64_tr_b16 v[226:227], v8 offset:10240
    v_mfma_f32_16x16x32_bf16 v[132:135], v[100:103], v[136:139], v[132:135]
    ds_read_b64_tr_b16 v[228:229], v10 offset:8192
    v_mfma_f32_16x16x32_bf16 v[196:199], v[100:103], v[140:143], v[196:199]
    ds_read_b64_tr_b16 v[230:231], v10 offset:10240
    s_waitcnt vmcnt(16)
    s_waitcnt lgkmcnt(12)
    v_mfma_f32_16x16x32_bf16 v[120:123], v[104:107], v[144:147], v[120:123]
    ds_read_b64_tr_b16 v[232:233], v6 offset:12288
    v_mfma_f32_16x16x32_bf16 v[184:187], v[104:107], v[148:151], v[184:187]
    ds_read_b64_tr_b16 v[234:235], v6 offset:14336
    v_mfma_f32_16x16x32_bf16 v[124:127], v[108:111], v[144:147], v[124:127]
    ds_read_b64_tr_b16 v[236:237], v7 offset:12288
    v_mfma_f32_16x16x32_bf16 v[188:191], v[108:111], v[148:151], v[188:191]
    ds_read_b64_tr_b16 v[238:239], v7 offset:14336
    s_waitcnt lgkmcnt(12)
    v_mfma_f32_16x16x32_bf16 v[128:131], v[112:115], v[144:147], v[128:131]
    ds_read_b64_tr_b16 v[240:241], v8 offset:12288
    v_mfma_f32_16x16x32_bf16 v[192:195], v[112:115], v[148:151], v[192:195]
    ds_read_b64_tr_b16 v[242:243], v8 offset:14336
    v_mfma_f32_16x16x32_bf16 v[132:135], v[116:119], v[144:147], v[132:135]
    ds_read_b64_tr_b16 v[244:245], v10 offset:12288
    v_mfma_f32_16x16x32_bf16 v[196:199], v[116:119], v[148:151], v[196:199]
    ds_read_b64_tr_b16 v[246:247], v10 offset:14336
    s_waitcnt vmcnt(8)
    s_barrier
    s_waitcnt lgkmcnt(12)
    v_mfma_f32_16x16x32_bf16 v[120:123], v[216:219], v[152:155], v[120:123]
    ds_read_b64_tr_b16 v[88:89], v17 offset:0
    v_mfma_f32_16x16x32_bf16 v[184:187], v[216:219], v[156:159], v[184:187]
    ds_read_b64_tr_b16 v[90:91], v17 offset:2048
    v_mfma_f32_16x16x32_bf16 v[124:127], v[220:223], v[152:155], v[124:127]
    ds_read_b64_tr_b16 v[92:93], v18 offset:0
    v_mfma_f32_16x16x32_bf16 v[188:191], v[220:223], v[156:159], v[188:191]
    ds_read_b64_tr_b16 v[94:95], v18 offset:2048
    s_waitcnt lgkmcnt(12)
    v_mfma_f32_16x16x32_bf16 v[128:131], v[224:227], v[152:155], v[128:131]
    ds_read_b64_tr_b16 v[96:97], v19 offset:0
    v_mfma_f32_16x16x32_bf16 v[192:195], v[224:227], v[156:159], v[192:195]
    ds_read_b64_tr_b16 v[98:99], v19 offset:2048
    v_mfma_f32_16x16x32_bf16 v[132:135], v[228:231], v[152:155], v[132:135]
    ds_read_b64_tr_b16 v[100:101], v20 offset:0
    v_mfma_f32_16x16x32_bf16 v[196:199], v[228:231], v[156:159], v[196:199]
    ds_read_b64_tr_b16 v[102:103], v20 offset:2048
    s_waitcnt vmcnt(12)
    s_waitcnt lgkmcnt(12)
    v_mfma_f32_16x16x32_bf16 v[120:123], v[232:235], v[160:163], v[120:123]
    ds_read_b64_tr_b16 v[104:105], v17 offset:4096
    v_mfma_f32_16x16x32_bf16 v[184:187], v[232:235], v[164:167], v[184:187]
    ds_read_b64_tr_b16 v[106:107], v17 offset:6144
    v_mfma_f32_16x16x32_bf16 v[124:127], v[236:239], v[160:163], v[124:127]
    ds_read_b64_tr_b16 v[108:109], v18 offset:4096
    v_mfma_f32_16x16x32_bf16 v[188:191], v[236:239], v[164:167], v[188:191]
    ds_read_b64_tr_b16 v[110:111], v18 offset:6144
    s_waitcnt lgkmcnt(12)
    v_mfma_f32_16x16x32_bf16 v[128:131], v[240:243], v[160:163], v[128:131]
    ds_read_b64_tr_b16 v[112:113], v19 offset:4096
    v_mfma_f32_16x16x32_bf16 v[192:195], v[240:243], v[164:167], v[192:195]
    ds_read_b64_tr_b16 v[114:115], v19 offset:6144
    v_mfma_f32_16x16x32_bf16 v[132:135], v[244:247], v[160:163], v[132:135]
    ds_read_b64_tr_b16 v[116:117], v20 offset:4096
    v_mfma_f32_16x16x32_bf16 v[196:199], v[244:247], v[164:167], v[196:199]
    ds_read_b64_tr_b16 v[118:119], v20 offset:6144
    s_waitcnt vmcnt(6)
    s_waitcnt lgkmcnt(12)
    v_mfma_f32_16x16x32_bf16 v[120:123], v[88:91], v[168:171], v[120:123]
    ds_read_b64_tr_b16 v[216:217], v17 offset:8192
    v_mfma_f32_16x16x32_bf16 v[184:187], v[88:91], v[172:175], v[184:187]
    ds_read_b64_tr_b16 v[218:219], v17 offset:10240
    v_mfma_f32_16x16x32_bf16 v[124:127], v[92:95], v[168:171], v[124:127]
    ds_read_b64_tr_b16 v[220:221], v18 offset:8192
    v_mfma_f32_16x16x32_bf16 v[188:191], v[92:95], v[172:175], v[188:191]
    ds_read_b64_tr_b16 v[222:223], v18 offset:10240
    s_waitcnt lgkmcnt(12)
    v_mfma_f32_16x16x32_bf16 v[128:131], v[96:99], v[168:171], v[128:131]
    ds_read_b64_tr_b16 v[224:225], v19 offset:8192
    v_mfma_f32_16x16x32_bf16 v[192:195], v[96:99], v[172:175], v[192:195]
    ds_read_b64_tr_b16 v[226:227], v19 offset:10240
    v_mfma_f32_16x16x32_bf16 v[132:135], v[100:103], v[168:171], v[132:135]
    ds_read_b64_tr_b16 v[228:229], v20 offset:8192
    v_mfma_f32_16x16x32_bf16 v[196:199], v[100:103], v[172:175], v[196:199]
    ds_read_b64_tr_b16 v[230:231], v20 offset:10240
    s_waitcnt vmcnt(4)
    s_waitcnt lgkmcnt(12)
    v_mfma_f32_16x16x32_bf16 v[120:123], v[104:107], v[176:179], v[120:123]
    ds_read_b64_tr_b16 v[232:233], v17 offset:12288
    v_mfma_f32_16x16x32_bf16 v[184:187], v[104:107], v[180:183], v[184:187]
    ds_read_b64_tr_b16 v[234:235], v17 offset:14336
    v_mfma_f32_16x16x32_bf16 v[124:127], v[108:111], v[176:179], v[124:127]
    ds_read_b64_tr_b16 v[236:237], v18 offset:12288
    v_mfma_f32_16x16x32_bf16 v[188:191], v[108:111], v[180:183], v[188:191]
    ds_read_b64_tr_b16 v[238:239], v18 offset:14336
    s_waitcnt lgkmcnt(12)
    v_mfma_f32_16x16x32_bf16 v[128:131], v[112:115], v[176:179], v[128:131]
    ds_read_b64_tr_b16 v[240:241], v19 offset:12288
    v_mfma_f32_16x16x32_bf16 v[192:195], v[112:115], v[180:183], v[192:195]
    ds_read_b64_tr_b16 v[242:243], v19 offset:14336
    v_mfma_f32_16x16x32_bf16 v[132:135], v[116:119], v[176:179], v[132:135]
    ds_read_b64_tr_b16 v[244:245], v20 offset:12288
    v_mfma_f32_16x16x32_bf16 v[196:199], v[116:119], v[180:183], v[196:199]
    ds_read_b64_tr_b16 v[246:247], v20 offset:14336
    s_waitcnt vmcnt(2)
    s_waitcnt lgkmcnt(12)
    v_mfma_f32_16x16x32_bf16 v[120:123], v[216:219], v[200:203], v[120:123]
    v_mfma_f32_16x16x32_bf16 v[184:187], v[216:219], v[204:207], v[184:187]
    v_mfma_f32_16x16x32_bf16 v[124:127], v[220:223], v[200:203], v[124:127]
    v_mfma_f32_16x16x32_bf16 v[188:191], v[220:223], v[204:207], v[188:191]
    s_waitcnt lgkmcnt(8)
    v_mfma_f32_16x16x32_bf16 v[128:131], v[224:227], v[200:203], v[128:131]
    v_mfma_f32_16x16x32_bf16 v[192:195], v[224:227], v[204:207], v[192:195]
    v_mfma_f32_16x16x32_bf16 v[132:135], v[228:231], v[200:203], v[132:135]
    v_mfma_f32_16x16x32_bf16 v[196:199], v[228:231], v[204:207], v[196:199]
    s_waitcnt vmcnt(0)
    s_waitcnt lgkmcnt(4)
    v_mfma_f32_16x16x32_bf16 v[120:123], v[232:235], v[208:211], v[120:123]
    v_mfma_f32_16x16x32_bf16 v[184:187], v[232:235], v[212:215], v[184:187]
    v_mfma_f32_16x16x32_bf16 v[124:127], v[236:239], v[208:211], v[124:127]
    v_mfma_f32_16x16x32_bf16 v[188:191], v[236:239], v[212:215], v[188:191]
    s_waitcnt lgkmcnt(0)
    v_mfma_f32_16x16x32_bf16 v[128:131], v[240:243], v[208:211], v[128:131]
    v_mfma_f32_16x16x32_bf16 v[192:195], v[240:243], v[212:215], v[192:195]
    v_mfma_f32_16x16x32_bf16 v[132:135], v[244:247], v[208:211], v[132:135]
    v_mfma_f32_16x16x32_bf16 v[196:199], v[244:247], v[212:215], v[196:199]
attn_out_kernel_g_epi:
    s_mov_b32 s56, s10
    s_mov_b32 s57, s11
    s_mov_b32 s58, 4194304
    s_mov_b32 s59, 0x20000
    s_waitcnt vmcnt(0) lgkmcnt(0)
    s_nop 3
    v_cvt_pk_bf16_f32 v56, v120, v121
    v_cvt_pk_bf16_f32 v58, v124, v125
    v_cvt_pk_bf16_f32 v60, v128, v129
    v_cvt_pk_bf16_f32 v62, v132, v133
    v_cvt_pk_bf16_f32 v64, v184, v185
    v_cvt_pk_bf16_f32 v66, v188, v189
    v_cvt_pk_bf16_f32 v68, v192, v193
    v_cvt_pk_bf16_f32 v70, v196, v197
    v_cvt_pk_bf16_f32 v57, v122, v123
    v_cvt_pk_bf16_f32 v59, v126, v127
    v_cvt_pk_bf16_f32 v61, v130, v131
    v_cvt_pk_bf16_f32 v63, v134, v135
    v_cvt_pk_bf16_f32 v65, v186, v187
    v_cvt_pk_bf16_f32 v67, v190, v191
    v_cvt_pk_bf16_f32 v69, v194, v195
    v_cvt_pk_bf16_f32 v71, v198, v199
    s_nop 1
    v_permlane16_swap_b32 v56, v58
    v_permlane16_swap_b32 v57, v59
    v_permlane16_swap_b32 v60, v62
    v_permlane16_swap_b32 v61, v63
    v_permlane16_swap_b32 v64, v66
    v_permlane16_swap_b32 v65, v67
    v_permlane16_swap_b32 v68, v70
    v_permlane16_swap_b32 v69, v71
    s_nop 0
    buffer_store_dwordx4 v[56:59], v22, s[56:59], 0 offen offset:0 sc1
    buffer_store_dwordx4 v[60:63], v22, s[56:59], 0 offen offset:64 sc1
    buffer_store_dwordx4 v[64:67], v22, s[56:59], s37 offen offset:0 sc1
    buffer_store_dwordx4 v[68:71], v22, s[56:59], s37 offen offset:64 sc1
attn_out_kernel_g_tailend:
attn_out_kernel_done:
    s_endpgm
attn_out_kernel_pfend:
.section .rodata,"a"
.p2align 6
.amdhsa_kernel proj_kernel
  .amdhsa_next_free_vgpr 504
  .amdhsa_next_free_sgpr 100
  .amdhsa_accum_offset 256
  .amdhsa_group_segment_fixed_size 0
  .amdhsa_kernarg_size 96
  .amdhsa_user_sgpr_count 2
  .amdhsa_user_sgpr_kernarg_segment_ptr 1
  .amdhsa_system_sgpr_workgroup_id_x 1
.end_amdhsa_kernel
.section .rodata,"a"
.p2align 6
.amdhsa_kernel attn_out_kernel
  .amdhsa_next_free_vgpr 248
  .amdhsa_next_free_sgpr 100
  .amdhsa_accum_offset 248
  .amdhsa_group_segment_fixed_size 0
  .amdhsa_kernarg_size 96
  .amdhsa_user_sgpr_count 2
  .amdhsa_user_sgpr_kernarg_segment_ptr 1
  .amdhsa_system_sgpr_workgroup_id_x 1
.end_amdhsa_kernel
```
